```python
import torch

def _softmax(x, axis=-1):
    return torch.softmax(x, dim=axis)

def _gelu(x):
    return torch.nn.functional.gelu(x, approximate='tanh')

def _silu(x):
    return torch.nn.functional.silu(x)

def _sigmoid(x):
    return torch.sigmoid(x)

def _layernorm(x, axis=-1, eps=1e-05):
    m = x.mean(dim=axis, keepdim=True)
    v = x.var(dim=axis, keepdim=True, unbiased=False)
    return (x - m) / torch.sqrt(v + eps)

def _scatter_add(tgt, idx, src, axis=0):
    return tgt.clone().index_add_(axis, idx, src)

def _segment_sum(src, seg, n):
    out = torch.zeros((n,) + src.shape[1:], dtype=src.dtype)
    return out.index_add_(0, seg, src)

def _pad(x, pw):
    flat = tuple((v for pair in reversed(pw) for v in pair))
    return torch.nn.functional.pad(x, flat)
kernel_name = 'gated_mix__mha_block__mixer_gmlp__prompt'

def setup_inputs():

    _w = lambda a: (lambda t: t.to(torch.bfloat16) if t.is_floating_point() else t)(torch.as_tensor(a))

    def _A_setup():
        B, S, D, H = (1, 2048, 512, 32)
        return {'x': _w((lambda *s: torch.randn(*s, dtype=torch.bfloat16) * 0.05)(B, S, D)), 'wqkv': _w((lambda *s: torch.randn(*s, dtype=torch.bfloat16) * 1.6)(D, 3 * D)), 'wo': _w((lambda *s: torch.randn(*s, dtype=torch.bfloat16) * 0.1)(D, D))}
    _A_in = _A_setup()

    def _B_setup():
        B, S, D, F = (1, 2048, 512, 1792)
        Fh = F // 2
        return {'x': _w((lambda *s: torch.randn(*s, dtype=torch.bfloat16) * 0.05)(B, S, D)), 'w_in': _w((lambda *s: torch.randn(*s, dtype=torch.bfloat16) * 0.8)(D, 2 * Fh)), 'w_sp': _w(0.01 * (lambda *s: torch.randn(*s, dtype=torch.bfloat16) * 0.8)(S, S)), 'b_sp': _w(1.0 + 0.01 * (lambda *s: torch.randn(*s, dtype=torch.bfloat16) * 0.05)(S)), 'w_out': _w((lambda *s: torch.randn(*s, dtype=torch.bfloat16) * 0.05)(Fh, D))}
    _B_in = _B_setup()
    return {'A_x': _A_in['x'], 'A_wqkv': _A_in['wqkv'], 'A_wo': _A_in['wo'], 'B_x': _B_in['x'], 'B_w_in': _B_in['w_in'], 'B_w_sp': _B_in['w_sp'], 'B_b_sp': _B_in['b_sp'], 'B_w_out': _B_in['w_out'], 'gate_w': _w((lambda *s: torch.randn(*s, dtype=torch.bfloat16) * 0.05)(512) * 16.0)}

def reference(A_x, A_wqkv, A_wo, B_x, B_w_in, B_w_sp, B_b_sp, B_w_out, gate_w):

    def _A_ref(x, wqkv, wo):
        B, S, D = x.shape
        H = 32
        Dh = D // H
        qkv = (lambda x, *d: x.permute(*d))((x @ wqkv).reshape(B, S, 3, H, Dh), 2, 0, 3, 1, 4)
        q, k, v = (qkv[0], qkv[1], qkv[2])
        scores = torch.einsum('bhqd,bhkd->bhqk', q, k) * Dh ** (-0.5)
        p = _softmax(scores, axis=-1)
        o = torch.einsum('bhqk,bhkd->bhqd', p, v)
        return (lambda x, *d: x.permute(*d))(o, 0, 2, 1, 3).reshape(B, S, D) @ wo

    def _B_ref(x, w_in, w_sp, b_sp, w_out):
        B, S, D = x.shape
        F = w_in.shape[-1]
        Fh = F // 2
        z = _gelu(torch.einsum('bsd,df->bsf', x, w_in))
        z1 = z[..., :Fh].clone()
        z2 = _layernorm(z[..., Fh:], axis=-1)
        g = torch.einsum('ts,bsf->btf', w_sp, z2) + b_sp[None, :, None]
        return torch.einsum('bsf,fd->bsd', z1 * g, w_out)
    x = A_x
    g = _sigmoid((x * gate_w).sum(-1, keepdims=True))
    a = _A_ref(x, A_wqkv, A_wo)
    b = _B_ref(x, B_w_in, B_w_sp, B_b_sp, B_w_out)
    return g * a + (1 - g) * b
```

```asm
; @launch grid=(256,1,1) block=(512,1,1) lds=163840
.amdgcn_target "amdgcn-amd-amdhsa--gfx950"
.text
.globl gated_mix__mha_block__mixer_gmlp__prompt_kernel
.p2align 8
.type gated_mix__mha_block__mixer_gmlp__prompt_kernel,@function
gated_mix__mha_block__mixer_gmlp__prompt_kernel:
    s_cmp_ge_u32 s2, 256
    s_cbranch_scc1 FK_END
    s_load_dwordx16 s[16:31], s[0:1], 0x0
    s_load_dwordx8 s[32:39], s[0:1], 0x40
    s_getpc_b64 s[4:5]
FK_PC:
    s_bfe_u32 s6, s2, 0x40003
    s_lshl_b32 s6, s6, 12
    v_lshl_add_u32 v254, v0, 3, s6
    v_min_u32 v254, FK_CODE_END-FK_PC-8, v254
    global_load_dwordx2 v[254:255], v254, s[4:5]
    v_and_b32 v1, 63, v0
    v_mov_b32 v31, 0
    v_lshrrev_b32 v5, 6, v0
    s_nop 0
    v_readfirstlane_b32 s64, v5
    s_and_b32 s71, s2, 7
    s_lshr_b32 s72, s2, 3
    s_and_b32 s73, s72, 3
    s_lshr_b32 s70, s72, 2
    s_lshr_b32 s67, s71, 1
    s_lshl_b32 s67, s67, 2
    s_add_u32 s67, s67, s73
    s_and_b32 s68, s71, 1
    s_lshl_b32 s68, s68, 3
    s_add_u32 s68, s68, s70
    s_lshl_b32 s3, s73, 1
    s_add_u32 s3, s3, s68
    s_and_b32 s3, s3, 7
    s_lshl_b32 s3, s3, 7
    s_lshl_b32 s69, s71, 2
    s_add_u32 s69, s69, s73
    s_and_b32 s65, s64, 3
    s_lshr_b32 s66, s64, 2
    s_lshl_b32 s75, s67, 17
    s_lshl_b32 s82, s64, 10
    s_lshl_b32 s83, s64, 11
    s_sub_u32 s71, s68, 4
    s_cmp_lt_u32 s68, 8
    s_cselect_b32 s97, s68, s71
    s_lshl_b32 s76, s97, 8
    s_cmp_eq_u32 s68, 11
    s_cmov_b32 s76, 0
    s_lshr_b32 s89, 0x070f, s68
    s_and_b32 s89, s89, 1
    s_cselect_b32 s71, 1792, 0
    s_mov_b32 s74, 3072
    s_cmov_b32 s74, 3584
    s_add_u32 s76, s76, s71
    s_lshr_b32 s77, s74, 1
    v_lshrrev_b32 v5, 3, v1
    v_lshrrev_b32 v6, 4, v1
    v_and_b32 v18, 7, v1
    v_xor_b32 v19, v18, v6
    v_lshlrev_b32 v19, 4, v19
    s_lshl_b32 s71, s64, 4
    v_add_u32 v20, s71, v5
    v_lshlrev_b32 v20, 10, v20
    v_add_u32 v8, v20, v19
    v_xor_b32 v9, 64, v8
    v_add_u32 v9, 8192, v9
    v_and_b32 v19, 1, v6
    v_lshlrev_b32 v19, 2, v19
    v_xor_b32 v19, v18, v19
    v_lshlrev_b32 v19, 4, v19
    s_lshl_b32 s71, s64, 3
    v_add_u32 v20, s71, v5
    v_mul_u32_u24 v10, s74, v20
    v_add_u32 v10, v10, v19
    s_waitcnt lgkmcnt(0)
    s_mov_b32 s40, s16
    s_mov_b32 s41, s17
    s_mov_b32 s42, 0x200000
    s_mov_b32 s43, 0x00020000
    s_mov_b32 s16, s69
    s_mov_b32 s17, s70
    s_lshr_b32 s70, s68, 1
    s_bfe_u32 s69, s2, 0x20001
    s_lshl_b32 s69, s69, 3
    s_bfe_u32 s71, s2, 0x30003
    s_add_u32 s69, s69, s71
    s_cmp_eq_u32 s89, 0
    s_cselect_b32 s44, s18, s24
    s_cselect_b32 s45, s19, s25
    s_mov_b32 s71, 0x1c0000
    s_cselect_b32 s46, 0x180000, s71
    s_mov_b32 s47, 0x00020000
    s_mov_b32 s52, s38
    s_mov_b32 s53, s39
    s_mov_b32 s54, 0x10000000
    s_mov_b32 s55, 0x00020000
    s_or_b32 s71, s2, s64
    s_cmp_lg_u32 s71, 0
    s_cbranch_scc1 FK_NOGEN
    v_mov_b32 v31, 0x1505040
    buffer_load_dword v30, v31, s[52:55], 0 offen sc1
FK_NOGEN:
    s_add_u32 s80, s75, s3
    s_mul_i32 s88, s3, s77
    s_add_u32 m0, s83, 0x0
    s_nop 0
    buffer_load_dwordx4 v8, s[40:43], s80 offen lds
    s_add_u32 s88, s88, s76
    s_add_u32 m0, s82, 0x4000
    s_nop 0
    buffer_load_dwordx4 v10, s[44:47], s88 offen lds
    s_add_u32 m0, s83, 0x400
    s_nop 0
    buffer_load_dwordx4 v9, s[40:43], s80 offen lds
    s_add_u32 m0, s82, 0x5f80
    s_nop 0
    buffer_load_dwordx4 v10, s[44:47], s88 offen offset:128 lds
    s_add_u32 s3, s3, 128
    s_and_b32 s3, s3, 1023
    s_add_u32 s80, s75, s3
    s_mul_i32 s88, s3, s77
    s_add_u32 m0, s83, 0x8000
    s_nop 0
    buffer_load_dwordx4 v8, s[40:43], s80 offen lds
    s_add_u32 s88, s88, s76
    s_add_u32 m0, s82, 0xc000
    s_nop 0
    buffer_load_dwordx4 v10, s[44:47], s88 offen lds
    s_add_u32 m0, s83, 0x8400
    s_nop 0
    buffer_load_dwordx4 v9, s[40:43], s80 offen lds
    s_add_u32 m0, s82, 0xdf80
    s_nop 0
    buffer_load_dwordx4 v10, s[44:47], s88 offen offset:128 lds
    s_add_u32 s3, s3, 128
    s_and_b32 s3, s3, 1023
    s_lshr_b32 s71, 0x3870, s68
    s_and_b32 s71, s71, 1
    s_cselect_b32 s48, s18, s24
    s_cselect_b32 s49, s19, s25
    s_mov_b32 s72, 0x1c0000
    s_cselect_b32 s50, 0x180000, s72
    s_mov_b32 s51, 0x00020000
    s_mov_b32 s74, 3584
    s_cmov_b32 s74, 3072
    s_cselect_b32 s23, 1, 2
    s_cmp_lg_u32 s89, 0
    s_cmov_b32 s23, 0
    s_lshr_b32 s96, s74, 1
    v_mul_u32_u24 v11, s74, v20
    v_add_u32 v11, v11, v19
    v_mul_u32_u24 v28, 3584, v20
    v_add_u32 v28, v28, v19
    s_mov_b32 s4, s24
    s_mov_b32 s5, s25
    s_mov_b32 s6, 0x1c0000
    s_mov_b32 s7, 0x00020000
    s_mov_b32 s56, s36
    s_mov_b32 s57, s37
    s_mov_b32 s58, 0x100
    s_mov_b32 s59, 0x00020000
    s_mov_b32 s60, s26
    s_mov_b32 s61, s27
    s_mov_b32 s62, 0x800000
    s_mov_b32 s63, 0x00020000
    s_mov_b32 s12, s32
    s_mov_b32 s13, s33
    s_mov_b32 s14, 0x400
    s_mov_b32 s15, 0x00020000
    s_lshl_b32 s81, s67, 2
    s_add_u32 s81, s81, s65
    s_lshl_b32 s71, s68, 2
    s_mov_b32 s84, 0xc642aa88
    s_mov_b32 s85, 0x7d7539b9
    s_lshr_b64 s[84:85], s[84:85], s71
    s_and_b32 s78, s84, 15
    s_lshl_b32 s78, s78, 7
    s_mov_b32 s84, 0x64200000
    s_mov_b32 s85, 0x55531000
    s_lshr_b64 s[84:85], s[84:85], s71
    s_and_b32 s79, s84, 15
    s_lshl_b32 s79, s79, 7
    v_lshlrev_b32 v2, 4, v1
    v_lshlrev_b32 v3, 7, v1
    s_lshl_b32 s74, s67, 2
    s_and_b32 s71, s68, 3
    s_lshl_b32 s71, s71, 10
    s_cmp_lt_u32 s68, 8
    s_mov_b32 s72, 0x1500040
    s_cmov_b32 s72, 0x1500000
    s_add_u32 s71, s71, s72
    s_cmp_eq_u32 s68, 11
    s_cmov_b32 s71, 0x1501000
    s_add_u32 s71, s71, s74
    s_mov_b64 exec, 0xff
    v_add_u32 v3, s71, v3
    s_lshl_b32 s72, s78, 2
    s_add_u32 s72, s72, s74
    s_add_u32 s72, s72, 0x1501000
    s_cmp_eq_u32 s23, 1
    s_cselect_b32 s71, s72, s71
    s_sub_u32 s71, s71, 1024
    s_mov_b64 exec, 0xff00
    v_add_u32 v3, s71, v3
    s_lshl_b32 s71, s97, 1
    s_add_u32 s71, s71, s66
    s_mul_i32 s72, s81, 14
    s_add_u32 s71, s71, s72
    s_lshl_b32 s71, s71, 9
    s_add_u32 s87, s71, 0x1410000
    s_lshl_b32 s71, s97, 7
    s_add_u32 s71, s71, s74
    s_add_u32 s71, s71, 0x1502000
    s_mov_b32 exec_lo, 0xff000000
    v_lshl_add_u32 v3, v1, 10, s71
    s_lshl_b32 s71, s97, 2
    s_add_u32 s97, s71, s66
    s_lshl_b32 s71, s67, 7
    s_lshl_b32 s72, s68, 2
    s_add_u32 s71, s71, s72
    s_add_u32 s71, s71, 0x1502000
    s_mov_b64 exec, 0x10000
    v_mov_b32 v3, s71
    s_lshl_b32 s71, s69, 2
    s_add_u32 s71, s71, 0x1504000
    s_mov_b64 exec, 0x40000
    v_mov_b32 v3, s71
    s_mov_b64 exec, -1
    s_add_u32 s80, s75, s3
    s_mul_i32 s88, s3, s77
    s_add_u32 m0, s83, 0x10000
    s_nop 0
    buffer_load_dwordx4 v8, s[40:43], s80 offen lds
    s_add_u32 s88, s88, s76
    s_add_u32 m0, s82, 0x14000
    s_nop 0
    buffer_load_dwordx4 v10, s[44:47], s88 offen lds
    s_add_u32 m0, s83, 0x10400
    s_nop 0
    buffer_load_dwordx4 v9, s[40:43], s80 offen lds
    s_add_u32 m0, s82, 0x15f80
    s_nop 0
    buffer_load_dwordx4 v10, s[44:47], s88 offen offset:128 lds
    s_add_u32 s3, s3, 128
    s_and_b32 s3, s3, 1023
    v_and_b32 v5, 31, v1
    v_lshrrev_b32 v6, 5, v1
    v_bfe_u32 v18, v5, 1, 3
    v_xor_b32 v18, v18, v6
    v_lshlrev_b32 v18, 4, v18
    v_lshlrev_b32 v19, 7, v5
    s_lshl_b32 s71, s65, 12
    v_add3_u32 v12, v18, v19, s71
    v_xor_b32 v13, 32, v12
    v_xor_b32 v14, 64, v12
    v_xor_b32 v15, 96, v12
    v_bfe_u32 v18, v1, 2, 2
    v_lshl_add_u32 v19, v6, 3, v18
    v_lshlrev_b32 v19, 7, v19
    v_lshrrev_b32 v18, 1, v18
    v_xor_b32 v18, s66, v18
    v_lshl_add_u32 v19, v18, 6, v19
    v_bfe_u32 v18, v1, 4, 1
    v_lshl_add_u32 v19, v18, 5, v19
    v_and_b32 v18, 3, v1
    v_lshl_add_u32 v16, v18, 3, v19
    v_mov_b32 v26, 0xbdd2d3e8
    s_lshl_b32 s71, s66, 21
    s_add_u32 s71, s71, 0x200000
    s_lshl_b32 s72, s16, 16
    s_add_u32 s71, s71, s72
    s_bfe_u32 s72, s64, 0x10001
    s_lshl_b32 s72, s72, 15
    s_add_u32 s71, s71, s72
    s_and_b32 s72, s64, 1
    s_lshl_b32 s72, s72, 10
    s_add_u32 s71, s71, s72
    v_add_u32 v29, s71, v2
    s_add_u32 s91, s82, 65536
    s_mov_b32 s95, 0
    s_lshl_b32 s71, s78, 11
    s_lshl_b32 s72, s66, 17
    s_add_u32 s71, s71, s72
    s_lshl_b32 s72, s81, 10
    s_add_u32 s92, s71, s72
    s_add_u32 s93, s92, 65536
    v_mov_b32 v56, -1
    v_mov_b32 v57, -1
    v_mov_b32 v58, -1
    v_mov_b32 v59, -1
    s_or_b32 s71, s2, s64
    s_cmp_lg_u32 s71, 0
    s_cbranch_scc1 FK_NOGEN2
    s_waitcnt vmcnt(12)
    v_readfirstlane_b32 s71, v30
    s_nop 0
    s_mul_i32 s71, s71, 1664525
    s_add_u32 s71, s71, 1013904223
    s_cmp_eq_u32 s71, 0
    s_cselect_b32 s71, 1013904223, s71
    v_mov_b32 v30, s71
    v_mov_b32 v5, 0
    s_mov_b64 exec, 1
    buffer_store_dword v30, v5, s[56:59], 0 offen sc1
    buffer_store_dword v30, v31, s[52:55], 0 offen sc1
    s_mov_b64 exec, -1
FK_NOGEN2:
    s_cmp_eq_u32 s23, 0
    s_cbranch_scc1 FK_G0Z
    s_cmp_lt_u32 s68, 12
    s_cbranch_scc1 FK_G0N
    s_waitcnt vmcnt(8) lgkmcnt(0)
    s_barrier
    ds_read_b128 v[128:131], v12 offset:0
    ds_read_b64_tr_b16 v[32:33], v16 offset:16384
    ds_read_b64_tr_b16 v[34:35], v16 offset:16896
    ds_read_b64_tr_b16 v[44:45], v16 offset:24576
    ds_read_b64_tr_b16 v[46:47], v16 offset:25088
    s_add_u32 s80, s75, s3
    s_mul_i32 s88, s3, s77
    s_add_u32 m0, s83, 0x18000
    s_nop 0
    buffer_load_dwordx4 v8, s[40:43], s80 offen lds
    ds_read_b128 v[132:135], v13 offset:0
    ds_read_b64_tr_b16 v[36:37], v16 offset:18432
    ds_read_b64_tr_b16 v[38:39], v16 offset:18944
    ds_read_b64_tr_b16 v[48:49], v16 offset:26624
    ds_read_b64_tr_b16 v[50:51], v16 offset:27136
    s_add_u32 s88, s88, s76
    s_add_u32 m0, s82, 0x1c000
    s_nop 0
    buffer_load_dwordx4 v10, s[44:47], s88 offen lds
    ds_read_b128 v[136:139], v14 offset:0
    ds_read_b64_tr_b16 v[40:41], v16 offset:20480
    ds_read_b64_tr_b16 v[42:43], v16 offset:20992
    ds_read_b64_tr_b16 v[52:53], v16 offset:28672
    ds_read_b64_tr_b16 v[54:55], v16 offset:29184
    s_waitcnt lgkmcnt(12)
    v_mfma_f32_32x32x16_bf16 v[64:79], v[128:131], v[32:35], 0
    s_waitcnt lgkmcnt(10)
    v_mfma_f32_32x32x16_bf16 v[80:95], v[128:131], v[44:47], 0
    s_add_u32 m0, s83, 0x18400
    s_nop 0
    buffer_load_dwordx4 v9, s[40:43], s80 offen lds
    ds_read_b128 v[140:143], v15 offset:0
    ds_read_b64_tr_b16 v[32:33], v16 offset:22528
    ds_read_b64_tr_b16 v[34:35], v16 offset:23040
    ds_read_b64_tr_b16 v[44:45], v16 offset:30720
    ds_read_b64_tr_b16 v[46:47], v16 offset:31232
    s_waitcnt lgkmcnt(12)
    v_mfma_f32_32x32x16_bf16 v[64:79], v[132:135], v[36:39], v[64:79]
    s_waitcnt lgkmcnt(10)
    v_mfma_f32_32x32x16_bf16 v[80:95], v[132:135], v[48:51], v[80:95]
    s_add_u32 m0, s82, 0x1df80
    s_nop 0
    buffer_load_dwordx4 v10, s[44:47], s88 offen offset:128 lds
    s_add_u32 s3, s3, 128
    s_and_b32 s3, s3, 1023
    s_waitcnt vmcnt(8) lgkmcnt(0)
    s_barrier
    ds_read_b128 v[144:147], v12 offset:32768
    ds_read_b64_tr_b16 v[36:37], v16 offset:49152
    ds_read_b64_tr_b16 v[38:39], v16 offset:49664
    ds_read_b64_tr_b16 v[48:49], v16 offset:57344
    ds_read_b64_tr_b16 v[50:51], v16 offset:57856
    v_mfma_f32_32x32x16_bf16 v[64:79], v[136:139], v[40:43], v[64:79]
    v_mfma_f32_32x32x16_bf16 v[80:95], v[136:139], v[52:55], v[80:95]
    s_add_u32 s80, s75, s3
    s_mul_i32 s88, s3, s77
    s_add_u32 m0, s83, 0x20000
    s_nop 0
    buffer_load_dwordx4 v8, s[40:43], s80 offen lds
    ds_read_b128 v[148:151], v13 offset:32768
    ds_read_b64_tr_b16 v[40:41], v16 offset:51200
    ds_read_b64_tr_b16 v[42:43], v16 offset:51712
    ds_read_b64_tr_b16 v[52:53], v16 offset:59392
    ds_read_b64_tr_b16 v[54:55], v16 offset:59904
    v_mfma_f32_32x32x16_bf16 v[64:79], v[140:143], v[32:35], v[64:79]
    v_mfma_f32_32x32x16_bf16 v[80:95], v[140:143], v[44:47], v[80:95]
    s_add_u32 s88, s88, s76
    s_add_u32 m0, s82, 0x24000
    s_nop 0
    buffer_load_dwordx4 v10, s[44:47], s88 offen lds
    ds_read_b128 v[152:155], v14 offset:32768
    ds_read_b64_tr_b16 v[32:33], v16 offset:53248
    ds_read_b64_tr_b16 v[34:35], v16 offset:53760
    ds_read_b64_tr_b16 v[44:45], v16 offset:61440
    ds_read_b64_tr_b16 v[46:47], v16 offset:61952
    s_waitcnt lgkmcnt(12)
    v_mfma_f32_32x32x16_bf16 v[64:79], v[144:147], v[36:39], v[64:79]
    s_waitcnt lgkmcnt(10)
    v_mfma_f32_32x32x16_bf16 v[80:95], v[144:147], v[48:51], v[80:95]
    s_add_u32 m0, s83, 0x20400
    s_nop 0
    buffer_load_dwordx4 v9, s[40:43], s80 offen lds
    ds_read_b128 v[156:159], v15 offset:32768
    ds_read_b64_tr_b16 v[36:37], v16 offset:55296
    ds_read_b64_tr_b16 v[38:39], v16 offset:55808
    ds_read_b64_tr_b16 v[48:49], v16 offset:63488
    ds_read_b64_tr_b16 v[50:51], v16 offset:64000
    s_waitcnt lgkmcnt(12)
    v_mfma_f32_32x32x16_bf16 v[64:79], v[148:151], v[40:43], v[64:79]
    s_waitcnt lgkmcnt(10)
    v_mfma_f32_32x32x16_bf16 v[80:95], v[148:151], v[52:55], v[80:95]
    s_add_u32 m0, s82, 0x25f80
    s_nop 0
    buffer_load_dwordx4 v10, s[44:47], s88 offen offset:128 lds
    s_add_u32 s3, s3, 128
    s_and_b32 s3, s3, 1023
    s_waitcnt vmcnt(8) lgkmcnt(0)
    s_barrier
    v_add_u32 v12, 0x10000, v12
    ds_read_b128 v[160:163], v12 offset:0
    v_add_u32 v16, 0x10000, v16
    ds_read_b64_tr_b16 v[40:41], v16 offset:16384
    ds_read_b64_tr_b16 v[42:43], v16 offset:16896
    ds_read_b64_tr_b16 v[52:53], v16 offset:24576
    ds_read_b64_tr_b16 v[54:55], v16 offset:25088
    v_mfma_f32_32x32x16_bf16 v[64:79], v[152:155], v[32:35], v[64:79]
    v_mfma_f32_32x32x16_bf16 v[80:95], v[152:155], v[44:47], v[80:95]
    s_add_u32 s80, s75, s3
    s_mul_i32 s88, s3, s77
    s_add_u32 m0, s83, 0x0
    s_nop 0
    buffer_load_dwordx4 v8, s[40:43], s80 offen lds
    v_add_u32 v13, 0x10000, v13
    ds_read_b128 v[164:167], v13 offset:0
    ds_read_b64_tr_b16 v[32:33], v16 offset:18432
    ds_read_b64_tr_b16 v[34:35], v16 offset:18944
    ds_read_b64_tr_b16 v[44:45], v16 offset:26624
    ds_read_b64_tr_b16 v[46:47], v16 offset:27136
    v_mfma_f32_32x32x16_bf16 v[64:79], v[156:159], v[36:39], v[64:79]
    v_mfma_f32_32x32x16_bf16 v[80:95], v[156:159], v[48:51], v[80:95]
    s_add_u32 s88, s88, s76
    s_add_u32 m0, s82, 0x4000
    s_nop 0
    buffer_load_dwordx4 v10, s[44:47], s88 offen lds
    v_add_u32 v14, 0x10000, v14
    ds_read_b128 v[168:171], v14 offset:0
    ds_read_b64_tr_b16 v[36:37], v16 offset:20480
    ds_read_b64_tr_b16 v[38:39], v16 offset:20992
    ds_read_b64_tr_b16 v[48:49], v16 offset:28672
    ds_read_b64_tr_b16 v[50:51], v16 offset:29184
    s_waitcnt lgkmcnt(12)
    v_mfma_f32_32x32x16_bf16 v[64:79], v[160:163], v[40:43], v[64:79]
    s_waitcnt lgkmcnt(10)
    v_mfma_f32_32x32x16_bf16 v[80:95], v[160:163], v[52:55], v[80:95]
    s_add_u32 m0, s83, 0x400
    s_nop 0
    buffer_load_dwordx4 v9, s[40:43], s80 offen lds
    v_add_u32 v15, 0x10000, v15
    ds_read_b128 v[172:175], v15 offset:0
    ds_read_b64_tr_b16 v[40:41], v16 offset:22528
    ds_read_b64_tr_b16 v[42:43], v16 offset:23040
    ds_read_b64_tr_b16 v[52:53], v16 offset:30720
    ds_read_b64_tr_b16 v[54:55], v16 offset:31232
    s_waitcnt lgkmcnt(12)
    v_mfma_f32_32x32x16_bf16 v[64:79], v[164:167], v[32:35], v[64:79]
    s_waitcnt lgkmcnt(10)
    v_mfma_f32_32x32x16_bf16 v[80:95], v[164:167], v[44:47], v[80:95]
    s_add_u32 m0, s82, 0x5f80
    s_nop 0
    buffer_load_dwordx4 v10, s[44:47], s88 offen offset:128 lds
    s_add_u32 s3, s3, 128
    s_and_b32 s3, s3, 1023
    s_waitcnt vmcnt(8) lgkmcnt(0)
    s_barrier
    ds_read_b128 v[176:179], v12 offset:32768
    ds_read_b64_tr_b16 v[32:33], v16 offset:49152
    ds_read_b64_tr_b16 v[34:35], v16 offset:49664
    ds_read_b64_tr_b16 v[44:45], v16 offset:57344
    ds_read_b64_tr_b16 v[46:47], v16 offset:57856
    v_mfma_f32_32x32x16_bf16 v[64:79], v[168:171], v[36:39], v[64:79]
    v_mfma_f32_32x32x16_bf16 v[80:95], v[168:171], v[48:51], v[80:95]
    s_add_u32 s80, s75, s3
    s_mul_i32 s88, s3, s77
    s_add_u32 m0, s83, 0x8000
    s_nop 0
    buffer_load_dwordx4 v8, s[40:43], s80 offen lds
    ds_read_b128 v[180:183], v13 offset:32768
    ds_read_b64_tr_b16 v[36:37], v16 offset:51200
    ds_read_b64_tr_b16 v[38:39], v16 offset:51712
    ds_read_b64_tr_b16 v[48:49], v16 offset:59392
    ds_read_b64_tr_b16 v[50:51], v16 offset:59904
    v_mfma_f32_32x32x16_bf16 v[64:79], v[172:175], v[40:43], v[64:79]
    v_mfma_f32_32x32x16_bf16 v[80:95], v[172:175], v[52:55], v[80:95]
    s_add_u32 s88, s88, s76
    s_add_u32 m0, s82, 0xc000
    s_nop 0
    buffer_load_dwordx4 v10, s[44:47], s88 offen lds
    ds_read_b128 v[184:187], v14 offset:32768
    ds_read_b64_tr_b16 v[40:41], v16 offset:53248
    ds_read_b64_tr_b16 v[42:43], v16 offset:53760
    ds_read_b64_tr_b16 v[52:53], v16 offset:61440
    ds_read_b64_tr_b16 v[54:55], v16 offset:61952
    s_waitcnt lgkmcnt(12)
    v_mfma_f32_32x32x16_bf16 v[64:79], v[176:179], v[32:35], v[64:79]
    s_waitcnt lgkmcnt(10)
    v_mfma_f32_32x32x16_bf16 v[80:95], v[176:179], v[44:47], v[80:95]
    s_add_u32 m0, s83, 0x8400
    s_nop 0
    buffer_load_dwordx4 v9, s[40:43], s80 offen lds
    ds_read_b128 v[188:191], v15 offset:32768
    ds_read_b64_tr_b16 v[32:33], v16 offset:55296
    ds_read_b64_tr_b16 v[34:35], v16 offset:55808
    ds_read_b64_tr_b16 v[44:45], v16 offset:63488
    ds_read_b64_tr_b16 v[46:47], v16 offset:64000
    s_waitcnt lgkmcnt(12)
    v_mfma_f32_32x32x16_bf16 v[64:79], v[180:183], v[36:39], v[64:79]
    s_waitcnt lgkmcnt(10)
    v_mfma_f32_32x32x16_bf16 v[80:95], v[180:183], v[48:51], v[80:95]
    s_add_u32 m0, s82, 0xdf80
    s_nop 0
    buffer_load_dwordx4 v10, s[44:47], s88 offen offset:128 lds
    s_add_u32 s3, s3, 128
    s_and_b32 s3, s3, 1023
    s_waitcnt vmcnt(8) lgkmcnt(0)
    s_barrier
    v_add_u32 v12, 0x10000, v12
    ds_read_b128 v[192:195], v12 offset:0
    v_add_u32 v16, 0x10000, v16
    ds_read_b64_tr_b16 v[36:37], v16 offset:16384
    ds_read_b64_tr_b16 v[38:39], v16 offset:16896
    ds_read_b64_tr_b16 v[48:49], v16 offset:24576
    ds_read_b64_tr_b16 v[50:51], v16 offset:25088
    s_cmp_lg_u32 s23, 1
    s_cbranch_scc1 QS_1
    buffer_store_dwordx4 v[56:59], v2, s[52:55], s92 offen sc1
    buffer_store_dwordx4 v[56:59], v2, s[52:55], s93 offen sc1
QS_1:
    v_mfma_f32_32x32x16_bf16 v[64:79], v[184:187], v[40:43], v[64:79]
    v_mfma_f32_32x32x16_bf16 v[80:95], v[184:187], v[52:55], v[80:95]
    s_add_u32 s80, s75, s3
    s_mul_i32 s88, s3, s77
    s_add_u32 m0, s83, 0x10000
    s_nop 0
    buffer_load_dwordx4 v8, s[40:43], s80 offen lds
    v_add_u32 v13, 0x10000, v13
    ds_read_b128 v[196:199], v13 offset:0
    ds_read_b64_tr_b16 v[40:41], v16 offset:18432
    ds_read_b64_tr_b16 v[42:43], v16 offset:18944
    ds_read_b64_tr_b16 v[52:53], v16 offset:26624
    ds_read_b64_tr_b16 v[54:55], v16 offset:27136
    v_mfma_f32_32x32x16_bf16 v[64:79], v[188:191], v[32:35], v[64:79]
    v_mfma_f32_32x32x16_bf16 v[80:95], v[188:191], v[44:47], v[80:95]
    s_add_u32 s88, s88, s76
    s_add_u32 m0, s82, 0x14000
    s_nop 0
    buffer_load_dwordx4 v10, s[44:47], s88 offen lds
    v_add_u32 v14, 0x10000, v14
    ds_read_b128 v[200:203], v14 offset:0
    ds_read_b64_tr_b16 v[32:33], v16 offset:20480
    ds_read_b64_tr_b16 v[34:35], v16 offset:20992
    ds_read_b64_tr_b16 v[44:45], v16 offset:28672
    ds_read_b64_tr_b16 v[46:47], v16 offset:29184
    s_waitcnt lgkmcnt(12)
    v_mfma_f32_32x32x16_bf16 v[64:79], v[192:195], v[36:39], v[64:79]
    s_waitcnt lgkmcnt(10)
    v_mfma_f32_32x32x16_bf16 v[80:95], v[192:195], v[48:51], v[80:95]
    s_add_u32 m0, s83, 0x10400
    s_nop 0
    buffer_load_dwordx4 v9, s[40:43], s80 offen lds
    v_add_u32 v15, 0x10000, v15
    ds_read_b128 v[204:207], v15 offset:0
    ds_read_b64_tr_b16 v[36:37], v16 offset:22528
    ds_read_b64_tr_b16 v[38:39], v16 offset:23040
    ds_read_b64_tr_b16 v[48:49], v16 offset:30720
    ds_read_b64_tr_b16 v[50:51], v16 offset:31232
    s_waitcnt lgkmcnt(12)
    v_mfma_f32_32x32x16_bf16 v[64:79], v[196:199], v[40:43], v[64:79]
    s_waitcnt lgkmcnt(10)
    v_mfma_f32_32x32x16_bf16 v[80:95], v[196:199], v[52:55], v[80:95]
    s_add_u32 m0, s82, 0x15f80
    s_nop 0
    buffer_load_dwordx4 v10, s[44:47], s88 offen offset:128 lds
    s_add_u32 s3, s3, 128
    s_and_b32 s3, s3, 1023
    s_waitcnt vmcnt(8) lgkmcnt(0)
    s_barrier
    v_subrev_u32 v12, 0x20000, v12
    ds_read_b128 v[208:211], v12 offset:0
    v_subrev_u32 v16, 0x20000, v16
    ds_read_b64_tr_b16 v[40:41], v16 offset:16384
    ds_read_b64_tr_b16 v[42:43], v16 offset:16896
    ds_read_b64_tr_b16 v[52:53], v16 offset:24576
    ds_read_b64_tr_b16 v[54:55], v16 offset:25088
    v_mfma_f32_32x32x16_bf16 v[64:79], v[200:203], v[32:35], v[64:79]
    v_mfma_f32_32x32x16_bf16 v[80:95], v[200:203], v[44:47], v[80:95]
    s_mul_i32 s80, s3, s96
    s_add_u32 s80, s80, s78
    s_add_u32 m0, s82, 0x18000
    s_nop 0
    buffer_load_dwordx4 v11, s[48:51], s80 offen lds
    v_subrev_u32 v13, 0x20000, v13
    ds_read_b128 v[212:215], v13 offset:0
    ds_read_b64_tr_b16 v[32:33], v16 offset:18432
    ds_read_b64_tr_b16 v[34:35], v16 offset:18944
    ds_read_b64_tr_b16 v[44:45], v16 offset:26624
    ds_read_b64_tr_b16 v[46:47], v16 offset:27136
    v_mfma_f32_32x32x16_bf16 v[64:79], v[204:207], v[36:39], v[64:79]
    v_mfma_f32_32x32x16_bf16 v[80:95], v[204:207], v[48:51], v[80:95]
    s_add_u32 s3, s3, 128
    s_and_b32 s3, s3, 1023
    s_mul_i32 s80, s3, s96
    s_add_u32 s80, s80, s78
    s_add_u32 m0, s82, 0x1a000
    s_nop 0
    buffer_load_dwordx4 v11, s[48:51], s80 offen lds
    v_subrev_u32 v14, 0x20000, v14
    ds_read_b128 v[216:219], v14 offset:0
    ds_read_b64_tr_b16 v[36:37], v16 offset:20480
    ds_read_b64_tr_b16 v[38:39], v16 offset:20992
    ds_read_b64_tr_b16 v[48:49], v16 offset:28672
    ds_read_b64_tr_b16 v[50:51], v16 offset:29184
    s_waitcnt lgkmcnt(12)
    v_mfma_f32_32x32x16_bf16 v[64:79], v[208:211], v[40:43], v[64:79]
    s_waitcnt lgkmcnt(10)
    v_mfma_f32_32x32x16_bf16 v[80:95], v[208:211], v[52:55], v[80:95]
    s_add_u32 s3, s3, 128
    s_and_b32 s3, s3, 1023
    s_mul_i32 s80, s3, s96
    s_add_u32 s80, s80, s78
    s_add_u32 m0, s82, 0x1c000
    s_nop 0
    buffer_load_dwordx4 v11, s[48:51], s80 offen lds
    v_subrev_u32 v15, 0x20000, v15
    ds_read_b128 v[220:223], v15 offset:0
    ds_read_b64_tr_b16 v[40:41], v16 offset:22528
    ds_read_b64_tr_b16 v[42:43], v16 offset:23040
    ds_read_b64_tr_b16 v[52:53], v16 offset:30720
    ds_read_b64_tr_b16 v[54:55], v16 offset:31232
    s_waitcnt lgkmcnt(12)
    v_mfma_f32_32x32x16_bf16 v[64:79], v[212:215], v[32:35], v[64:79]
    s_waitcnt lgkmcnt(10)
    v_mfma_f32_32x32x16_bf16 v[80:95], v[212:215], v[44:47], v[80:95]
    s_add_u32 s3, s3, 128
    s_and_b32 s3, s3, 1023
    s_mul_i32 s80, s3, s96
    s_add_u32 s80, s80, s78
    s_add_u32 m0, s82, 0x1e000
    s_nop 0
    buffer_load_dwordx4 v11, s[48:51], s80 offen lds
    s_add_u32 s3, s3, 128
    s_and_b32 s3, s3, 1023
    s_waitcnt vmcnt(8) lgkmcnt(0)
    s_barrier
    ds_read_b128 v[224:227], v12 offset:32768
    ds_read_b64_tr_b16 v[32:33], v16 offset:49152
    ds_read_b64_tr_b16 v[34:35], v16 offset:49664
    ds_read_b64_tr_b16 v[44:45], v16 offset:57344
    ds_read_b64_tr_b16 v[46:47], v16 offset:57856
    v_mov_b32 v31, 0
    buffer_load_dword v30, v31, s[56:59], 0 offen sc1
    v_mfma_f32_32x32x16_bf16 v[64:79], v[216:219], v[36:39], v[64:79]
    v_mfma_f32_32x32x16_bf16 v[80:95], v[216:219], v[48:51], v[80:95]
    s_mul_i32 s80, s3, s96
    s_add_u32 s80, s80, s78
    s_add_u32 m0, s82, 0x20000
    s_nop 0
    buffer_load_dwordx4 v11, s[48:51], s80 offen lds
    ds_read_b128 v[228:231], v13 offset:32768
    ds_read_b64_tr_b16 v[36:37], v16 offset:51200
    ds_read_b64_tr_b16 v[38:39], v16 offset:51712
    ds_read_b64_tr_b16 v[48:49], v16 offset:59392
    ds_read_b64_tr_b16 v[50:51], v16 offset:59904
    v_mfma_f32_32x32x16_bf16 v[64:79], v[220:223], v[40:43], v[64:79]
    v_mfma_f32_32x32x16_bf16 v[80:95], v[220:223], v[52:55], v[80:95]
    s_add_u32 s3, s3, 128
    s_and_b32 s3, s3, 1023
    s_mul_i32 s80, s3, s96
    s_add_u32 s80, s80, s78
    s_add_u32 m0, s82, 0x22000
    s_nop 0
    buffer_load_dwordx4 v11, s[48:51], s80 offen lds
    ds_read_b128 v[232:235], v14 offset:32768
    ds_read_b64_tr_b16 v[40:41], v16 offset:53248
    ds_read_b64_tr_b16 v[42:43], v16 offset:53760
    ds_read_b64_tr_b16 v[52:53], v16 offset:61440
    ds_read_b64_tr_b16 v[54:55], v16 offset:61952
    s_waitcnt lgkmcnt(12)
    v_mfma_f32_32x32x16_bf16 v[64:79], v[224:227], v[32:35], v[64:79]
    s_waitcnt lgkmcnt(10)
    v_mfma_f32_32x32x16_bf16 v[80:95], v[224:227], v[44:47], v[80:95]
    s_add_u32 s3, s3, 128
    s_and_b32 s3, s3, 1023
    s_mul_i32 s80, s3, s96
    s_add_u32 s80, s80, s78
    s_add_u32 m0, s82, 0x24000
    s_nop 0
    buffer_load_dwordx4 v11, s[48:51], s80 offen lds
    ds_read_b128 v[236:239], v15 offset:32768
    ds_read_b64_tr_b16 v[32:33], v16 offset:55296
    ds_read_b64_tr_b16 v[34:35], v16 offset:55808
    ds_read_b64_tr_b16 v[44:45], v16 offset:63488
    ds_read_b64_tr_b16 v[46:47], v16 offset:64000
    s_waitcnt lgkmcnt(12)
    v_mfma_f32_32x32x16_bf16 v[64:79], v[228:231], v[36:39], v[64:79]
    s_waitcnt lgkmcnt(10)
    v_mfma_f32_32x32x16_bf16 v[80:95], v[228:231], v[48:51], v[80:95]
    s_add_u32 s3, s3, 128
    s_and_b32 s3, s3, 1023
    s_mul_i32 s80, s3, s96
    s_add_u32 s80, s80, s78
    s_add_u32 m0, s82, 0x26000
    s_nop 0
    buffer_load_dwordx4 v11, s[48:51], s80 offen lds
    s_add_u32 s3, s3, 128
    s_and_b32 s3, s3, 1023
    s_waitcnt vmcnt(9) lgkmcnt(0)
    s_barrier
    v_add_u32 v12, 0x10000, v12
    ds_read_b128 v[240:243], v12 offset:0
    v_add_u32 v16, 0x10000, v16
    ds_read_b64_tr_b16 v[36:37], v16 offset:16384
    ds_read_b64_tr_b16 v[38:39], v16 offset:16896
    ds_read_b64_tr_b16 v[48:49], v16 offset:24576
    ds_read_b64_tr_b16 v[50:51], v16 offset:25088
    v_mfma_f32_32x32x16_bf16 v[64:79], v[232:235], v[40:43], v[64:79]
    v_mfma_f32_32x32x16_bf16 v[80:95], v[232:235], v[52:55], v[80:95]
    s_mul_i32 s80, s3, 1792
    s_add_u32 s80, s80, s79
    s_add_u32 m0, s82, 0x0
    s_nop 0
    buffer_load_dwordx4 v28, s[4:7], s80 offen lds
    v_add_u32 v13, 0x10000, v13
    ds_read_b128 v[244:247], v13 offset:0
    ds_read_b64_tr_b16 v[40:41], v16 offset:18432
    ds_read_b64_tr_b16 v[42:43], v16 offset:18944
    ds_read_b64_tr_b16 v[52:53], v16 offset:26624
    ds_read_b64_tr_b16 v[54:55], v16 offset:27136
    v_mfma_f32_32x32x16_bf16 v[64:79], v[236:239], v[32:35], v[64:79]
    v_mfma_f32_32x32x16_bf16 v[80:95], v[236:239], v[44:47], v[80:95]
    s_add_u32 s3, s3, 128
    s_and_b32 s3, s3, 1023
    s_mul_i32 s80, s3, 1792
    s_add_u32 s80, s80, s79
    s_add_u32 m0, s82, 0x2000
    s_nop 0
    buffer_load_dwordx4 v28, s[4:7], s80 offen lds
    v_add_u32 v14, 0x10000, v14
    ds_read_b128 v[248:251], v14 offset:0
    ds_read_b64_tr_b16 v[32:33], v16 offset:20480
    ds_read_b64_tr_b16 v[34:35], v16 offset:20992
    ds_read_b64_tr_b16 v[44:45], v16 offset:28672
    ds_read_b64_tr_b16 v[46:47], v16 offset:29184
    s_waitcnt lgkmcnt(12)
    v_mfma_f32_32x32x16_bf16 v[64:79], v[240:243], v[36:39], v[64:79]
    s_waitcnt lgkmcnt(10)
    v_mfma_f32_32x32x16_bf16 v[80:95], v[240:243], v[48:51], v[80:95]
    s_add_u32 s3, s3, 128
    s_and_b32 s3, s3, 1023
    s_mul_i32 s80, s3, 1792
    s_add_u32 s80, s80, s79
    s_add_u32 m0, s82, 0x4000
    s_nop 0
    buffer_load_dwordx4 v28, s[4:7], s80 offen lds
    v_add_u32 v15, 0x10000, v15
    ds_read_b128 v[252:255], v15 offset:0
    ds_read_b64_tr_b16 v[36:37], v16 offset:22528
    ds_read_b64_tr_b16 v[38:39], v16 offset:23040
    ds_read_b64_tr_b16 v[48:49], v16 offset:30720
    ds_read_b64_tr_b16 v[50:51], v16 offset:31232
    s_waitcnt lgkmcnt(12)
    v_mfma_f32_32x32x16_bf16 v[64:79], v[244:247], v[40:43], v[64:79]
    s_waitcnt lgkmcnt(10)
    v_mfma_f32_32x32x16_bf16 v[80:95], v[244:247], v[52:55], v[80:95]
    s_add_u32 s3, s3, 128
    s_and_b32 s3, s3, 1023
    s_mul_i32 s80, s3, 1792
    s_add_u32 s80, s80, s79
    s_add_u32 m0, s82, 0x6000
    s_nop 0
    buffer_load_dwordx4 v28, s[4:7], s80 offen lds
    s_add_u32 s3, s3, 128
    s_and_b32 s3, s3, 1023
    s_waitcnt lgkmcnt(7)
    v_mfma_f32_32x32x16_bf16 v[64:79], v[248:251], v[32:35], v[64:79]
    s_waitcnt lgkmcnt(5)
    v_mfma_f32_32x32x16_bf16 v[80:95], v[248:251], v[44:47], v[80:95]
    s_waitcnt lgkmcnt(2)
    v_mfma_f32_32x32x16_bf16 v[64:79], v[252:255], v[36:39], v[64:79]
    s_waitcnt lgkmcnt(0)
    v_mfma_f32_32x32x16_bf16 v[80:95], v[252:255], v[48:51], v[80:95]
    s_mov_b32 s88, 0
    s_waitcnt vmcnt(8)
    s_branch TG_3
TG_2:
    buffer_load_dword v30, v31, s[56:59], 0 offen sc1
    s_waitcnt vmcnt(0)
TG_3:
    v_readfirstlane_b32 s22, v30
    s_nop 0
    s_cmp_lg_u32 s22, 0
    s_cbranch_scc1 TG_4
    s_sleep 1
    s_add_u32 s88, s88, 1
    s_cmp_lt_u32 s88, 40000
    s_cbranch_scc1 TG_2
TG_4:
    s_waitcnt lgkmcnt(0)
    s_barrier
    ds_read_b64_tr_b16 v[32:33], v16 offset:32768
    v_bfe_u32 v5, v1, 4, 1
    ds_read_b64_tr_b16 v[34:35], v16 offset:33280
    v_lshlrev_b32 v5, 16, v5
    ds_read_b64_tr_b16 v[36:37], v16 offset:34816
    v_lshrrev_b32 v6, 5, v1
    v_lshl_add_u32 v5, v6, 8, v5
    ds_read_b64_tr_b16 v[38:39], v16 offset:35328
    v_and_b32 v6, 15, v1
    ds_read_b64_tr_b16 v[40:41], v16 offset:36864
    v_lshl_add_u32 v17, v6, 4, v5
    s_and_b32 s84, s68, 3
    ds_read_b64_tr_b16 v[42:43], v16 offset:37376
    s_lshl_b32 s84, s84, 2
    ds_read_b64_tr_b16 v[44:45], v16 offset:38912
    s_add_u32 s84, s84, s66
    s_lshl_b32 s84, s84, 17
    ds_read_b64_tr_b16 v[46:47], v16 offset:39424
    s_lshl_b32 s85, s81, 10
    ds_read_b64_tr_b16 v[48:49], v16 offset:40960
    s_add_u32 s84, s84, s85
    s_add_u32 s90, s84, 0x400000
    ds_read_b64_tr_b16 v[50:51], v16 offset:41472
    v_cvt_pk_bf16_f32 v112, v64, v65
    s_waitcnt lgkmcnt(8)
    v_mfma_f32_32x32x16_bf16 v[96:111], v[32:35], v[128:131], 0
    v_cvt_pk_bf16_f32 v113, v66, v67
    v_cvt_pk_bf16_f32 v114, v68, v69
    ds_read_b64_tr_b16 v[52:53], v16 offset:43008
    v_cvt_pk_bf16_f32 v115, v70, v71
    ds_read_b64_tr_b16 v[54:55], v16 offset:43520
    v_cvt_pk_bf16_f32 v116, v72, v73
    s_waitcnt lgkmcnt(8)
    v_mfma_f32_32x32x16_bf16 v[96:111], v[36:39], v[132:135], v[96:111]
    v_cvt_pk_bf16_f32 v117, v74, v75
    v_cvt_pk_bf16_f32 v118, v76, v77
    ds_read_b64_tr_b16 v[32:33], v16 offset:45056
    v_cvt_pk_bf16_f32 v119, v78, v79
    ds_read_b64_tr_b16 v[34:35], v16 offset:45568
    s_add_u32 s87, s90, 0x0
    buffer_store_dwordx4 v[112:115], v17, s[52:55], s87 offen offset:0 sc1
    s_waitcnt lgkmcnt(8)
    v_mfma_f32_32x32x16_bf16 v[96:111], v[40:43], v[136:139], v[96:111]
    buffer_store_dwordx4 v[116:119], v17, s[52:55], s87 offen offset:512 sc1
    ds_read_b64_tr_b16 v[36:37], v16 offset:47104
    v_cvt_pk_bf16_f32 v120, v80, v81
    v_cvt_pk_bf16_f32 v121, v82, v83
    ds_read_b64_tr_b16 v[38:39], v16 offset:47616
    v_cvt_pk_bf16_f32 v122, v84, v85
    s_waitcnt lgkmcnt(8)
    v_mfma_f32_32x32x16_bf16 v[96:111], v[44:47], v[140:143], v[96:111]
    v_cvt_pk_bf16_f32 v123, v86, v87
    v_cvt_pk_bf16_f32 v124, v88, v89
    ds_read_b64_tr_b16 v[40:41], v16 offset:49152
    v_cvt_pk_bf16_f32 v125, v90, v91
    ds_read_b64_tr_b16 v[42:43], v16 offset:49664
    v_cvt_pk_bf16_f32 v126, v92, v93
    v_cvt_pk_bf16_f32 v127, v94, v95
    s_waitcnt lgkmcnt(8)
    v_mfma_f32_32x32x16_bf16 v[96:111], v[48:51], v[144:147], v[96:111]
    s_add_u32 s87, s90, 0x40000
    ds_read_b64_tr_b16 v[44:45], v16 offset:51200
    buffer_store_dwordx4 v[120:123], v17, s[52:55], s87 offen offset:0 sc1
    buffer_store_dwordx4 v[124:127], v17, s[52:55], s87 offen offset:512 sc1
    ds_read_b64_tr_b16 v[46:47], v16 offset:51712
    s_waitcnt lgkmcnt(8)
    v_mfma_f32_32x32x16_bf16 v[96:111], v[52:55], v[148:151], v[96:111]
    ds_read_b64_tr_b16 v[48:49], v16 offset:53248
    ds_read_b64_tr_b16 v[50:51], v16 offset:53760
    s_waitcnt lgkmcnt(8)
    v_mfma_f32_32x32x16_bf16 v[96:111], v[32:35], v[152:155], v[96:111]
    ds_read_b64_tr_b16 v[52:53], v16 offset:55296
    ds_read_b64_tr_b16 v[54:55], v16 offset:55808
    s_waitcnt lgkmcnt(8)
    v_mfma_f32_32x32x16_bf16 v[96:111], v[36:39], v[156:159], v[96:111]
    ds_read_b64_tr_b16 v[32:33], v16 offset:57344
    ds_read_b64_tr_b16 v[34:35], v16 offset:57856
    s_waitcnt lgkmcnt(8)
    v_mfma_f32_32x32x16_bf16 v[96:111], v[40:43], v[160:163], v[96:111]
    ds_read_b64_tr_b16 v[36:37], v16 offset:59392
    ds_read_b64_tr_b16 v[38:39], v16 offset:59904
    s_waitcnt lgkmcnt(8)
    v_mfma_f32_32x32x16_bf16 v[96:111], v[44:47], v[164:167], v[96:111]
    ds_read_b64_tr_b16 v[40:41], v16 offset:61440
    ds_read_b64_tr_b16 v[42:43], v16 offset:61952
    s_waitcnt lgkmcnt(8)
    v_mfma_f32_32x32x16_bf16 v[96:111], v[48:51], v[168:171], v[96:111]
    ds_read_b64_tr_b16 v[44:45], v16 offset:63488
    ds_read_b64_tr_b16 v[46:47], v16 offset:64000
    s_waitcnt lgkmcnt(8)
    v_mfma_f32_32x32x16_bf16 v[96:111], v[52:55], v[172:175], v[96:111]
    s_waitcnt vmcnt(8) lgkmcnt(0)
    s_barrier
    v_add_u32 v16, 0x10000, v16
    ds_read_b64_tr_b16 v[48:49], v16 offset:0
    ds_read_b64_tr_b16 v[50:51], v16 offset:512
    v_mfma_f32_32x32x16_bf16 v[96:111], v[32:35], v[176:179], v[96:111]
    ds_read_b64_tr_b16 v[52:53], v16 offset:2048
    ds_read_b64_tr_b16 v[54:55], v16 offset:2560
    v_mfma_f32_32x32x16_bf16 v[96:111], v[36:39], v[180:183], v[96:111]
    ds_read_b64_tr_b16 v[32:33], v16 offset:4096
    ds_read_b64_tr_b16 v[34:35], v16 offset:4608
    v_mfma_f32_32x32x16_bf16 v[96:111], v[40:43], v[184:187], v[96:111]
    ds_read_b64_tr_b16 v[36:37], v16 offset:6144
    ds_read_b64_tr_b16 v[38:39], v16 offset:6656
    v_mfma_f32_32x32x16_bf16 v[96:111], v[44:47], v[188:191], v[96:111]
    ds_read_b64_tr_b16 v[40:41], v16 offset:8192
    ds_read_b64_tr_b16 v[42:43], v16 offset:8704
    s_waitcnt lgkmcnt(8)
    v_mfma_f32_32x32x16_bf16 v[96:111], v[48:51], v[192:195], v[96:111]
    ds_read_b64_tr_b16 v[44:45], v16 offset:10240
    ds_read_b64_tr_b16 v[46:47], v16 offset:10752
    s_waitcnt lgkmcnt(8)
    v_mfma_f32_32x32x16_bf16 v[96:111], v[52:55], v[196:199], v[96:111]
    ds_read_b64_tr_b16 v[48:49], v16 offset:12288
    ds_read_b64_tr_b16 v[50:51], v16 offset:12800
    s_waitcnt lgkmcnt(8)
    v_mfma_f32_32x32x16_bf16 v[96:111], v[32:35], v[200:203], v[96:111]
    ds_read_b64_tr_b16 v[52:53], v16 offset:14336
    ds_read_b64_tr_b16 v[54:55], v16 offset:14848
    s_waitcnt lgkmcnt(8)
    v_mfma_f32_32x32x16_bf16 v[96:111], v[36:39], v[204:207], v[96:111]
    ds_read_b64_tr_b16 v[32:33], v16 offset:16384
    ds_read_b64_tr_b16 v[34:35], v16 offset:16896
    s_waitcnt lgkmcnt(8)
    v_mfma_f32_32x32x16_bf16 v[96:111], v[40:43], v[208:211], v[96:111]
    s_waitcnt vmcnt(0)
    s_barrier
    s_cmp_lg_u32 s64, 0
    s_cbranch_scc1 FL_5
    v_mov_b32 v5, s22
    s_mov_b64 exec, 0xfff
    buffer_store_dword v5, v3, s[52:55], 0 offen sc1
    s_mov_b64 exec, -1
FL_5:
    ds_read_b64_tr_b16 v[36:37], v16 offset:18432
    ds_read_b64_tr_b16 v[38:39], v16 offset:18944
    s_waitcnt lgkmcnt(8)
    v_mfma_f32_32x32x16_bf16 v[96:111], v[44:47], v[212:215], v[96:111]
    s_mul_i32 s80, s3, 1792
    s_add_u32 s80, s80, s79
    s_add_u32 m0, s82, 0x8000
    s_nop 0
    buffer_load_dwordx4 v28, s[4:7], s80 offen lds
    ds_read_b64_tr_b16 v[40:41], v16 offset:20480
    ds_read_b64_tr_b16 v[42:43], v16 offset:20992
    s_waitcnt lgkmcnt(8)
    v_mfma_f32_32x32x16_bf16 v[96:111], v[48:51], v[216:219], v[96:111]
    s_add_u32 s3, s3, 128
    s_and_b32 s3, s3, 1023
    s_mul_i32 s80, s3, 1792
    s_add_u32 s80, s80, s79
    s_add_u32 m0, s82, 0xa000
    s_nop 0
    buffer_load_dwordx4 v28, s[4:7], s80 offen lds
    ds_read_b64_tr_b16 v[44:45], v16 offset:22528
    ds_read_b64_tr_b16 v[46:47], v16 offset:23040
    s_waitcnt lgkmcnt(8)
    v_mfma_f32_32x32x16_bf16 v[96:111], v[52:55], v[220:223], v[96:111]
    s_add_u32 s3, s3, 128
    s_and_b32 s3, s3, 1023
    s_mul_i32 s80, s3, 1792
    s_add_u32 s80, s80, s79
    s_add_u32 m0, s82, 0xc000
    s_nop 0
    buffer_load_dwordx4 v28, s[4:7], s80 offen lds
    ds_read_b64_tr_b16 v[48:49], v16 offset:24576
    ds_read_b64_tr_b16 v[50:51], v16 offset:25088
    s_waitcnt lgkmcnt(8)
    v_mfma_f32_32x32x16_bf16 v[96:111], v[32:35], v[224:227], v[96:111]
    s_add_u32 s3, s3, 128
    s_and_b32 s3, s3, 1023
    s_mul_i32 s80, s3, 1792
    s_add_u32 s80, s80, s79
    s_add_u32 m0, s82, 0xe000
    s_nop 0
    buffer_load_dwordx4 v28, s[4:7], s80 offen lds
    s_add_u32 s3, s3, 128
    s_and_b32 s3, s3, 1023
    ds_read_b64_tr_b16 v[52:53], v16 offset:26624
    ds_read_b64_tr_b16 v[54:55], v16 offset:27136
    s_waitcnt lgkmcnt(8)
    v_mfma_f32_32x32x16_bf16 v[96:111], v[36:39], v[228:231], v[96:111]
    ds_read_b64_tr_b16 v[32:33], v16 offset:28672
    ds_read_b64_tr_b16 v[34:35], v16 offset:29184
    s_waitcnt lgkmcnt(8)
    v_mfma_f32_32x32x16_bf16 v[96:111], v[40:43], v[232:235], v[96:111]
    ds_read_b64_tr_b16 v[36:37], v16 offset:30720
    ds_read_b64_tr_b16 v[38:39], v16 offset:31232
    s_waitcnt lgkmcnt(8)
    v_mfma_f32_32x32x16_bf16 v[96:111], v[44:47], v[236:239], v[96:111]
    s_waitcnt lgkmcnt(6)
    v_mfma_f32_32x32x16_bf16 v[96:111], v[48:51], v[240:243], v[96:111]
    s_waitcnt lgkmcnt(4)
    v_mfma_f32_32x32x16_bf16 v[96:111], v[52:55], v[244:247], v[96:111]
    s_waitcnt lgkmcnt(2)
    v_mfma_f32_32x32x16_bf16 v[96:111], v[32:35], v[248:251], v[96:111]
    s_waitcnt lgkmcnt(0)
    v_mfma_f32_32x32x16_bf16 v[96:111], v[36:39], v[252:255], v[96:111]
    s_branch FK_R3E
FK_G0N:
    s_waitcnt vmcnt(8) lgkmcnt(0)
    s_barrier
    ds_read_b128 v[128:131], v12 offset:0
    ds_read_b64_tr_b16 v[32:33], v16 offset:16384
    ds_read_b64_tr_b16 v[34:35], v16 offset:16896
    ds_read_b64_tr_b16 v[44:45], v16 offset:24576
    ds_read_b64_tr_b16 v[46:47], v16 offset:25088
    s_add_u32 s80, s75, s3
    s_mul_i32 s88, s3, s77
    s_add_u32 m0, s83, 0x18000
    s_nop 0
    buffer_load_dwordx4 v8, s[40:43], s80 offen lds
    ds_read_b128 v[132:135], v13 offset:0
    ds_read_b64_tr_b16 v[36:37], v16 offset:18432
    ds_read_b64_tr_b16 v[38:39], v16 offset:18944
    ds_read_b64_tr_b16 v[48:49], v16 offset:26624
    ds_read_b64_tr_b16 v[50:51], v16 offset:27136
    s_add_u32 s88, s88, s76
    s_add_u32 m0, s82, 0x1c000
    s_nop 0
    buffer_load_dwordx4 v10, s[44:47], s88 offen lds
    ds_read_b128 v[136:139], v14 offset:0
    ds_read_b64_tr_b16 v[40:41], v16 offset:20480
    ds_read_b64_tr_b16 v[42:43], v16 offset:20992
    ds_read_b64_tr_b16 v[52:53], v16 offset:28672
    ds_read_b64_tr_b16 v[54:55], v16 offset:29184
    s_waitcnt lgkmcnt(12)
    v_mfma_f32_32x32x16_bf16 v[64:79], v[32:35], v[128:131], 0
    s_waitcnt lgkmcnt(10)
    v_mfma_f32_32x32x16_bf16 v[80:95], v[44:47], v[128:131], 0
    s_add_u32 m0, s83, 0x18400
    s_nop 0
    buffer_load_dwordx4 v9, s[40:43], s80 offen lds
    ds_read_b128 v[140:143], v15 offset:0
    ds_read_b64_tr_b16 v[32:33], v16 offset:22528
    ds_read_b64_tr_b16 v[34:35], v16 offset:23040
    ds_read_b64_tr_b16 v[44:45], v16 offset:30720
    ds_read_b64_tr_b16 v[46:47], v16 offset:31232
    s_waitcnt lgkmcnt(12)
    v_mfma_f32_32x32x16_bf16 v[64:79], v[36:39], v[132:135], v[64:79]
    s_waitcnt lgkmcnt(10)
    v_mfma_f32_32x32x16_bf16 v[80:95], v[48:51], v[132:135], v[80:95]
    s_add_u32 m0, s82, 0x1df80
    s_nop 0
    buffer_load_dwordx4 v10, s[44:47], s88 offen offset:128 lds
    s_add_u32 s3, s3, 128
    s_and_b32 s3, s3, 1023
    s_waitcnt vmcnt(8) lgkmcnt(0)
    s_barrier
    ds_read_b128 v[144:147], v12 offset:32768
    ds_read_b64_tr_b16 v[36:37], v16 offset:49152
    ds_read_b64_tr_b16 v[38:39], v16 offset:49664
    ds_read_b64_tr_b16 v[48:49], v16 offset:57344
    ds_read_b64_tr_b16 v[50:51], v16 offset:57856
    v_mfma_f32_32x32x16_bf16 v[64:79], v[40:43], v[136:139], v[64:79]
    v_mfma_f32_32x32x16_bf16 v[80:95], v[52:55], v[136:139], v[80:95]
    s_add_u32 s80, s75, s3
    s_mul_i32 s88, s3, s77
    s_add_u32 m0, s83, 0x20000
    s_nop 0
    buffer_load_dwordx4 v8, s[40:43], s80 offen lds
    ds_read_b128 v[148:151], v13 offset:32768
    ds_read_b64_tr_b16 v[40:41], v16 offset:51200
    ds_read_b64_tr_b16 v[42:43], v16 offset:51712
    ds_read_b64_tr_b16 v[52:53], v16 offset:59392
    ds_read_b64_tr_b16 v[54:55], v16 offset:59904
    v_mfma_f32_32x32x16_bf16 v[64:79], v[32:35], v[140:143], v[64:79]
    v_mfma_f32_32x32x16_bf16 v[80:95], v[44:47], v[140:143], v[80:95]
    s_add_u32 s88, s88, s76
    s_add_u32 m0, s82, 0x24000
    s_nop 0
    buffer_load_dwordx4 v10, s[44:47], s88 offen lds
    ds_read_b128 v[152:155], v14 offset:32768
    ds_read_b64_tr_b16 v[32:33], v16 offset:53248
    ds_read_b64_tr_b16 v[34:35], v16 offset:53760
    ds_read_b64_tr_b16 v[44:45], v16 offset:61440
    ds_read_b64_tr_b16 v[46:47], v16 offset:61952
    s_waitcnt lgkmcnt(12)
    v_mfma_f32_32x32x16_bf16 v[64:79], v[36:39], v[144:147], v[64:79]
    s_waitcnt lgkmcnt(10)
    v_mfma_f32_32x32x16_bf16 v[80:95], v[48:51], v[144:147], v[80:95]
    s_add_u32 m0, s83, 0x20400
    s_nop 0
    buffer_load_dwordx4 v9, s[40:43], s80 offen lds
    ds_read_b128 v[156:159], v15 offset:32768
    ds_read_b64_tr_b16 v[36:37], v16 offset:55296
    ds_read_b64_tr_b16 v[38:39], v16 offset:55808
    ds_read_b64_tr_b16 v[48:49], v16 offset:63488
    ds_read_b64_tr_b16 v[50:51], v16 offset:64000
    s_waitcnt lgkmcnt(12)
    v_mfma_f32_32x32x16_bf16 v[64:79], v[40:43], v[148:151], v[64:79]
    s_waitcnt lgkmcnt(10)
    v_mfma_f32_32x32x16_bf16 v[80:95], v[52:55], v[148:151], v[80:95]
    s_add_u32 m0, s82, 0x25f80
    s_nop 0
    buffer_load_dwordx4 v10, s[44:47], s88 offen offset:128 lds
    s_add_u32 s3, s3, 128
    s_and_b32 s3, s3, 1023
    s_waitcnt vmcnt(8) lgkmcnt(0)
    s_barrier
    v_add_u32 v12, 0x10000, v12
    ds_read_b128 v[160:163], v12 offset:0
    v_add_u32 v16, 0x10000, v16
    ds_read_b64_tr_b16 v[40:41], v16 offset:16384
    ds_read_b64_tr_b16 v[42:43], v16 offset:16896
    ds_read_b64_tr_b16 v[52:53], v16 offset:24576
    ds_read_b64_tr_b16 v[54:55], v16 offset:25088
    v_mfma_f32_32x32x16_bf16 v[64:79], v[32:35], v[152:155], v[64:79]
    v_mfma_f32_32x32x16_bf16 v[80:95], v[44:47], v[152:155], v[80:95]
    s_add_u32 s80, s75, s3
    s_mul_i32 s88, s3, s77
    s_add_u32 m0, s83, 0x0
    s_nop 0
    buffer_load_dwordx4 v8, s[40:43], s80 offen lds
    v_add_u32 v13, 0x10000, v13
    ds_read_b128 v[164:167], v13 offset:0
    ds_read_b64_tr_b16 v[32:33], v16 offset:18432
    ds_read_b64_tr_b16 v[34:35], v16 offset:18944
    ds_read_b64_tr_b16 v[44:45], v16 offset:26624
    ds_read_b64_tr_b16 v[46:47], v16 offset:27136
    v_mfma_f32_32x32x16_bf16 v[64:79], v[36:39], v[156:159], v[64:79]
    v_mfma_f32_32x32x16_bf16 v[80:95], v[48:51], v[156:159], v[80:95]
    s_add_u32 s88, s88, s76
    s_add_u32 m0, s82, 0x4000
    s_nop 0
    buffer_load_dwordx4 v10, s[44:47], s88 offen lds
    v_add_u32 v14, 0x10000, v14
    ds_read_b128 v[168:171], v14 offset:0
    ds_read_b64_tr_b16 v[36:37], v16 offset:20480
    ds_read_b64_tr_b16 v[38:39], v16 offset:20992
    ds_read_b64_tr_b16 v[48:49], v16 offset:28672
    ds_read_b64_tr_b16 v[50:51], v16 offset:29184
    s_waitcnt lgkmcnt(12)
    v_mfma_f32_32x32x16_bf16 v[64:79], v[40:43], v[160:163], v[64:79]
    s_waitcnt lgkmcnt(10)
    v_mfma_f32_32x32x16_bf16 v[80:95], v[52:55], v[160:163], v[80:95]
    s_add_u32 m0, s83, 0x400
    s_nop 0
    buffer_load_dwordx4 v9, s[40:43], s80 offen lds
    v_add_u32 v15, 0x10000, v15
    ds_read_b128 v[172:175], v15 offset:0
    ds_read_b64_tr_b16 v[40:41], v16 offset:22528
    ds_read_b64_tr_b16 v[42:43], v16 offset:23040
    ds_read_b64_tr_b16 v[52:53], v16 offset:30720
    ds_read_b64_tr_b16 v[54:55], v16 offset:31232
    s_waitcnt lgkmcnt(12)
    v_mfma_f32_32x32x16_bf16 v[64:79], v[32:35], v[164:167], v[64:79]
    s_waitcnt lgkmcnt(10)
    v_mfma_f32_32x32x16_bf16 v[80:95], v[44:47], v[164:167], v[80:95]
    s_add_u32 m0, s82, 0x5f80
    s_nop 0
    buffer_load_dwordx4 v10, s[44:47], s88 offen offset:128 lds
    s_add_u32 s3, s3, 128
    s_and_b32 s3, s3, 1023
    s_waitcnt vmcnt(8) lgkmcnt(0)
    s_barrier
    ds_read_b128 v[176:179], v12 offset:32768
    ds_read_b64_tr_b16 v[32:33], v16 offset:49152
    ds_read_b64_tr_b16 v[34:35], v16 offset:49664
    ds_read_b64_tr_b16 v[44:45], v16 offset:57344
    ds_read_b64_tr_b16 v[46:47], v16 offset:57856
    v_mfma_f32_32x32x16_bf16 v[64:79], v[36:39], v[168:171], v[64:79]
    v_mfma_f32_32x32x16_bf16 v[80:95], v[48:51], v[168:171], v[80:95]
    s_add_u32 s80, s75, s3
    s_mul_i32 s88, s3, s77
    s_add_u32 m0, s83, 0x8000
    s_nop 0
    buffer_load_dwordx4 v8, s[40:43], s80 offen lds
    ds_read_b128 v[180:183], v13 offset:32768
    ds_read_b64_tr_b16 v[36:37], v16 offset:51200
    ds_read_b64_tr_b16 v[38:39], v16 offset:51712
    ds_read_b64_tr_b16 v[48:49], v16 offset:59392
    ds_read_b64_tr_b16 v[50:51], v16 offset:59904
    v_mfma_f32_32x32x16_bf16 v[64:79], v[40:43], v[172:175], v[64:79]
    v_mfma_f32_32x32x16_bf16 v[80:95], v[52:55], v[172:175], v[80:95]
    s_add_u32 s88, s88, s76
    s_add_u32 m0, s82, 0xc000
    s_nop 0
    buffer_load_dwordx4 v10, s[44:47], s88 offen lds
    ds_read_b128 v[184:187], v14 offset:32768
    ds_read_b64_tr_b16 v[40:41], v16 offset:53248
    ds_read_b64_tr_b16 v[42:43], v16 offset:53760
    ds_read_b64_tr_b16 v[52:53], v16 offset:61440
    ds_read_b64_tr_b16 v[54:55], v16 offset:61952
    s_waitcnt lgkmcnt(12)
    v_mfma_f32_32x32x16_bf16 v[64:79], v[32:35], v[176:179], v[64:79]
    s_waitcnt lgkmcnt(10)
    v_mfma_f32_32x32x16_bf16 v[80:95], v[44:47], v[176:179], v[80:95]
    s_add_u32 m0, s83, 0x8400
    s_nop 0
    buffer_load_dwordx4 v9, s[40:43], s80 offen lds
    ds_read_b128 v[188:191], v15 offset:32768
    ds_read_b64_tr_b16 v[32:33], v16 offset:55296
    ds_read_b64_tr_b16 v[34:35], v16 offset:55808
    ds_read_b64_tr_b16 v[44:45], v16 offset:63488
    ds_read_b64_tr_b16 v[46:47], v16 offset:64000
    s_waitcnt lgkmcnt(12)
    v_mfma_f32_32x32x16_bf16 v[64:79], v[36:39], v[180:183], v[64:79]
    s_waitcnt lgkmcnt(10)
    v_mfma_f32_32x32x16_bf16 v[80:95], v[48:51], v[180:183], v[80:95]
    s_add_u32 m0, s82, 0xdf80
    s_nop 0
    buffer_load_dwordx4 v10, s[44:47], s88 offen offset:128 lds
    s_add_u32 s3, s3, 128
    s_and_b32 s3, s3, 1023
    s_waitcnt vmcnt(8) lgkmcnt(0)
    s_barrier
    v_add_u32 v12, 0x10000, v12
    ds_read_b128 v[192:195], v12 offset:0
    v_add_u32 v16, 0x10000, v16
    ds_read_b64_tr_b16 v[36:37], v16 offset:16384
    ds_read_b64_tr_b16 v[38:39], v16 offset:16896
    ds_read_b64_tr_b16 v[48:49], v16 offset:24576
    ds_read_b64_tr_b16 v[50:51], v16 offset:25088
    s_cmp_lg_u32 s23, 1
    s_cbranch_scc1 QS_6
    buffer_store_dwordx4 v[56:59], v2, s[52:55], s92 offen sc1
    buffer_store_dwordx4 v[56:59], v2, s[52:55], s93 offen sc1
QS_6:
    v_mfma_f32_32x32x16_bf16 v[64:79], v[40:43], v[184:187], v[64:79]
    v_mfma_f32_32x32x16_bf16 v[80:95], v[52:55], v[184:187], v[80:95]
    s_add_u32 s80, s75, s3
    s_mul_i32 s88, s3, s77
    s_add_u32 m0, s83, 0x10000
    s_nop 0
    buffer_load_dwordx4 v8, s[40:43], s80 offen lds
    v_add_u32 v13, 0x10000, v13
    ds_read_b128 v[196:199], v13 offset:0
    ds_read_b64_tr_b16 v[40:41], v16 offset:18432
    ds_read_b64_tr_b16 v[42:43], v16 offset:18944
    ds_read_b64_tr_b16 v[52:53], v16 offset:26624
    ds_read_b64_tr_b16 v[54:55], v16 offset:27136
    v_mfma_f32_32x32x16_bf16 v[64:79], v[32:35], v[188:191], v[64:79]
    v_mfma_f32_32x32x16_bf16 v[80:95], v[44:47], v[188:191], v[80:95]
    s_add_u32 s88, s88, s76
    s_add_u32 m0, s82, 0x14000
    s_nop 0
    buffer_load_dwordx4 v10, s[44:47], s88 offen lds
    v_add_u32 v14, 0x10000, v14
    ds_read_b128 v[200:203], v14 offset:0
    ds_read_b64_tr_b16 v[32:33], v16 offset:20480
    ds_read_b64_tr_b16 v[34:35], v16 offset:20992
    ds_read_b64_tr_b16 v[44:45], v16 offset:28672
    ds_read_b64_tr_b16 v[46:47], v16 offset:29184
    s_waitcnt lgkmcnt(12)
    v_mfma_f32_32x32x16_bf16 v[64:79], v[36:39], v[192:195], v[64:79]
    s_waitcnt lgkmcnt(10)
    v_mfma_f32_32x32x16_bf16 v[80:95], v[48:51], v[192:195], v[80:95]
    s_add_u32 m0, s83, 0x10400
    s_nop 0
    buffer_load_dwordx4 v9, s[40:43], s80 offen lds
    v_add_u32 v15, 0x10000, v15
    ds_read_b128 v[204:207], v15 offset:0
    ds_read_b64_tr_b16 v[36:37], v16 offset:22528
    ds_read_b64_tr_b16 v[38:39], v16 offset:23040
    ds_read_b64_tr_b16 v[48:49], v16 offset:30720
    ds_read_b64_tr_b16 v[50:51], v16 offset:31232
    s_waitcnt lgkmcnt(12)
    v_mfma_f32_32x32x16_bf16 v[64:79], v[40:43], v[196:199], v[64:79]
    s_waitcnt lgkmcnt(10)
    v_mfma_f32_32x32x16_bf16 v[80:95], v[52:55], v[196:199], v[80:95]
    s_add_u32 m0, s82, 0x15f80
    s_nop 0
    buffer_load_dwordx4 v10, s[44:47], s88 offen offset:128 lds
    s_add_u32 s3, s3, 128
    s_and_b32 s3, s3, 1023
    s_waitcnt vmcnt(8) lgkmcnt(0)
    s_barrier
    v_subrev_u32 v12, 0x20000, v12
    ds_read_b128 v[208:211], v12 offset:0
    v_subrev_u32 v16, 0x20000, v16
    ds_read_b64_tr_b16 v[40:41], v16 offset:16384
    ds_read_b64_tr_b16 v[42:43], v16 offset:16896
    ds_read_b64_tr_b16 v[52:53], v16 offset:24576
    ds_read_b64_tr_b16 v[54:55], v16 offset:25088
    v_mfma_f32_32x32x16_bf16 v[64:79], v[32:35], v[200:203], v[64:79]
    v_mfma_f32_32x32x16_bf16 v[80:95], v[44:47], v[200:203], v[80:95]
    s_mul_i32 s80, s3, s96
    s_add_u32 s80, s80, s78
    s_add_u32 m0, s82, 0x18000
    s_nop 0
    buffer_load_dwordx4 v11, s[48:51], s80 offen lds
    v_subrev_u32 v13, 0x20000, v13
    ds_read_b128 v[212:215], v13 offset:0
    ds_read_b64_tr_b16 v[32:33], v16 offset:18432
    ds_read_b64_tr_b16 v[34:35], v16 offset:18944
    ds_read_b64_tr_b16 v[44:45], v16 offset:26624
    ds_read_b64_tr_b16 v[46:47], v16 offset:27136
    v_mfma_f32_32x32x16_bf16 v[64:79], v[36:39], v[204:207], v[64:79]
    v_mfma_f32_32x32x16_bf16 v[80:95], v[48:51], v[204:207], v[80:95]
    s_add_u32 s3, s3, 128
    s_and_b32 s3, s3, 1023
    s_mul_i32 s80, s3, s96
    s_add_u32 s80, s80, s78
    s_add_u32 m0, s82, 0x1a000
    s_nop 0
    buffer_load_dwordx4 v11, s[48:51], s80 offen lds
    v_subrev_u32 v14, 0x20000, v14
    ds_read_b128 v[216:219], v14 offset:0
    ds_read_b64_tr_b16 v[36:37], v16 offset:20480
    ds_read_b64_tr_b16 v[38:39], v16 offset:20992
    ds_read_b64_tr_b16 v[48:49], v16 offset:28672
    ds_read_b64_tr_b16 v[50:51], v16 offset:29184
    s_waitcnt lgkmcnt(12)
    v_mfma_f32_32x32x16_bf16 v[64:79], v[40:43], v[208:211], v[64:79]
    s_waitcnt lgkmcnt(10)
    v_mfma_f32_32x32x16_bf16 v[80:95], v[52:55], v[208:211], v[80:95]
    s_add_u32 s3, s3, 128
    s_and_b32 s3, s3, 1023
    s_mul_i32 s80, s3, s96
    s_add_u32 s80, s80, s78
    s_add_u32 m0, s82, 0x1c000
    s_nop 0
    buffer_load_dwordx4 v11, s[48:51], s80 offen lds
    v_subrev_u32 v15, 0x20000, v15
    ds_read_b128 v[220:223], v15 offset:0
    ds_read_b64_tr_b16 v[40:41], v16 offset:22528
    ds_read_b64_tr_b16 v[42:43], v16 offset:23040
    ds_read_b64_tr_b16 v[52:53], v16 offset:30720
    ds_read_b64_tr_b16 v[54:55], v16 offset:31232
    s_waitcnt lgkmcnt(12)
    v_mfma_f32_32x32x16_bf16 v[64:79], v[32:35], v[212:215], v[64:79]
    s_waitcnt lgkmcnt(10)
    v_mfma_f32_32x32x16_bf16 v[80:95], v[44:47], v[212:215], v[80:95]
    s_add_u32 s3, s3, 128
    s_and_b32 s3, s3, 1023
    s_mul_i32 s80, s3, s96
    s_add_u32 s80, s80, s78
    s_add_u32 m0, s82, 0x1e000
    s_nop 0
    buffer_load_dwordx4 v11, s[48:51], s80 offen lds
    s_add_u32 s3, s3, 128
    s_and_b32 s3, s3, 1023
    s_waitcnt vmcnt(8) lgkmcnt(0)
    s_barrier
    ds_read_b128 v[224:227], v12 offset:32768
    ds_read_b64_tr_b16 v[32:33], v16 offset:49152
    ds_read_b64_tr_b16 v[34:35], v16 offset:49664
    ds_read_b64_tr_b16 v[44:45], v16 offset:57344
    ds_read_b64_tr_b16 v[46:47], v16 offset:57856
    v_mov_b32 v31, 0
    buffer_load_dword v30, v31, s[56:59], 0 offen sc1
    v_mfma_f32_32x32x16_bf16 v[64:79], v[36:39], v[216:219], v[64:79]
    v_mfma_f32_32x32x16_bf16 v[80:95], v[48:51], v[216:219], v[80:95]
    s_mul_i32 s80, s3, s96
    s_add_u32 s80, s80, s78
    s_add_u32 m0, s82, 0x20000
    s_nop 0
    buffer_load_dwordx4 v11, s[48:51], s80 offen lds
    ds_read_b128 v[228:231], v13 offset:32768
    ds_read_b64_tr_b16 v[36:37], v16 offset:51200
    ds_read_b64_tr_b16 v[38:39], v16 offset:51712
    ds_read_b64_tr_b16 v[48:49], v16 offset:59392
    ds_read_b64_tr_b16 v[50:51], v16 offset:59904
    v_mfma_f32_32x32x16_bf16 v[64:79], v[40:43], v[220:223], v[64:79]
    v_mfma_f32_32x32x16_bf16 v[80:95], v[52:55], v[220:223], v[80:95]
    s_add_u32 s3, s3, 128
    s_and_b32 s3, s3, 1023
    s_mul_i32 s80, s3, s96
    s_add_u32 s80, s80, s78
    s_add_u32 m0, s82, 0x22000
    s_nop 0
    buffer_load_dwordx4 v11, s[48:51], s80 offen lds
    ds_read_b128 v[232:235], v14 offset:32768
    ds_read_b64_tr_b16 v[40:41], v16 offset:53248
    ds_read_b64_tr_b16 v[42:43], v16 offset:53760
    ds_read_b64_tr_b16 v[52:53], v16 offset:61440
    ds_read_b64_tr_b16 v[54:55], v16 offset:61952
    s_waitcnt lgkmcnt(12)
    v_mfma_f32_32x32x16_bf16 v[64:79], v[32:35], v[224:227], v[64:79]
    s_waitcnt lgkmcnt(10)
    v_mfma_f32_32x32x16_bf16 v[80:95], v[44:47], v[224:227], v[80:95]
    s_add_u32 s3, s3, 128
    s_and_b32 s3, s3, 1023
    s_mul_i32 s80, s3, s96
    s_add_u32 s80, s80, s78
    s_add_u32 m0, s82, 0x24000
    s_nop 0
    buffer_load_dwordx4 v11, s[48:51], s80 offen lds
    ds_read_b128 v[236:239], v15 offset:32768
    ds_read_b64_tr_b16 v[32:33], v16 offset:55296
    ds_read_b64_tr_b16 v[34:35], v16 offset:55808
    ds_read_b64_tr_b16 v[44:45], v16 offset:63488
    ds_read_b64_tr_b16 v[46:47], v16 offset:64000
    s_waitcnt lgkmcnt(12)
    v_mfma_f32_32x32x16_bf16 v[64:79], v[36:39], v[228:231], v[64:79]
    s_waitcnt lgkmcnt(10)
    v_mfma_f32_32x32x16_bf16 v[80:95], v[48:51], v[228:231], v[80:95]
    s_add_u32 s3, s3, 128
    s_and_b32 s3, s3, 1023
    s_mul_i32 s80, s3, s96
    s_add_u32 s80, s80, s78
    s_add_u32 m0, s82, 0x26000
    s_nop 0
    buffer_load_dwordx4 v11, s[48:51], s80 offen lds
    s_add_u32 s3, s3, 128
    s_and_b32 s3, s3, 1023
    s_waitcnt vmcnt(9) lgkmcnt(0)
    s_barrier
    v_add_u32 v12, 0x10000, v12
    ds_read_b128 v[240:243], v12 offset:0
    v_add_u32 v16, 0x10000, v16
    ds_read_b64_tr_b16 v[36:37], v16 offset:16384
    ds_read_b64_tr_b16 v[38:39], v16 offset:16896
    ds_read_b64_tr_b16 v[48:49], v16 offset:24576
    ds_read_b64_tr_b16 v[50:51], v16 offset:25088
    v_mfma_f32_32x32x16_bf16 v[64:79], v[40:43], v[232:235], v[64:79]
    v_mfma_f32_32x32x16_bf16 v[80:95], v[52:55], v[232:235], v[80:95]
    s_mul_i32 s80, s3, 1792
    s_add_u32 s80, s80, s79
    s_add_u32 m0, s82, 0x0
    s_nop 0
    buffer_load_dwordx4 v28, s[4:7], s80 offen lds
    v_add_u32 v13, 0x10000, v13
    ds_read_b128 v[244:247], v13 offset:0
    ds_read_b64_tr_b16 v[40:41], v16 offset:18432
    ds_read_b64_tr_b16 v[42:43], v16 offset:18944
    ds_read_b64_tr_b16 v[52:53], v16 offset:26624
    ds_read_b64_tr_b16 v[54:55], v16 offset:27136
    v_mfma_f32_32x32x16_bf16 v[64:79], v[32:35], v[236:239], v[64:79]
    v_mfma_f32_32x32x16_bf16 v[80:95], v[44:47], v[236:239], v[80:95]
    s_add_u32 s3, s3, 128
    s_and_b32 s3, s3, 1023
    s_mul_i32 s80, s3, 1792
    s_add_u32 s80, s80, s79
    s_add_u32 m0, s82, 0x2000
    s_nop 0
    buffer_load_dwordx4 v28, s[4:7], s80 offen lds
    v_add_u32 v14, 0x10000, v14
    ds_read_b128 v[248:251], v14 offset:0
    ds_read_b64_tr_b16 v[32:33], v16 offset:20480
    ds_read_b64_tr_b16 v[34:35], v16 offset:20992
    ds_read_b64_tr_b16 v[44:45], v16 offset:28672
    ds_read_b64_tr_b16 v[46:47], v16 offset:29184
    s_waitcnt lgkmcnt(12)
    v_mfma_f32_32x32x16_bf16 v[64:79], v[36:39], v[240:243], v[64:79]
    s_waitcnt lgkmcnt(10)
    v_mfma_f32_32x32x16_bf16 v[80:95], v[48:51], v[240:243], v[80:95]
    s_add_u32 s3, s3, 128
    s_and_b32 s3, s3, 1023
    s_mul_i32 s80, s3, 1792
    s_add_u32 s80, s80, s79
    s_add_u32 m0, s82, 0x4000
    s_nop 0
    buffer_load_dwordx4 v28, s[4:7], s80 offen lds
    v_add_u32 v15, 0x10000, v15
    ds_read_b128 v[252:255], v15 offset:0
    ds_read_b64_tr_b16 v[36:37], v16 offset:22528
    ds_read_b64_tr_b16 v[38:39], v16 offset:23040
    ds_read_b64_tr_b16 v[48:49], v16 offset:30720
    ds_read_b64_tr_b16 v[50:51], v16 offset:31232
    s_waitcnt lgkmcnt(12)
    v_mfma_f32_32x32x16_bf16 v[64:79], v[40:43], v[244:247], v[64:79]
    s_waitcnt lgkmcnt(10)
    v_mfma_f32_32x32x16_bf16 v[80:95], v[52:55], v[244:247], v[80:95]
    s_add_u32 s3, s3, 128
    s_and_b32 s3, s3, 1023
    s_mul_i32 s80, s3, 1792
    s_add_u32 s80, s80, s79
    s_add_u32 m0, s82, 0x6000
    s_nop 0
    buffer_load_dwordx4 v28, s[4:7], s80 offen lds
    s_add_u32 s3, s3, 128
    s_and_b32 s3, s3, 1023
    s_waitcnt lgkmcnt(7)
    v_mfma_f32_32x32x16_bf16 v[64:79], v[32:35], v[248:251], v[64:79]
    s_waitcnt lgkmcnt(5)
    v_mfma_f32_32x32x16_bf16 v[80:95], v[44:47], v[248:251], v[80:95]
    s_waitcnt lgkmcnt(2)
    v_mfma_f32_32x32x16_bf16 v[64:79], v[36:39], v[252:255], v[64:79]
    s_waitcnt lgkmcnt(0)
    v_mfma_f32_32x32x16_bf16 v[80:95], v[48:51], v[252:255], v[80:95]
    s_mov_b32 s88, 0
    s_waitcnt vmcnt(8)
    s_branch TG_8
TG_7:
    buffer_load_dword v30, v31, s[56:59], 0 offen sc1
    s_waitcnt vmcnt(0)
TG_8:
    v_readfirstlane_b32 s22, v30
    s_nop 0
    s_cmp_lg_u32 s22, 0
    s_cbranch_scc1 TG_9
    s_sleep 1
    s_add_u32 s88, s88, 1
    s_cmp_lt_u32 s88, 40000
    s_cbranch_scc1 TG_7
TG_9:
    s_waitcnt lgkmcnt(0)
    s_barrier
    ds_read_b64_tr_b16 v[32:33], v16 offset:32768
    s_cmp_eq_u32 s68, 11
    s_cselect_b32 s86, 0x3eb8aa3b, 1.0
    ds_read_b64_tr_b16 v[34:35], v16 offset:33280
    s_mov_b32 s90, 0x200000
    s_cmov_b32 s90, 0xffe80000
    s_and_b32 s84, s68, 3
    ds_read_b64_tr_b16 v[36:37], v16 offset:34816
    s_lshl_b32 s84, s84, 2
    s_add_u32 s84, s84, s66
    s_lshl_b32 s84, s84, 17
    ds_read_b64_tr_b16 v[38:39], v16 offset:35328
    s_lshl_b32 s85, s81, 10
    s_add_u32 s84, s84, s85
    s_add_u32 s90, s84, s90
    ds_read_b64_tr_b16 v[40:41], v16 offset:36864
    v_mul_f32 v64, s86, v64
    v_mul_f32 v65, s86, v65
    ds_read_b64_tr_b16 v[42:43], v16 offset:37376
    v_mul_f32 v66, s86, v66
    v_mul_f32 v67, s86, v67
    v_mul_f32 v68, s86, v68
    ds_read_b64_tr_b16 v[44:45], v16 offset:38912
    v_mul_f32 v69, s86, v69
    v_mul_f32 v70, s86, v70
    v_mul_f32 v71, s86, v71
    ds_read_b64_tr_b16 v[46:47], v16 offset:39424
    v_cvt_pk_bf16_f32 v112, v64, v65
    v_cvt_pk_bf16_f32 v113, v66, v67
    v_cvt_pk_bf16_f32 v114, v68, v69
    ds_read_b64_tr_b16 v[48:49], v16 offset:40960
    v_cvt_pk_bf16_f32 v115, v70, v71
    s_add_u32 s87, s90, 0x0
    buffer_store_dwordx4 v[112:115], v2, s[52:55], s87 offen sc1
    ds_read_b64_tr_b16 v[50:51], v16 offset:41472
    v_mul_f32 v72, s86, v72
    v_mul_f32 v73, s86, v73
    s_waitcnt lgkmcnt(8)
    v_mfma_f32_32x32x16_bf16 v[96:111], v[32:35], v[128:131], 0
    v_mul_f32 v74, s86, v74
    v_mul_f32 v75, s86, v75
    v_mul_f32 v76, s86, v76
    ds_read_b64_tr_b16 v[52:53], v16 offset:43008
    v_mul_f32 v77, s86, v77
    v_mul_f32 v78, s86, v78
    v_mul_f32 v79, s86, v79
    ds_read_b64_tr_b16 v[54:55], v16 offset:43520
    v_cvt_pk_bf16_f32 v116, v72, v73
    v_cvt_pk_bf16_f32 v117, v74, v75
    v_cvt_pk_bf16_f32 v118, v76, v77
    s_waitcnt lgkmcnt(8)
    v_mfma_f32_32x32x16_bf16 v[96:111], v[36:39], v[132:135], v[96:111]
    v_cvt_pk_bf16_f32 v119, v78, v79
    s_add_u32 s87, s90, 0x10000
    buffer_store_dwordx4 v[116:119], v2, s[52:55], s87 offen sc1
    ds_read_b64_tr_b16 v[32:33], v16 offset:45056
    v_mul_f32 v80, s86, v80
    v_mul_f32 v81, s86, v81
    ds_read_b64_tr_b16 v[34:35], v16 offset:45568
    v_mul_f32 v82, s86, v82
    v_mul_f32 v83, s86, v83
    v_mul_f32 v84, s86, v84
    s_waitcnt lgkmcnt(8)
    v_mfma_f32_32x32x16_bf16 v[96:111], v[40:43], v[136:139], v[96:111]
    v_mul_f32 v85, s86, v85
    v_mul_f32 v86, s86, v86
    v_mul_f32 v87, s86, v87
    ds_read_b64_tr_b16 v[36:37], v16 offset:47104
    v_cvt_pk_bf16_f32 v120, v80, v81
    v_cvt_pk_bf16_f32 v121, v82, v83
    v_cvt_pk_bf16_f32 v122, v84, v85
    ds_read_b64_tr_b16 v[38:39], v16 offset:47616
    v_cvt_pk_bf16_f32 v123, v86, v87
    s_add_u32 s87, s90, 0x40000
    buffer_store_dwordx4 v[120:123], v2, s[52:55], s87 offen sc1
    s_waitcnt lgkmcnt(8)
    v_mfma_f32_32x32x16_bf16 v[96:111], v[44:47], v[140:143], v[96:111]
    v_mul_f32 v88, s86, v88
    v_mul_f32 v89, s86, v89
    ds_read_b64_tr_b16 v[40:41], v16 offset:49152
    v_mul_f32 v90, s86, v90
    v_mul_f32 v91, s86, v91
    v_mul_f32 v92, s86, v92
    ds_read_b64_tr_b16 v[42:43], v16 offset:49664
    v_mul_f32 v93, s86, v93
    v_mul_f32 v94, s86, v94
    v_mul_f32 v95, s86, v95
    s_waitcnt lgkmcnt(8)
    v_mfma_f32_32x32x16_bf16 v[96:111], v[48:51], v[144:147], v[96:111]
    v_cvt_pk_bf16_f32 v124, v88, v89
    v_cvt_pk_bf16_f32 v125, v90, v91
    v_cvt_pk_bf16_f32 v126, v92, v93
    ds_read_b64_tr_b16 v[44:45], v16 offset:51200
    v_cvt_pk_bf16_f32 v127, v94, v95
    s_add_u32 s87, s90, 0x50000
    buffer_store_dwordx4 v[124:127], v2, s[52:55], s87 offen sc1
    ds_read_b64_tr_b16 v[46:47], v16 offset:51712
    s_waitcnt lgkmcnt(8)
    v_mfma_f32_32x32x16_bf16 v[96:111], v[52:55], v[148:151], v[96:111]
    ds_read_b64_tr_b16 v[48:49], v16 offset:53248
    ds_read_b64_tr_b16 v[50:51], v16 offset:53760
    s_waitcnt lgkmcnt(8)
    v_mfma_f32_32x32x16_bf16 v[96:111], v[32:35], v[152:155], v[96:111]
    ds_read_b64_tr_b16 v[52:53], v16 offset:55296
    ds_read_b64_tr_b16 v[54:55], v16 offset:55808
    s_waitcnt lgkmcnt(8)
    v_mfma_f32_32x32x16_bf16 v[96:111], v[36:39], v[156:159], v[96:111]
    ds_read_b64_tr_b16 v[32:33], v16 offset:57344
    ds_read_b64_tr_b16 v[34:35], v16 offset:57856
    s_waitcnt lgkmcnt(8)
    v_mfma_f32_32x32x16_bf16 v[96:111], v[40:43], v[160:163], v[96:111]
    ds_read_b64_tr_b16 v[36:37], v16 offset:59392
    ds_read_b64_tr_b16 v[38:39], v16 offset:59904
    s_waitcnt lgkmcnt(8)
    v_mfma_f32_32x32x16_bf16 v[96:111], v[44:47], v[164:167], v[96:111]
    ds_read_b64_tr_b16 v[40:41], v16 offset:61440
    ds_read_b64_tr_b16 v[42:43], v16 offset:61952
    s_waitcnt lgkmcnt(8)
    v_mfma_f32_32x32x16_bf16 v[96:111], v[48:51], v[168:171], v[96:111]
    ds_read_b64_tr_b16 v[44:45], v16 offset:63488
    ds_read_b64_tr_b16 v[46:47], v16 offset:64000
    s_waitcnt lgkmcnt(8)
    v_mfma_f32_32x32x16_bf16 v[96:111], v[52:55], v[172:175], v[96:111]
    s_waitcnt vmcnt(8) lgkmcnt(0)
    s_barrier
    v_add_u32 v16, 0x10000, v16
    ds_read_b64_tr_b16 v[48:49], v16 offset:0
    ds_read_b64_tr_b16 v[50:51], v16 offset:512
    v_mfma_f32_32x32x16_bf16 v[96:111], v[32:35], v[176:179], v[96:111]
    ds_read_b64_tr_b16 v[52:53], v16 offset:2048
    ds_read_b64_tr_b16 v[54:55], v16 offset:2560
    v_mfma_f32_32x32x16_bf16 v[96:111], v[36:39], v[180:183], v[96:111]
    ds_read_b64_tr_b16 v[32:33], v16 offset:4096
    ds_read_b64_tr_b16 v[34:35], v16 offset:4608
    v_mfma_f32_32x32x16_bf16 v[96:111], v[40:43], v[184:187], v[96:111]
    ds_read_b64_tr_b16 v[36:37], v16 offset:6144
    ds_read_b64_tr_b16 v[38:39], v16 offset:6656
    v_mfma_f32_32x32x16_bf16 v[96:111], v[44:47], v[188:191], v[96:111]
    ds_read_b64_tr_b16 v[40:41], v16 offset:8192
    ds_read_b64_tr_b16 v[42:43], v16 offset:8704
    s_waitcnt lgkmcnt(8)
    v_mfma_f32_32x32x16_bf16 v[96:111], v[48:51], v[192:195], v[96:111]
    ds_read_b64_tr_b16 v[44:45], v16 offset:10240
    ds_read_b64_tr_b16 v[46:47], v16 offset:10752
    s_waitcnt lgkmcnt(8)
    v_mfma_f32_32x32x16_bf16 v[96:111], v[52:55], v[196:199], v[96:111]
    ds_read_b64_tr_b16 v[48:49], v16 offset:12288
    ds_read_b64_tr_b16 v[50:51], v16 offset:12800
    s_waitcnt lgkmcnt(8)
    v_mfma_f32_32x32x16_bf16 v[96:111], v[32:35], v[200:203], v[96:111]
    ds_read_b64_tr_b16 v[52:53], v16 offset:14336
    ds_read_b64_tr_b16 v[54:55], v16 offset:14848
    s_waitcnt lgkmcnt(8)
    v_mfma_f32_32x32x16_bf16 v[96:111], v[36:39], v[204:207], v[96:111]
    ds_read_b64_tr_b16 v[32:33], v16 offset:16384
    ds_read_b64_tr_b16 v[34:35], v16 offset:16896
    s_waitcnt lgkmcnt(8)
    v_mfma_f32_32x32x16_bf16 v[96:111], v[40:43], v[208:211], v[96:111]
    s_waitcnt vmcnt(0)
    s_barrier
    s_cmp_lg_u32 s64, 0
    s_cbranch_scc1 FL_10
    v_mov_b32 v5, s22
    s_mov_b64 exec, 0xfff
    buffer_store_dword v5, v3, s[52:55], 0 offen sc1
    s_mov_b64 exec, -1
FL_10:
    ds_read_b64_tr_b16 v[36:37], v16 offset:18432
    ds_read_b64_tr_b16 v[38:39], v16 offset:18944
    s_waitcnt lgkmcnt(8)
    v_mfma_f32_32x32x16_bf16 v[96:111], v[44:47], v[212:215], v[96:111]
    s_mul_i32 s80, s3, 1792
    s_add_u32 s80, s80, s79
    s_add_u32 m0, s82, 0x8000
    s_nop 0
    buffer_load_dwordx4 v28, s[4:7], s80 offen lds
    ds_read_b64_tr_b16 v[40:41], v16 offset:20480
    ds_read_b64_tr_b16 v[42:43], v16 offset:20992
    s_waitcnt lgkmcnt(8)
    v_mfma_f32_32x32x16_bf16 v[96:111], v[48:51], v[216:219], v[96:111]
    s_add_u32 s3, s3, 128
    s_and_b32 s3, s3, 1023
    s_mul_i32 s80, s3, 1792
    s_add_u32 s80, s80, s79
    s_add_u32 m0, s82, 0xa000
    s_nop 0
    buffer_load_dwordx4 v28, s[4:7], s80 offen lds
    ds_read_b64_tr_b16 v[44:45], v16 offset:22528
    ds_read_b64_tr_b16 v[46:47], v16 offset:23040
    s_waitcnt lgkmcnt(8)
    v_mfma_f32_32x32x16_bf16 v[96:111], v[52:55], v[220:223], v[96:111]
    s_add_u32 s3, s3, 128
    s_and_b32 s3, s3, 1023
    s_mul_i32 s80, s3, 1792
    s_add_u32 s80, s80, s79
    s_add_u32 m0, s82, 0xc000
    s_nop 0
    buffer_load_dwordx4 v28, s[4:7], s80 offen lds
    ds_read_b64_tr_b16 v[48:49], v16 offset:24576
    ds_read_b64_tr_b16 v[50:51], v16 offset:25088
    s_waitcnt lgkmcnt(8)
    v_mfma_f32_32x32x16_bf16 v[96:111], v[32:35], v[224:227], v[96:111]
    s_add_u32 s3, s3, 128
    s_and_b32 s3, s3, 1023
    s_mul_i32 s80, s3, 1792
    s_add_u32 s80, s80, s79
    s_add_u32 m0, s82, 0xe000
    s_nop 0
    buffer_load_dwordx4 v28, s[4:7], s80 offen lds
    s_add_u32 s3, s3, 128
    s_and_b32 s3, s3, 1023
    ds_read_b64_tr_b16 v[52:53], v16 offset:26624
    ds_read_b64_tr_b16 v[54:55], v16 offset:27136
    s_waitcnt lgkmcnt(8)
    v_mfma_f32_32x32x16_bf16 v[96:111], v[36:39], v[228:231], v[96:111]
    ds_read_b64_tr_b16 v[32:33], v16 offset:28672
    ds_read_b64_tr_b16 v[34:35], v16 offset:29184
    s_waitcnt lgkmcnt(8)
    v_mfma_f32_32x32x16_bf16 v[96:111], v[40:43], v[232:235], v[96:111]
    ds_read_b64_tr_b16 v[36:37], v16 offset:30720
    ds_read_b64_tr_b16 v[38:39], v16 offset:31232
    s_waitcnt lgkmcnt(8)
    v_mfma_f32_32x32x16_bf16 v[96:111], v[44:47], v[236:239], v[96:111]
    s_waitcnt lgkmcnt(6)
    v_mfma_f32_32x32x16_bf16 v[96:111], v[48:51], v[240:243], v[96:111]
    s_waitcnt lgkmcnt(4)
    v_mfma_f32_32x32x16_bf16 v[96:111], v[52:55], v[244:247], v[96:111]
    s_waitcnt lgkmcnt(2)
    v_mfma_f32_32x32x16_bf16 v[96:111], v[32:35], v[248:251], v[96:111]
    s_waitcnt lgkmcnt(0)
    v_mfma_f32_32x32x16_bf16 v[96:111], v[36:39], v[252:255], v[96:111]
FK_R3E:
    s_cmp_lg_u32 s23, 1
    s_cbranch_scc1 FK_R3O
    s_waitcnt lgkmcnt(0)
    s_barrier
    v_subrev_u32 v16, 0x20000, v16
    ds_read_b64_tr_b16 v[32:33], v16 offset:0
    ds_read_b64_tr_b16 v[34:35], v16 offset:512
    ds_read_b64_tr_b16 v[36:37], v16 offset:2048
    ds_read_b64_tr_b16 v[38:39], v16 offset:2560
    s_mov_b32 s86, 0x3eb8aa3b
    ds_read_b64_tr_b16 v[40:41], v16 offset:4096
    s_nop 0
    v_mul_f32 v96, s86, v96
    ds_read_b64_tr_b16 v[42:43], v16 offset:4608
    v_mul_f32 v97, s86, v97
    ds_read_b64_tr_b16 v[44:45], v16 offset:6144
    v_mul_f32 v98, s86, v98
    ds_read_b64_tr_b16 v[46:47], v16 offset:6656
    v_mul_f32 v99, s86, v99
    ds_read_b64_tr_b16 v[48:49], v16 offset:8192
    v_mul_f32 v100, s86, v100
    ds_read_b64_tr_b16 v[50:51], v16 offset:8704
    v_mul_f32 v101, s86, v101
    s_waitcnt lgkmcnt(8)
    v_mfma_f32_32x32x16_bf16 v[80:95], v[32:35], v[128:131], 0
    v_mul_f32 v102, s86, v102
    v_mul_f32 v103, s86, v103
    ds_read_b64_tr_b16 v[52:53], v16 offset:10240
    v_cvt_pk_bf16_f32 v56, v96, v97
    ds_read_b64_tr_b16 v[54:55], v16 offset:10752
    v_cvt_pk_bf16_f32 v57, v98, v99
    s_waitcnt lgkmcnt(8)
    v_mfma_f32_32x32x16_bf16 v[80:95], v[36:39], v[132:135], v[80:95]
    v_cvt_pk_bf16_f32 v58, v100, v101
    ds_read_b64_tr_b16 v[32:33], v16 offset:12288
    v_cvt_pk_bf16_f32 v59, v102, v103
    ds_read_b64_tr_b16 v[34:35], v16 offset:12800
    buffer_store_dwordx4 v[56:59], v2, s[52:55], s92 offen sc1
    s_waitcnt lgkmcnt(8)
    v_mfma_f32_32x32x16_bf16 v[80:95], v[40:43], v[136:139], v[80:95]
    v_mul_f32 v104, s86, v104
    ds_read_b64_tr_b16 v[36:37], v16 offset:14336
    v_mul_f32 v105, s86, v105
    ds_read_b64_tr_b16 v[38:39], v16 offset:14848
    v_mul_f32 v106, s86, v106
    v_mul_f32 v107, s86, v107
    s_waitcnt lgkmcnt(8)
    v_mfma_f32_32x32x16_bf16 v[80:95], v[44:47], v[140:143], v[80:95]
    v_mul_f32 v108, s86, v108
    ds_read_b64_tr_b16 v[40:41], v16 offset:16384
    v_mul_f32 v109, s86, v109
    ds_read_b64_tr_b16 v[42:43], v16 offset:16896
    v_mul_f32 v110, s86, v110
    s_waitcnt lgkmcnt(8)
    v_mfma_f32_32x32x16_bf16 v[80:95], v[48:51], v[144:147], v[80:95]
    v_mul_f32 v111, s86, v111
    ds_read_b64_tr_b16 v[44:45], v16 offset:18432
    v_cvt_pk_bf16_f32 v60, v104, v105
    ds_read_b64_tr_b16 v[46:47], v16 offset:18944
    v_cvt_pk_bf16_f32 v61, v106, v107
    s_waitcnt lgkmcnt(8)
    v_mfma_f32_32x32x16_bf16 v[80:95], v[52:55], v[148:151], v[80:95]
    v_cvt_pk_bf16_f32 v62, v108, v109
    ds_read_b64_tr_b16 v[48:49], v16 offset:20480
    v_cvt_pk_bf16_f32 v63, v110, v111
    buffer_store_dwordx4 v[60:63], v2, s[52:55], s93 offen sc1
    ds_read_b64_tr_b16 v[50:51], v16 offset:20992
    s_waitcnt lgkmcnt(8)
    v_mfma_f32_32x32x16_bf16 v[80:95], v[32:35], v[152:155], v[80:95]
    ds_read_b64_tr_b16 v[52:53], v16 offset:22528
    ds_read_b64_tr_b16 v[54:55], v16 offset:23040
    s_waitcnt lgkmcnt(8)
    v_mfma_f32_32x32x16_bf16 v[80:95], v[36:39], v[156:159], v[80:95]
    ds_read_b64_tr_b16 v[32:33], v16 offset:24576
    ds_read_b64_tr_b16 v[34:35], v16 offset:25088
    s_waitcnt lgkmcnt(8)
    v_mfma_f32_32x32x16_bf16 v[80:95], v[40:43], v[160:163], v[80:95]
    ds_read_b64_tr_b16 v[36:37], v16 offset:26624
    ds_read_b64_tr_b16 v[38:39], v16 offset:27136
    s_waitcnt lgkmcnt(8)
    v_mfma_f32_32x32x16_bf16 v[80:95], v[44:47], v[164:167], v[80:95]
    ds_read_b64_tr_b16 v[40:41], v16 offset:28672
    ds_read_b64_tr_b16 v[42:43], v16 offset:29184
    s_waitcnt lgkmcnt(8)
    v_mfma_f32_32x32x16_bf16 v[80:95], v[48:51], v[168:171], v[80:95]
    ds_read_b64_tr_b16 v[44:45], v16 offset:30720
    ds_read_b64_tr_b16 v[46:47], v16 offset:31232
    s_waitcnt lgkmcnt(8)
    v_mfma_f32_32x32x16_bf16 v[80:95], v[52:55], v[172:175], v[80:95]
    s_waitcnt vmcnt(2) lgkmcnt(0)
    s_barrier
    ds_read_b64_tr_b16 v[48:49], v16 offset:32768
    ds_read_b64_tr_b16 v[50:51], v16 offset:33280
    v_mfma_f32_32x32x16_bf16 v[80:95], v[32:35], v[176:179], v[80:95]
    s_cmp_lg_u32 s64, 0
    s_cbranch_scc1 EI_11
    s_lshl_b32 s71, s16, 7
    s_add_u32 s71, s71, 0x1500000
    v_lshlrev_b32 v31, 2, v1
    v_add_u32 v31, s71, v31
    s_lshl_b32 s72, s17, 3
    s_add_u32 s71, s71, s72
    s_add_u32 s71, s71, 4096
    s_mov_b32 exec_lo, 0
    v_and_b32 v31, 4, v31
    v_add_u32 v31, s71, v31
    s_mov_b32 exec_lo, -1
    buffer_load_dword v30, v31, s[52:55], 0 offen sc1
EI_11:
    ds_read_b64_tr_b16 v[52:53], v16 offset:34816
    ds_read_b64_tr_b16 v[54:55], v16 offset:35328
    v_mfma_f32_32x32x16_bf16 v[80:95], v[36:39], v[180:183], v[80:95]
    ds_read_b64_tr_b16 v[32:33], v16 offset:36864
    ds_read_b64_tr_b16 v[34:35], v16 offset:37376
    v_mfma_f32_32x32x16_bf16 v[80:95], v[40:43], v[184:187], v[80:95]
    ds_read_b64_tr_b16 v[36:37], v16 offset:38912
    ds_read_b64_tr_b16 v[38:39], v16 offset:39424
    v_mfma_f32_32x32x16_bf16 v[80:95], v[44:47], v[188:191], v[80:95]
    ds_read_b64_tr_b16 v[40:41], v16 offset:40960
    ds_read_b64_tr_b16 v[42:43], v16 offset:41472
    s_waitcnt lgkmcnt(8)
    v_mfma_f32_32x32x16_bf16 v[80:95], v[48:51], v[192:195], v[80:95]
    ds_read_b64_tr_b16 v[44:45], v16 offset:43008
    ds_read_b64_tr_b16 v[46:47], v16 offset:43520
    s_waitcnt lgkmcnt(8)
    v_mfma_f32_32x32x16_bf16 v[80:95], v[52:55], v[196:199], v[80:95]
    ds_read_b64_tr_b16 v[48:49], v16 offset:45056
    ds_read_b64_tr_b16 v[50:51], v16 offset:45568
    s_waitcnt lgkmcnt(8)
    v_mfma_f32_32x32x16_bf16 v[80:95], v[32:35], v[200:203], v[80:95]
    ds_read_b64_tr_b16 v[52:53], v16 offset:47104
    ds_read_b64_tr_b16 v[54:55], v16 offset:47616
    s_waitcnt lgkmcnt(8)
    v_mfma_f32_32x32x16_bf16 v[80:95], v[36:39], v[204:207], v[80:95]
    ds_read_b64_tr_b16 v[32:33], v16 offset:49152
    ds_read_b64_tr_b16 v[34:35], v16 offset:49664
    s_waitcnt lgkmcnt(8)
    v_mfma_f32_32x32x16_bf16 v[80:95], v[40:43], v[208:211], v[80:95]
    s_cmp_lg_u32 s64, 0
    s_cbranch_scc1 EN_15
    s_mov_b32 s88, 0
    s_waitcnt vmcnt(0)
    s_branch PC_13
PL_12:
    buffer_load_dword v30, v31, s[52:55], 0 offen sc1
    s_waitcnt vmcnt(0)
PC_13:
    v_cmp_ne_u32 vcc, s22, v30
    s_nop 0
    s_and_b32 vcc_lo, vcc_lo, 0x03030303
    s_cmp_eq_u64 vcc, 0
    s_cbranch_scc1 PD_14
    s_sleep 1
    s_add_u32 s88, s88, 1
    s_cmp_lt_u32 s88, 40000
    s_cbranch_scc1 PL_12
PD_14:
EN_15:
    s_barrier
    s_add_u32 m0, s91, 0x0
    s_nop 0
    buffer_load_dwordx4 v29, s[52:55], s95 offen sc1 lds
    s_add_u32 s95, s95, 2048
    s_lshl_b32 s90, s17, 3
    s_lshl_b32 s71, s65, 1
    s_add_u32 s90, s90, s71
    s_add_u32 s90, s90, s66
    s_lshl_b32 s71, s16, 16
    s_lshl_b32 s72, s90, 10
    s_add_u32 s75, s71, s72
    s_xor_b32 s76, s75, 1024
    s_add_u32 m0, s91, 0x2000
    s_nop 0
    buffer_load_dwordx4 v29, s[52:55], s95 offen sc1 lds
    s_add_u32 s95, s95, 2048
    s_xor_b32 s91, s91, 16384
    s_add_u32 m0, s91, 0x0
    s_nop 0
    buffer_load_dwordx4 v29, s[52:55], s95 offen sc1 lds
    s_add_u32 s95, s95, 2048
    ds_read_b64_tr_b16 v[36:37], v16 offset:51200
    ds_read_b64_tr_b16 v[38:39], v16 offset:51712
    s_waitcnt lgkmcnt(8)
    v_mfma_f32_32x32x16_bf16 v[80:95], v[44:47], v[212:215], v[80:95]
    ds_read_b64_tr_b16 v[40:41], v16 offset:53248
    ds_read_b64_tr_b16 v[42:43], v16 offset:53760
    s_waitcnt lgkmcnt(8)
    v_mfma_f32_32x32x16_bf16 v[80:95], v[48:51], v[216:219], v[80:95]
    ds_read_b64_tr_b16 v[44:45], v16 offset:55296
    ds_read_b64_tr_b16 v[46:47], v16 offset:55808
    s_waitcnt lgkmcnt(8)
    v_mfma_f32_32x32x16_bf16 v[80:95], v[52:55], v[220:223], v[80:95]
    ds_read_b64_tr_b16 v[48:49], v16 offset:57344
    ds_read_b64_tr_b16 v[50:51], v16 offset:57856
    s_waitcnt lgkmcnt(8)
    v_mfma_f32_32x32x16_bf16 v[80:95], v[32:35], v[224:227], v[80:95]
    s_lshl_b32 s71, s66, 11
    s_add_u32 s71, s71, 65536
    v_add_u32 v8, s71, v2
    v_lshrrev_b32 v5, 5, v1
    v_and_b32 v6, 15, v1
    v_lshlrev_b32 v6, 4, v6
    ds_read_b64_tr_b16 v[52:53], v16 offset:59392
    v_lshl_add_u32 v6, v5, 8, v6
    s_add_u32 s71, s71, 4096
    v_add_u32 v9, s71, v6
    s_mov_b32 s98, 0xffff
    s_mov_b32 s99, 0xffff
    v_and_b32 v6, 31, v1
    v_bfe_u32 v7, v6, 1, 3
    ds_read_b64_tr_b16 v[54:55], v16 offset:59904
    v_xor_b32 v7, v7, v5
    v_lshlrev_b32 v7, 4, v7
    v_lshlrev_b32 v6, 7, v6
    s_lshl_b32 s71, s66, 13
    s_add_u32 s71, s71, 98304
    v_add3_u32 v12, v6, v7, s71
    s_waitcnt lgkmcnt(8)
    v_mfma_f32_32x32x16_bf16 v[80:95], v[36:39], v[228:231], v[80:95]
    v_xor_b32 v13, 32, v12
    v_xor_b32 v14, 64, v12
    v_xor_b32 v15, 96, v12
    v_lshrrev_b32 v5, 3, v1
    v_lshrrev_b32 v6, 4, v1
    v_and_b32 v7, 7, v1
    v_xor_b32 v7, v7, v6
    ds_read_b64_tr_b16 v[32:33], v16 offset:61440
    v_lshlrev_b32 v7, 4, v7
    s_lshl_b32 s71, s69, 6
    s_lshl_b32 s72, s65, 4
    s_lshl_b32 s73, s66, 5
    s_xor_b32 s72, s72, s73
    s_add_u32 s71, s71, s72
    ds_read_b64_tr_b16 v[34:35], v16 offset:61952
    v_add_u32 v5, s71, v5
    v_lshlrev_b32 v5, 12, v5
    s_lshl_b32 s71, s66, 11
    v_add3_u32 v10, v5, v7, s71
    v_xor_b32 v11, 64, v10
    v_add_u32 v11, 32768, v11
    s_mov_b32 s94, 0
    s_waitcnt lgkmcnt(8)
    v_mfma_f32_32x32x16_bf16 v[80:95], v[40:43], v[232:235], v[80:95]
    s_lshl_b32 s71, s70, 2
    s_add_u32 s71, s71, s65
    s_lshl_b32 s71, s71, 1
    s_add_u32 s71, s71, s66
    s_lshl_b32 s71, s71, 16
    s_add_u32 s96, s71, 0xa00000
    v_and_b32 v5, 27, v1
    ds_read_b64_tr_b16 v[36:37], v16 offset:63488
    v_cmp_eq_u32 vcc, 16, v5
    v_mov_b32 v6, 0x3f803f80
    s_nop 0
    v_cndmask_b32 v6, 0, v6, vcc
    v_mov_b32 v208, v6
    v_mov_b32 v209, v6
    v_mov_b32 v210, v6
    ds_read_b64_tr_b16 v[38:39], v16 offset:64000
    v_mov_b32 v211, v6
    v_mov_b32 v212, v6
    v_mov_b32 v213, v6
    v_mov_b32 v214, v6
    v_mov_b32 v215, v6
    v_mov_b32 v216, v6
    v_mov_b32 v217, v6
    s_waitcnt lgkmcnt(8)
    v_mfma_f32_32x32x16_bf16 v[80:95], v[44:47], v[236:239], v[80:95]
    buffer_load_dwordx4 v[112:115], v2, s[52:55], s76 offen sc1
    buffer_load_dwordx4 v[116:119], v2, s[52:55], s75 offen sc1
    v_mov_b32 v218, v6
    v_mov_b32 v219, v6
    v_mov_b32 v220, v6
    v_mov_b32 v221, v6
    v_mov_b32 v222, v6
    v_mov_b32 v223, v6
    s_waitcnt lgkmcnt(6)
    v_mfma_f32_32x32x16_bf16 v[80:95], v[48:51], v[240:243], v[80:95]
    s_mov_b32 s40, s28
    s_mov_b32 s41, s29
    s_mov_b32 s42, 0x1000
    s_mov_b32 s43, 0x00020000
    s_mov_b32 s4, s30
    s_mov_b32 s5, s31
    s_mov_b32 s6, 0xe0000
    s_waitcnt lgkmcnt(4)
    v_mfma_f32_32x32x16_bf16 v[80:95], v[52:55], v[244:247], v[80:95]
    s_mov_b32 s7, 0x00020000
    s_mov_b32 s8, s20
    s_mov_b32 s9, s21
    s_mov_b32 s10, 0x80000
    s_mov_b32 s11, 0x00020000
    s_mov_b32 s12, s34
    s_waitcnt lgkmcnt(2)
    v_mfma_f32_32x32x16_bf16 v[80:95], v[32:35], v[248:251], v[80:95]
    s_mov_b32 s13, s35
    s_mov_b32 s14, 0x200000
    s_mov_b32 s15, 0x00020000
    v_lshrrev_b32 v5, 3, v1
    v_bfe_u32 v6, v1, 4, 1
    v_lshlrev_b32 v6, 2, v6
    v_and_b32 v7, 7, v1
    s_waitcnt lgkmcnt(0)
    v_mfma_f32_32x32x16_bf16 v[80:95], v[36:39], v[252:255], v[80:95]
    v_xor_b32 v7, v7, v6
    v_lshlrev_b32 v7, 4, v7
    s_lshl_b32 s71, s64, 3
    v_add_u32 v5, s71, v5
    v_lshl_add_u32 v20, v5, 10, v7
    s_lshl_b32 s71, s70, 7
    v_add_u32 v20, s71, v20
    s_branch FK_R4E
FK_R3O:
    s_cmp_eq_u32 s70, 7
    s_cbranch_scc1 FK_R4
    s_waitcnt lgkmcnt(0)
    s_barrier
    v_subrev_u32 v16, 0x20000, v16
    ds_read_b64_tr_b16 v[32:33], v16 offset:0
    ds_read_b64_tr_b16 v[34:35], v16 offset:512
    ds_read_b64_tr_b16 v[36:37], v16 offset:2048
    ds_read_b64_tr_b16 v[38:39], v16 offset:2560
    ds_read_b64_tr_b16 v[40:41], v16 offset:4096
    ds_read_b64_tr_b16 v[42:43], v16 offset:4608
    ds_read_b64_tr_b16 v[44:45], v16 offset:6144
    ds_read_b64_tr_b16 v[46:47], v16 offset:6656
    s_lshr_b32 s84, s78, 6
    s_add_u32 s84, s84, s66
    ds_read_b64_tr_b16 v[48:49], v16 offset:8192
    s_mul_i32 s85, s81, 28
    s_add_u32 s84, s84, s85
    s_lshl_b32 s84, s84, 11
    ds_read_b64_tr_b16 v[50:51], v16 offset:8704
    s_add_u32 s84, s84, 0x600000
    v_mul_f32 v18, v96, v96
    s_waitcnt lgkmcnt(8)
    v_mfma_f32_32x32x16_bf16 v[80:95], v[32:35], v[128:131], 0
    v_mul_f32 v19, v97, v97
    v_mul_f32 v20, v98, v98
    v_mul_f32 v21, v99, v99
    ds_read_b64_tr_b16 v[52:53], v16 offset:10240
    v_mul_f32 v22, v100, v100
    v_mul_f32 v23, v101, v101
    ds_read_b64_tr_b16 v[54:55], v16 offset:10752
    v_mul_f32 v24, v102, v102
    v_mul_f32 v25, v103, v103
    v_fmaak_f32 v18, v26, v18, 0xc0135761
    s_waitcnt lgkmcnt(8)
    v_mfma_f32_32x32x16_bf16 v[80:95], v[36:39], v[132:135], v[80:95]
    v_fmaak_f32 v19, v26, v19, 0xc0135761
    v_fmaak_f32 v20, v26, v20, 0xc0135761
    v_fmaak_f32 v21, v26, v21, 0xc0135761
    ds_read_b64_tr_b16 v[32:33], v16 offset:12288
    v_fmaak_f32 v22, v26, v22, 0xc0135761
    v_fmaak_f32 v23, v26, v23, 0xc0135761
    ds_read_b64_tr_b16 v[34:35], v16 offset:12800
    v_fmaak_f32 v24, v26, v24, 0xc0135761
    v_fmaak_f32 v25, v26, v25, 0xc0135761
    v_mul_f32 v18, v18, v96
    s_waitcnt lgkmcnt(8)
    v_mfma_f32_32x32x16_bf16 v[80:95], v[40:43], v[136:139], v[80:95]
    v_mul_f32 v19, v19, v97
    v_mul_f32 v20, v20, v98
    ds_read_b64_tr_b16 v[36:37], v16 offset:14336
    v_mul_f32 v21, v21, v99
    v_mul_f32 v22, v22, v100
    v_mul_f32 v23, v23, v101
    ds_read_b64_tr_b16 v[38:39], v16 offset:14848
    v_mul_f32 v24, v24, v102
    v_mul_f32 v25, v25, v103
    v_exp_f32 v18, v18
    s_waitcnt lgkmcnt(8)
    v_mfma_f32_32x32x16_bf16 v[80:95], v[44:47], v[140:143], v[80:95]
    v_exp_f32 v19, v19
    v_exp_f32 v20, v20
    ds_read_b64_tr_b16 v[40:41], v16 offset:16384
    v_exp_f32 v21, v21
    v_exp_f32 v22, v22
    v_exp_f32 v23, v23
    ds_read_b64_tr_b16 v[42:43], v16 offset:16896
    v_exp_f32 v24, v24
    v_exp_f32 v25, v25
    s_waitcnt lgkmcnt(8)
    v_mfma_f32_32x32x16_bf16 v[80:95], v[48:51], v[144:147], v[80:95]
    v_add_f32 v18, 1.0, v18
    v_add_f32 v19, 1.0, v19
    v_add_f32 v20, 1.0, v20
    ds_read_b64_tr_b16 v[44:45], v16 offset:18432
    v_add_f32 v21, 1.0, v21
    v_add_f32 v22, 1.0, v22
    v_add_f32 v23, 1.0, v23
    ds_read_b64_tr_b16 v[46:47], v16 offset:18944
    v_add_f32 v24, 1.0, v24
    v_add_f32 v25, 1.0, v25
    s_waitcnt lgkmcnt(8)
    v_mfma_f32_32x32x16_bf16 v[80:95], v[52:55], v[148:151], v[80:95]
    v_rcp_f32 v18, v18
    v_rcp_f32 v19, v19
    v_rcp_f32 v20, v20
    ds_read_b64_tr_b16 v[48:49], v16 offset:20480
    v_rcp_f32 v21, v21
    v_rcp_f32 v22, v22
    ds_read_b64_tr_b16 v[50:51], v16 offset:20992
    v_rcp_f32 v23, v23
    v_rcp_f32 v24, v24
    v_rcp_f32 v25, v25
    s_waitcnt lgkmcnt(8)
    v_mfma_f32_32x32x16_bf16 v[80:95], v[32:35], v[152:155], v[80:95]
    v_mul_f32 v96, v96, v18
    v_mul_f32 v97, v97, v19
    v_mul_f32 v98, v98, v20
    ds_read_b64_tr_b16 v[52:53], v16 offset:22528
    v_mul_f32 v99, v99, v21
    v_mul_f32 v100, v100, v22
    ds_read_b64_tr_b16 v[54:55], v16 offset:23040
    v_mul_f32 v101, v101, v23
    v_mul_f32 v102, v102, v24
    v_mul_f32 v103, v103, v25
    s_waitcnt lgkmcnt(8)
    v_mfma_f32_32x32x16_bf16 v[80:95], v[36:39], v[156:159], v[80:95]
    v_mul_f32 v18, v104, v104
    v_mul_f32 v19, v105, v105
    ds_read_b64_tr_b16 v[32:33], v16 offset:24576
    v_mul_f32 v20, v106, v106
    v_mul_f32 v21, v107, v107
    v_mul_f32 v22, v108, v108
    ds_read_b64_tr_b16 v[34:35], v16 offset:25088
    v_mul_f32 v23, v109, v109
    v_mul_f32 v24, v110, v110
    v_mul_f32 v25, v111, v111
    s_waitcnt lgkmcnt(8)
    v_mfma_f32_32x32x16_bf16 v[80:95], v[40:43], v[160:163], v[80:95]
    v_fmaak_f32 v18, v26, v18, 0xc0135761
    v_fmaak_f32 v19, v26, v19, 0xc0135761
    ds_read_b64_tr_b16 v[36:37], v16 offset:26624
    v_fmaak_f32 v20, v26, v20, 0xc0135761
    v_fmaak_f32 v21, v26, v21, 0xc0135761
    v_fmaak_f32 v22, v26, v22, 0xc0135761
    ds_read_b64_tr_b16 v[38:39], v16 offset:27136
    v_fmaak_f32 v23, v26, v23, 0xc0135761
    v_fmaak_f32 v24, v26, v24, 0xc0135761
    s_waitcnt lgkmcnt(8)
    v_mfma_f32_32x32x16_bf16 v[80:95], v[44:47], v[164:167], v[80:95]
    v_fmaak_f32 v25, v26, v25, 0xc0135761
    v_mul_f32 v18, v18, v104
    v_mul_f32 v19, v19, v105
    ds_read_b64_tr_b16 v[40:41], v16 offset:28672
    v_mul_f32 v20, v20, v106
    v_mul_f32 v21, v21, v107
    v_mul_f32 v22, v22, v108
    ds_read_b64_tr_b16 v[42:43], v16 offset:29184
    v_mul_f32 v23, v23, v109
    v_mul_f32 v24, v24, v110
    s_waitcnt lgkmcnt(8)
    v_mfma_f32_32x32x16_bf16 v[80:95], v[48:51], v[168:171], v[80:95]
    v_mul_f32 v25, v25, v111
    v_exp_f32 v18, v18
    v_exp_f32 v19, v19
    ds_read_b64_tr_b16 v[44:45], v16 offset:30720
    v_exp_f32 v20, v20
    v_exp_f32 v21, v21
    ds_read_b64_tr_b16 v[46:47], v16 offset:31232
    v_exp_f32 v22, v22
    v_exp_f32 v23, v23
    v_exp_f32 v24, v24
    s_waitcnt lgkmcnt(8)
    v_mfma_f32_32x32x16_bf16 v[80:95], v[52:55], v[172:175], v[80:95]
    v_exp_f32 v25, v25
    v_add_f32 v18, 1.0, v18
    v_add_f32 v19, 1.0, v19
    s_waitcnt vmcnt(0) lgkmcnt(0)
    s_barrier
    ds_read_b64_tr_b16 v[48:49], v16 offset:32768
    v_add_f32 v20, 1.0, v20
    v_add_f32 v21, 1.0, v21
    v_add_f32 v22, 1.0, v22
    v_add_f32 v23, 1.0, v23
    v_add_f32 v24, 1.0, v24
    v_add_f32 v25, 1.0, v25
    v_rcp_f32 v18, v18
    v_rcp_f32 v19, v19
    v_rcp_f32 v20, v20
    v_rcp_f32 v21, v21
    v_rcp_f32 v22, v22
    v_rcp_f32 v23, v23
    v_rcp_f32 v24, v24
    v_rcp_f32 v25, v25
    v_mul_f32 v104, v104, v18
    v_mul_f32 v105, v105, v19
    ds_read_b64_tr_b16 v[50:51], v16 offset:33280
    v_mul_f32 v106, v106, v20
    v_mul_f32 v107, v107, v21
    v_mul_f32 v108, v108, v22
    v_mul_f32 v109, v109, v23
    v_mul_f32 v110, v110, v24
    v_mul_f32 v111, v111, v25
    v_cvt_pk_bf16_f32 v56, v96, v97
    v_cvt_pk_bf16_f32 v57, v98, v99
    v_cvt_pk_bf16_f32 v58, v100, v101
    v_cvt_pk_bf16_f32 v59, v102, v103
    v_cvt_pk_bf16_f32 v60, v104, v105
    v_cvt_pk_bf16_f32 v61, v106, v107
    v_cvt_pk_bf16_f32 v62, v108, v109
    v_cvt_pk_bf16_f32 v63, v110, v111
    buffer_store_dwordx4 v[56:59], v2, s[52:55], s84 offen offset:0 sc1
    buffer_store_dwordx4 v[60:63], v2, s[52:55], s84 offen offset:1024 sc1
    v_mfma_f32_32x32x16_bf16 v[80:95], v[32:35], v[176:179], v[80:95]
    s_cmp_lg_u32 s64, 0
    s_cbranch_scc1 EI_16
    s_lshl_b32 s71, s16, 7
    s_add_u32 s71, s71, 0x1500000
    v_lshlrev_b32 v31, 2, v1
    v_add_u32 v31, s71, v31
    s_lshl_b32 s72, s17, 3
    s_add_u32 s71, s71, s72
    s_add_u32 s71, s71, 4096
    s_mov_b32 exec_lo, 0
    v_and_b32 v31, 4, v31
    v_add_u32 v31, s71, v31
    s_mov_b32 exec_lo, -1
    buffer_load_dword v30, v31, s[52:55], 0 offen sc1
EI_16:
    ds_read_b64_tr_b16 v[52:53], v16 offset:34816
    ds_read_b64_tr_b16 v[54:55], v16 offset:35328
    v_mfma_f32_32x32x16_bf16 v[80:95], v[36:39], v[180:183], v[80:95]
    ds_read_b64_tr_b16 v[32:33], v16 offset:36864
    ds_read_b64_tr_b16 v[34:35], v16 offset:37376
    v_mfma_f32_32x32x16_bf16 v[80:95], v[40:43], v[184:187], v[80:95]
    ds_read_b64_tr_b16 v[36:37], v16 offset:38912
    ds_read_b64_tr_b16 v[38:39], v16 offset:39424
    v_mfma_f32_32x32x16_bf16 v[80:95], v[44:47], v[188:191], v[80:95]
    ds_read_b64_tr_b16 v[40:41], v16 offset:40960
    ds_read_b64_tr_b16 v[42:43], v16 offset:41472
    s_waitcnt lgkmcnt(8)
    v_mfma_f32_32x32x16_bf16 v[80:95], v[48:51], v[192:195], v[80:95]
    ds_read_b64_tr_b16 v[44:45], v16 offset:43008
    ds_read_b64_tr_b16 v[46:47], v16 offset:43520
    s_waitcnt lgkmcnt(8)
    v_mfma_f32_32x32x16_bf16 v[80:95], v[52:55], v[196:199], v[80:95]
    ds_read_b64_tr_b16 v[48:49], v16 offset:45056
    ds_read_b64_tr_b16 v[50:51], v16 offset:45568
    s_waitcnt lgkmcnt(8)
    v_mfma_f32_32x32x16_bf16 v[80:95], v[32:35], v[200:203], v[80:95]
    ds_read_b64_tr_b16 v[52:53], v16 offset:47104
    ds_read_b64_tr_b16 v[54:55], v16 offset:47616
    s_waitcnt lgkmcnt(8)
    v_mfma_f32_32x32x16_bf16 v[80:95], v[36:39], v[204:207], v[80:95]
    ds_read_b64_tr_b16 v[32:33], v16 offset:49152
    ds_read_b64_tr_b16 v[34:35], v16 offset:49664
    s_waitcnt lgkmcnt(8)
    v_mfma_f32_32x32x16_bf16 v[80:95], v[40:43], v[208:211], v[80:95]
    s_cmp_lg_u32 s64, 0
    s_cbranch_scc1 EN_20
    s_mov_b32 s88, 0
    s_waitcnt vmcnt(0)
    s_branch PC_18
PL_17:
    buffer_load_dword v30, v31, s[52:55], 0 offen sc1
    s_waitcnt vmcnt(0)
PC_18:
    v_cmp_ne_u32 vcc, s22, v30
    s_nop 0
    s_and_b32 vcc_lo, vcc_lo, 0x03030303
    s_cmp_eq_u64 vcc, 0
    s_cbranch_scc1 PD_19
    s_sleep 1
    s_add_u32 s88, s88, 1
    s_cmp_lt_u32 s88, 40000
    s_cbranch_scc1 PL_17
PD_19:
EN_20:
    s_barrier
    s_add_u32 m0, s91, 0x0
    s_nop 0
    buffer_load_dwordx4 v29, s[52:55], s95 offen sc1 lds
    s_add_u32 s95, s95, 2048
    s_lshl_b32 s90, s17, 3
    s_lshl_b32 s71, s65, 1
    s_add_u32 s90, s90, s71
    s_add_u32 s90, s90, s66
    s_lshl_b32 s71, s16, 16
    s_lshl_b32 s72, s90, 10
    s_add_u32 s75, s71, s72
    s_xor_b32 s76, s75, 1024
    s_add_u32 m0, s91, 0x2000
    s_nop 0
    buffer_load_dwordx4 v29, s[52:55], s95 offen sc1 lds
    s_add_u32 s95, s95, 2048
    s_xor_b32 s91, s91, 16384
    s_add_u32 m0, s91, 0x0
    s_nop 0
    buffer_load_dwordx4 v29, s[52:55], s95 offen sc1 lds
    s_add_u32 s95, s95, 2048
    ds_read_b64_tr_b16 v[36:37], v16 offset:51200
    ds_read_b64_tr_b16 v[38:39], v16 offset:51712
    s_waitcnt lgkmcnt(8)
    v_mfma_f32_32x32x16_bf16 v[80:95], v[44:47], v[212:215], v[80:95]
    ds_read_b64_tr_b16 v[40:41], v16 offset:53248
    ds_read_b64_tr_b16 v[42:43], v16 offset:53760
    s_waitcnt lgkmcnt(8)
    v_mfma_f32_32x32x16_bf16 v[80:95], v[48:51], v[216:219], v[80:95]
    ds_read_b64_tr_b16 v[44:45], v16 offset:55296
    ds_read_b64_tr_b16 v[46:47], v16 offset:55808
    s_waitcnt lgkmcnt(8)
    v_mfma_f32_32x32x16_bf16 v[80:95], v[52:55], v[220:223], v[80:95]
    ds_read_b64_tr_b16 v[48:49], v16 offset:57344
    ds_read_b64_tr_b16 v[50:51], v16 offset:57856
    s_waitcnt lgkmcnt(8)
    v_mfma_f32_32x32x16_bf16 v[80:95], v[32:35], v[224:227], v[80:95]
    s_lshl_b32 s71, s66, 11
    s_add_u32 s71, s71, 65536
    v_add_u32 v8, s71, v2
    v_lshrrev_b32 v5, 5, v1
    v_and_b32 v6, 15, v1
    v_lshlrev_b32 v6, 4, v6
    ds_read_b64_tr_b16 v[52:53], v16 offset:59392
    v_lshl_add_u32 v6, v5, 8, v6
    s_add_u32 s71, s71, 4096
    v_add_u32 v9, s71, v6
    s_mov_b32 s98, 0xffff
    s_mov_b32 s99, 0xffff
    v_and_b32 v6, 31, v1
    v_bfe_u32 v7, v6, 1, 3
    ds_read_b64_tr_b16 v[54:55], v16 offset:59904
    v_xor_b32 v7, v7, v5
    v_lshlrev_b32 v7, 4, v7
    v_lshlrev_b32 v6, 7, v6
    s_lshl_b32 s71, s66, 13
    s_add_u32 s71, s71, 98304
    v_add3_u32 v12, v6, v7, s71
    s_waitcnt lgkmcnt(8)
    v_mfma_f32_32x32x16_bf16 v[80:95], v[36:39], v[228:231], v[80:95]
    v_xor_b32 v13, 32, v12
    v_xor_b32 v14, 64, v12
    v_xor_b32 v15, 96, v12
    v_lshrrev_b32 v5, 3, v1
    v_lshrrev_b32 v6, 4, v1
    v_and_b32 v7, 7, v1
    v_xor_b32 v7, v7, v6
    ds_read_b64_tr_b16 v[32:33], v16 offset:61440
    v_lshlrev_b32 v7, 4, v7
    s_lshl_b32 s71, s69, 6
    s_lshl_b32 s72, s65, 4
    s_lshl_b32 s73, s66, 5
    s_xor_b32 s72, s72, s73
    s_add_u32 s71, s71, s72
    ds_read_b64_tr_b16 v[34:35], v16 offset:61952
    v_add_u32 v5, s71, v5
    v_lshlrev_b32 v5, 12, v5
    s_lshl_b32 s71, s66, 11
    v_add3_u32 v10, v5, v7, s71
    v_xor_b32 v11, 64, v10
    v_add_u32 v11, 32768, v11
    s_mov_b32 s94, 0
    s_waitcnt lgkmcnt(8)
    v_mfma_f32_32x32x16_bf16 v[80:95], v[40:43], v[232:235], v[80:95]
    s_lshl_b32 s71, s70, 2
    s_add_u32 s71, s71, s65
    s_lshl_b32 s71, s71, 1
    s_add_u32 s71, s71, s66
    s_lshl_b32 s71, s71, 16
    s_add_u32 s96, s71, 0xa00000
    v_and_b32 v5, 27, v1
    ds_read_b64_tr_b16 v[36:37], v16 offset:63488
    v_cmp_eq_u32 vcc, 16, v5
    v_mov_b32 v6, 0x3f803f80
    s_nop 0
    v_cndmask_b32 v6, 0, v6, vcc
    v_mov_b32 v208, v6
    v_mov_b32 v209, v6
    v_mov_b32 v210, v6
    ds_read_b64_tr_b16 v[38:39], v16 offset:64000
    v_mov_b32 v211, v6
    v_mov_b32 v212, v6
    v_mov_b32 v213, v6
    v_mov_b32 v214, v6
    v_mov_b32 v215, v6
    v_mov_b32 v216, v6
    v_mov_b32 v217, v6
    s_waitcnt lgkmcnt(8)
    v_mfma_f32_32x32x16_bf16 v[80:95], v[44:47], v[236:239], v[80:95]
    buffer_load_dwordx4 v[112:115], v2, s[52:55], s76 offen sc1
    buffer_load_dwordx4 v[116:119], v2, s[52:55], s75 offen sc1
    v_mov_b32 v218, v6
    v_mov_b32 v219, v6
    v_mov_b32 v220, v6
    v_mov_b32 v221, v6
    v_mov_b32 v222, v6
    v_mov_b32 v223, v6
    s_waitcnt lgkmcnt(6)
    v_mfma_f32_32x32x16_bf16 v[80:95], v[48:51], v[240:243], v[80:95]
    s_mov_b32 s40, s28
    s_mov_b32 s41, s29
    s_mov_b32 s42, 0x1000
    s_mov_b32 s43, 0x00020000
    s_mov_b32 s4, s30
    s_mov_b32 s5, s31
    s_mov_b32 s6, 0xe0000
    s_waitcnt lgkmcnt(4)
    v_mfma_f32_32x32x16_bf16 v[80:95], v[52:55], v[244:247], v[80:95]
    s_mov_b32 s7, 0x00020000
    s_mov_b32 s8, s20
    s_mov_b32 s9, s21
    s_mov_b32 s10, 0x80000
    s_mov_b32 s11, 0x00020000
    s_mov_b32 s12, s34
    s_waitcnt lgkmcnt(2)
    v_mfma_f32_32x32x16_bf16 v[80:95], v[32:35], v[248:251], v[80:95]
    s_mov_b32 s13, s35
    s_mov_b32 s14, 0x200000
    s_mov_b32 s15, 0x00020000
    v_lshrrev_b32 v5, 3, v1
    v_bfe_u32 v6, v1, 4, 1
    v_lshlrev_b32 v6, 2, v6
    v_and_b32 v7, 7, v1
    s_waitcnt lgkmcnt(0)
    v_mfma_f32_32x32x16_bf16 v[80:95], v[36:39], v[252:255], v[80:95]
    v_xor_b32 v7, v7, v6
    v_lshlrev_b32 v7, 4, v7
    s_lshl_b32 s71, s64, 3
    v_add_u32 v5, s71, v5
    v_lshl_add_u32 v20, v5, 10, v7
    s_lshl_b32 s71, s70, 7
    v_add_u32 v20, s71, v20
FK_R4E:
    s_mov_b32 s86, 0xc0135761
    s_mov_b32 s87, 0xc0135761
    v_mov_b32 v27, 0xbdd2d3e8
    s_lshr_b32 s84, s79, 6
    s_add_u32 s84, s84, s66
    s_mul_i32 s85, s81, 28
    s_add_u32 s84, s84, s85
    s_lshl_b32 s84, s84, 11
    s_add_u32 s84, s84, 0x600000
    v_pk_mul_f32 v[32:33], v[80:81], v[80:81]
    v_pk_mul_f32 v[34:35], v[82:83], v[82:83]
    v_pk_mul_f32 v[36:37], v[84:85], v[84:85]
    v_pk_mul_f32 v[38:39], v[86:87], v[86:87]
    v_pk_fma_f32 v[32:33], v[32:33], v[26:27], s[86:87]
    v_pk_fma_f32 v[34:35], v[34:35], v[26:27], s[86:87]
    v_pk_fma_f32 v[36:37], v[36:37], v[26:27], s[86:87]
    v_pk_fma_f32 v[38:39], v[38:39], v[26:27], s[86:87]
    v_pk_mul_f32 v[32:33], v[32:33], v[80:81]
    v_pk_mul_f32 v[34:35], v[34:35], v[82:83]
    v_pk_mul_f32 v[36:37], v[36:37], v[84:85]
    v_pk_mul_f32 v[38:39], v[38:39], v[86:87]
    v_exp_f32 v32, v32
    v_exp_f32 v33, v33
    v_exp_f32 v34, v34
    v_exp_f32 v35, v35
    v_exp_f32 v36, v36
    v_exp_f32 v37, v37
    v_exp_f32 v38, v38
    v_exp_f32 v39, v39
    v_pk_add_f32 v[32:33], v[32:33], 1.0 op_sel_hi:[1,0]
    v_pk_add_f32 v[34:35], v[34:35], 1.0 op_sel_hi:[1,0]
    v_pk_add_f32 v[36:37], v[36:37], 1.0 op_sel_hi:[1,0]
    v_pk_add_f32 v[38:39], v[38:39], 1.0 op_sel_hi:[1,0]
    v_rcp_f32 v32, v32
    v_rcp_f32 v33, v33
    v_rcp_f32 v34, v34
    v_rcp_f32 v35, v35
    v_rcp_f32 v36, v36
    v_rcp_f32 v37, v37
    v_rcp_f32 v38, v38
    v_rcp_f32 v39, v39
    v_pk_mul_f32 v[80:81], v[80:81], v[32:33]
    v_pk_mul_f32 v[82:83], v[82:83], v[34:35]
    v_pk_mul_f32 v[84:85], v[84:85], v[36:37]
    v_pk_mul_f32 v[86:87], v[86:87], v[38:39]
    v_pk_mul_f32 v[32:33], v[88:89], v[88:89]
    v_pk_mul_f32 v[34:35], v[90:91], v[90:91]
    v_pk_mul_f32 v[36:37], v[92:93], v[92:93]
    v_pk_mul_f32 v[38:39], v[94:95], v[94:95]
    v_pk_fma_f32 v[32:33], v[32:33], v[26:27], s[86:87]
    v_pk_fma_f32 v[34:35], v[34:35], v[26:27], s[86:87]
    v_pk_fma_f32 v[36:37], v[36:37], v[26:27], s[86:87]
    v_pk_fma_f32 v[38:39], v[38:39], v[26:27], s[86:87]
    v_pk_mul_f32 v[32:33], v[32:33], v[88:89]
    v_pk_mul_f32 v[34:35], v[34:35], v[90:91]
    v_pk_mul_f32 v[36:37], v[36:37], v[92:93]
    v_pk_mul_f32 v[38:39], v[38:39], v[94:95]
    v_exp_f32 v32, v32
    v_exp_f32 v33, v33
    v_exp_f32 v34, v34
    v_exp_f32 v35, v35
    v_exp_f32 v36, v36
    v_exp_f32 v37, v37
    v_exp_f32 v38, v38
    v_exp_f32 v39, v39
    v_pk_add_f32 v[32:33], v[32:33], 1.0 op_sel_hi:[1,0]
    v_pk_add_f32 v[34:35], v[34:35], 1.0 op_sel_hi:[1,0]
    v_pk_add_f32 v[36:37], v[36:37], 1.0 op_sel_hi:[1,0]
    v_pk_add_f32 v[38:39], v[38:39], 1.0 op_sel_hi:[1,0]
    v_rcp_f32 v32, v32
    v_rcp_f32 v33, v33
    v_rcp_f32 v34, v34
    v_rcp_f32 v35, v35
    v_rcp_f32 v36, v36
    v_rcp_f32 v37, v37
    v_rcp_f32 v38, v38
    v_rcp_f32 v39, v39
    v_pk_mul_f32 v[88:89], v[88:89], v[32:33]
    v_pk_mul_f32 v[90:91], v[90:91], v[34:35]
    v_pk_mul_f32 v[92:93], v[92:93], v[36:37]
    v_pk_mul_f32 v[94:95], v[94:95], v[38:39]
    v_cvt_pk_bf16_f32 v56, v80, v81
    v_cvt_pk_bf16_f32 v57, v82, v83
    v_cvt_pk_bf16_f32 v58, v84, v85
    v_cvt_pk_bf16_f32 v59, v86, v87
    v_cvt_pk_bf16_f32 v60, v88, v89
    v_cvt_pk_bf16_f32 v61, v90, v91
    v_cvt_pk_bf16_f32 v62, v92, v93
    v_cvt_pk_bf16_f32 v63, v94, v95
    buffer_store_dwordx4 v[56:59], v2, s[52:55], s84 offen offset:0 sc1
    buffer_store_dwordx4 v[60:63], v2, s[52:55], s84 offen offset:1024 sc1
    s_waitcnt vmcnt(2)
    s_branch FK_ENTRY_A2
FK_G0Z:
    s_waitcnt vmcnt(8) lgkmcnt(0)
    s_barrier
    ds_read_b128 v[128:131], v12 offset:0
    ds_read_b64_tr_b16 v[32:33], v16 offset:16384
    ds_read_b64_tr_b16 v[34:35], v16 offset:16896
    ds_read_b64_tr_b16 v[44:45], v16 offset:24576
    ds_read_b64_tr_b16 v[46:47], v16 offset:25088
    s_add_u32 s80, s75, s3
    s_mul_i32 s88, s3, s77
    s_add_u32 m0, s83, 0x18000
    s_nop 0
    buffer_load_dwordx4 v8, s[40:43], s80 offen lds
    ds_read_b128 v[132:135], v13 offset:0
    ds_read_b64_tr_b16 v[36:37], v16 offset:18432
    ds_read_b64_tr_b16 v[38:39], v16 offset:18944
    ds_read_b64_tr_b16 v[48:49], v16 offset:26624
    ds_read_b64_tr_b16 v[50:51], v16 offset:27136
    s_add_u32 s88, s88, s76
    s_add_u32 m0, s82, 0x1c000
    s_nop 0
    buffer_load_dwordx4 v10, s[44:47], s88 offen lds
    ds_read_b128 v[136:139], v14 offset:0
    ds_read_b64_tr_b16 v[40:41], v16 offset:20480
    ds_read_b64_tr_b16 v[42:43], v16 offset:20992
    ds_read_b64_tr_b16 v[52:53], v16 offset:28672
    ds_read_b64_tr_b16 v[54:55], v16 offset:29184
    s_waitcnt lgkmcnt(12)
    v_mfma_f32_32x32x16_bf16 v[64:79], v[32:35], v[128:131], 0
    s_waitcnt lgkmcnt(10)
    v_mfma_f32_32x32x16_bf16 v[80:95], v[44:47], v[128:131], 0
    s_add_u32 m0, s83, 0x18400
    s_nop 0
    buffer_load_dwordx4 v9, s[40:43], s80 offen lds
    ds_read_b128 v[140:143], v15 offset:0
    ds_read_b64_tr_b16 v[32:33], v16 offset:22528
    ds_read_b64_tr_b16 v[34:35], v16 offset:23040
    ds_read_b64_tr_b16 v[44:45], v16 offset:30720
    ds_read_b64_tr_b16 v[46:47], v16 offset:31232
    s_waitcnt lgkmcnt(12)
    v_mfma_f32_32x32x16_bf16 v[64:79], v[36:39], v[132:135], v[64:79]
    s_waitcnt lgkmcnt(10)
    v_mfma_f32_32x32x16_bf16 v[80:95], v[48:51], v[132:135], v[80:95]
    s_add_u32 m0, s82, 0x1df80
    s_nop 0
    buffer_load_dwordx4 v10, s[44:47], s88 offen offset:128 lds
    s_add_u32 s3, s3, 128
    s_and_b32 s3, s3, 1023
    s_waitcnt vmcnt(8) lgkmcnt(0)
    s_barrier
    ds_read_b128 v[144:147], v12 offset:32768
    ds_read_b64_tr_b16 v[36:37], v16 offset:49152
    ds_read_b64_tr_b16 v[38:39], v16 offset:49664
    ds_read_b64_tr_b16 v[48:49], v16 offset:57344
    ds_read_b64_tr_b16 v[50:51], v16 offset:57856
    v_mfma_f32_32x32x16_bf16 v[64:79], v[40:43], v[136:139], v[64:79]
    v_mfma_f32_32x32x16_bf16 v[80:95], v[52:55], v[136:139], v[80:95]
    s_add_u32 s80, s75, s3
    s_mul_i32 s88, s3, s77
    s_add_u32 m0, s83, 0x20000
    s_nop 0
    buffer_load_dwordx4 v8, s[40:43], s80 offen lds
    ds_read_b128 v[148:151], v13 offset:32768
    ds_read_b64_tr_b16 v[40:41], v16 offset:51200
    ds_read_b64_tr_b16 v[42:43], v16 offset:51712
    ds_read_b64_tr_b16 v[52:53], v16 offset:59392
    ds_read_b64_tr_b16 v[54:55], v16 offset:59904
    v_mfma_f32_32x32x16_bf16 v[64:79], v[32:35], v[140:143], v[64:79]
    v_mfma_f32_32x32x16_bf16 v[80:95], v[44:47], v[140:143], v[80:95]
    s_add_u32 s88, s88, s76
    s_add_u32 m0, s82, 0x24000
    s_nop 0
    buffer_load_dwordx4 v10, s[44:47], s88 offen lds
    ds_read_b128 v[152:155], v14 offset:32768
    ds_read_b64_tr_b16 v[32:33], v16 offset:53248
    ds_read_b64_tr_b16 v[34:35], v16 offset:53760
    ds_read_b64_tr_b16 v[44:45], v16 offset:61440
    ds_read_b64_tr_b16 v[46:47], v16 offset:61952
    s_waitcnt lgkmcnt(12)
    v_mfma_f32_32x32x16_bf16 v[64:79], v[36:39], v[144:147], v[64:79]
    s_waitcnt lgkmcnt(10)
    v_mfma_f32_32x32x16_bf16 v[80:95], v[48:51], v[144:147], v[80:95]
    s_add_u32 m0, s83, 0x20400
    s_nop 0
    buffer_load_dwordx4 v9, s[40:43], s80 offen lds
    ds_read_b128 v[156:159], v15 offset:32768
    ds_read_b64_tr_b16 v[36:37], v16 offset:55296
    ds_read_b64_tr_b16 v[38:39], v16 offset:55808
    ds_read_b64_tr_b16 v[48:49], v16 offset:63488
    ds_read_b64_tr_b16 v[50:51], v16 offset:64000
    s_waitcnt lgkmcnt(12)
    v_mfma_f32_32x32x16_bf16 v[64:79], v[40:43], v[148:151], v[64:79]
    s_waitcnt lgkmcnt(10)
    v_mfma_f32_32x32x16_bf16 v[80:95], v[52:55], v[148:151], v[80:95]
    s_add_u32 m0, s82, 0x25f80
    s_nop 0
    buffer_load_dwordx4 v10, s[44:47], s88 offen offset:128 lds
    s_add_u32 s3, s3, 128
    s_and_b32 s3, s3, 1023
    s_waitcnt vmcnt(8) lgkmcnt(0)
    s_barrier
    v_add_u32 v12, 0x10000, v12
    ds_read_b128 v[160:163], v12 offset:0
    v_add_u32 v16, 0x10000, v16
    ds_read_b64_tr_b16 v[40:41], v16 offset:16384
    ds_read_b64_tr_b16 v[42:43], v16 offset:16896
    ds_read_b64_tr_b16 v[52:53], v16 offset:24576
    ds_read_b64_tr_b16 v[54:55], v16 offset:25088
    v_mfma_f32_32x32x16_bf16 v[64:79], v[32:35], v[152:155], v[64:79]
    v_mfma_f32_32x32x16_bf16 v[80:95], v[44:47], v[152:155], v[80:95]
    s_add_u32 s80, s75, s3
    s_mul_i32 s88, s3, s77
    s_add_u32 m0, s83, 0x0
    s_nop 0
    buffer_load_dwordx4 v8, s[40:43], s80 offen lds
    v_add_u32 v13, 0x10000, v13
    ds_read_b128 v[164:167], v13 offset:0
    ds_read_b64_tr_b16 v[32:33], v16 offset:18432
    ds_read_b64_tr_b16 v[34:35], v16 offset:18944
    ds_read_b64_tr_b16 v[44:45], v16 offset:26624
    ds_read_b64_tr_b16 v[46:47], v16 offset:27136
    v_mfma_f32_32x32x16_bf16 v[64:79], v[36:39], v[156:159], v[64:79]
    v_mfma_f32_32x32x16_bf16 v[80:95], v[48:51], v[156:159], v[80:95]
    s_add_u32 s88, s88, s76
    s_add_u32 m0, s82, 0x4000
    s_nop 0
    buffer_load_dwordx4 v10, s[44:47], s88 offen lds
    v_add_u32 v14, 0x10000, v14
    ds_read_b128 v[168:171], v14 offset:0
    ds_read_b64_tr_b16 v[36:37], v16 offset:20480
    ds_read_b64_tr_b16 v[38:39], v16 offset:20992
    ds_read_b64_tr_b16 v[48:49], v16 offset:28672
    ds_read_b64_tr_b16 v[50:51], v16 offset:29184
    s_waitcnt lgkmcnt(12)
    v_mfma_f32_32x32x16_bf16 v[64:79], v[40:43], v[160:163], v[64:79]
    s_waitcnt lgkmcnt(10)
    v_mfma_f32_32x32x16_bf16 v[80:95], v[52:55], v[160:163], v[80:95]
    s_add_u32 m0, s83, 0x400
    s_nop 0
    buffer_load_dwordx4 v9, s[40:43], s80 offen lds
    v_add_u32 v15, 0x10000, v15
    ds_read_b128 v[172:175], v15 offset:0
    ds_read_b64_tr_b16 v[40:41], v16 offset:22528
    ds_read_b64_tr_b16 v[42:43], v16 offset:23040
    ds_read_b64_tr_b16 v[52:53], v16 offset:30720
    ds_read_b64_tr_b16 v[54:55], v16 offset:31232
    s_waitcnt lgkmcnt(12)
    v_mfma_f32_32x32x16_bf16 v[64:79], v[32:35], v[164:167], v[64:79]
    s_waitcnt lgkmcnt(10)
    v_mfma_f32_32x32x16_bf16 v[80:95], v[44:47], v[164:167], v[80:95]
    s_add_u32 m0, s82, 0x5f80
    s_nop 0
    buffer_load_dwordx4 v10, s[44:47], s88 offen offset:128 lds
    s_add_u32 s3, s3, 128
    s_and_b32 s3, s3, 1023
    s_waitcnt vmcnt(8) lgkmcnt(0)
    s_barrier
    ds_read_b128 v[176:179], v12 offset:32768
    ds_read_b64_tr_b16 v[32:33], v16 offset:49152
    ds_read_b64_tr_b16 v[34:35], v16 offset:49664
    ds_read_b64_tr_b16 v[44:45], v16 offset:57344
    ds_read_b64_tr_b16 v[46:47], v16 offset:57856
    v_mfma_f32_32x32x16_bf16 v[64:79], v[36:39], v[168:171], v[64:79]
    v_mfma_f32_32x32x16_bf16 v[80:95], v[48:51], v[168:171], v[80:95]
    s_add_u32 s80, s75, s3
    s_mul_i32 s88, s3, s77
    s_add_u32 m0, s83, 0x8000
    s_nop 0
    buffer_load_dwordx4 v8, s[40:43], s80 offen lds
    ds_read_b128 v[180:183], v13 offset:32768
    ds_read_b64_tr_b16 v[36:37], v16 offset:51200
    ds_read_b64_tr_b16 v[38:39], v16 offset:51712
    ds_read_b64_tr_b16 v[48:49], v16 offset:59392
    ds_read_b64_tr_b16 v[50:51], v16 offset:59904
    v_mfma_f32_32x32x16_bf16 v[64:79], v[40:43], v[172:175], v[64:79]
    v_mfma_f32_32x32x16_bf16 v[80:95], v[52:55], v[172:175], v[80:95]
    s_add_u32 s88, s88, s76
    s_add_u32 m0, s82, 0xc000
    s_nop 0
    buffer_load_dwordx4 v10, s[44:47], s88 offen lds
    ds_read_b128 v[184:187], v14 offset:32768
    ds_read_b64_tr_b16 v[40:41], v16 offset:53248
    ds_read_b64_tr_b16 v[42:43], v16 offset:53760
    ds_read_b64_tr_b16 v[52:53], v16 offset:61440
    ds_read_b64_tr_b16 v[54:55], v16 offset:61952
    s_waitcnt lgkmcnt(12)
    v_mfma_f32_32x32x16_bf16 v[64:79], v[32:35], v[176:179], v[64:79]
    s_waitcnt lgkmcnt(10)
    v_mfma_f32_32x32x16_bf16 v[80:95], v[44:47], v[176:179], v[80:95]
    s_add_u32 m0, s83, 0x8400
    s_nop 0
    buffer_load_dwordx4 v9, s[40:43], s80 offen lds
    ds_read_b128 v[188:191], v15 offset:32768
    ds_read_b64_tr_b16 v[32:33], v16 offset:55296
    ds_read_b64_tr_b16 v[34:35], v16 offset:55808
    ds_read_b64_tr_b16 v[44:45], v16 offset:63488
    ds_read_b64_tr_b16 v[46:47], v16 offset:64000
    s_waitcnt lgkmcnt(12)
    v_mfma_f32_32x32x16_bf16 v[64:79], v[36:39], v[180:183], v[64:79]
    s_waitcnt lgkmcnt(10)
    v_mfma_f32_32x32x16_bf16 v[80:95], v[48:51], v[180:183], v[80:95]
    s_add_u32 m0, s82, 0xdf80
    s_nop 0
    buffer_load_dwordx4 v10, s[44:47], s88 offen offset:128 lds
    s_add_u32 s3, s3, 128
    s_and_b32 s3, s3, 1023
    s_waitcnt vmcnt(8) lgkmcnt(0)
    s_barrier
    v_add_u32 v12, 0x10000, v12
    ds_read_b128 v[192:195], v12 offset:0
    v_add_u32 v16, 0x10000, v16
    ds_read_b64_tr_b16 v[36:37], v16 offset:16384
    ds_read_b64_tr_b16 v[38:39], v16 offset:16896
    ds_read_b64_tr_b16 v[48:49], v16 offset:24576
    ds_read_b64_tr_b16 v[50:51], v16 offset:25088
    v_mfma_f32_32x32x16_bf16 v[64:79], v[40:43], v[184:187], v[64:79]
    v_mfma_f32_32x32x16_bf16 v[80:95], v[52:55], v[184:187], v[80:95]
    s_add_u32 s80, s75, s3
    s_mul_i32 s88, s3, s77
    s_add_u32 m0, s83, 0x10000
    s_nop 0
    buffer_load_dwordx4 v8, s[40:43], s80 offen lds
    v_add_u32 v13, 0x10000, v13
    ds_read_b128 v[196:199], v13 offset:0
    ds_read_b64_tr_b16 v[40:41], v16 offset:18432
    ds_read_b64_tr_b16 v[42:43], v16 offset:18944
    ds_read_b64_tr_b16 v[52:53], v16 offset:26624
    ds_read_b64_tr_b16 v[54:55], v16 offset:27136
    v_mfma_f32_32x32x16_bf16 v[64:79], v[32:35], v[188:191], v[64:79]
    v_mfma_f32_32x32x16_bf16 v[80:95], v[44:47], v[188:191], v[80:95]
    s_add_u32 s88, s88, s76
    s_add_u32 m0, s82, 0x14000
    s_nop 0
    buffer_load_dwordx4 v10, s[44:47], s88 offen lds
    v_add_u32 v14, 0x10000, v14
    ds_read_b128 v[200:203], v14 offset:0
    ds_read_b64_tr_b16 v[32:33], v16 offset:20480
    ds_read_b64_tr_b16 v[34:35], v16 offset:20992
    ds_read_b64_tr_b16 v[44:45], v16 offset:28672
    ds_read_b64_tr_b16 v[46:47], v16 offset:29184
    s_waitcnt lgkmcnt(12)
    v_mfma_f32_32x32x16_bf16 v[64:79], v[36:39], v[192:195], v[64:79]
    s_waitcnt lgkmcnt(10)
    v_mfma_f32_32x32x16_bf16 v[80:95], v[48:51], v[192:195], v[80:95]
    s_add_u32 m0, s83, 0x10400
    s_nop 0
    buffer_load_dwordx4 v9, s[40:43], s80 offen lds
    v_add_u32 v15, 0x10000, v15
    ds_read_b128 v[204:207], v15 offset:0
    ds_read_b64_tr_b16 v[36:37], v16 offset:22528
    ds_read_b64_tr_b16 v[38:39], v16 offset:23040
    ds_read_b64_tr_b16 v[48:49], v16 offset:30720
    ds_read_b64_tr_b16 v[50:51], v16 offset:31232
    s_waitcnt lgkmcnt(12)
    v_mfma_f32_32x32x16_bf16 v[64:79], v[40:43], v[196:199], v[64:79]
    s_waitcnt lgkmcnt(10)
    v_mfma_f32_32x32x16_bf16 v[80:95], v[52:55], v[196:199], v[80:95]
    s_add_u32 m0, s82, 0x15f80
    s_nop 0
    buffer_load_dwordx4 v10, s[44:47], s88 offen offset:128 lds
    s_add_u32 s3, s3, 128
    s_and_b32 s3, s3, 1023
    s_waitcnt vmcnt(8) lgkmcnt(0)
    s_barrier
    v_subrev_u32 v12, 0x20000, v12
    ds_read_b128 v[208:211], v12 offset:0
    v_subrev_u32 v16, 0x20000, v16
    ds_read_b64_tr_b16 v[40:41], v16 offset:16384
    ds_read_b64_tr_b16 v[42:43], v16 offset:16896
    ds_read_b64_tr_b16 v[52:53], v16 offset:24576
    ds_read_b64_tr_b16 v[54:55], v16 offset:25088
    v_mfma_f32_32x32x16_bf16 v[64:79], v[32:35], v[200:203], v[64:79]
    v_mfma_f32_32x32x16_bf16 v[80:95], v[44:47], v[200:203], v[80:95]
    s_mul_i32 s80, s3, s96
    s_add_u32 s80, s80, s78
    s_add_u32 m0, s82, 0x18000
    s_nop 0
    buffer_load_dwordx4 v11, s[48:51], s80 offen lds
    v_subrev_u32 v13, 0x20000, v13
    ds_read_b128 v[212:215], v13 offset:0
    ds_read_b64_tr_b16 v[32:33], v16 offset:18432
    ds_read_b64_tr_b16 v[34:35], v16 offset:18944
    ds_read_b64_tr_b16 v[44:45], v16 offset:26624
    ds_read_b64_tr_b16 v[46:47], v16 offset:27136
    v_mfma_f32_32x32x16_bf16 v[64:79], v[36:39], v[204:207], v[64:79]
    v_mfma_f32_32x32x16_bf16 v[80:95], v[48:51], v[204:207], v[80:95]
    s_add_u32 s3, s3, 128
    s_and_b32 s3, s3, 1023
    s_mul_i32 s80, s3, s96
    s_add_u32 s80, s80, s78
    s_add_u32 m0, s82, 0x1a000
    s_nop 0
    buffer_load_dwordx4 v11, s[48:51], s80 offen lds
    v_subrev_u32 v14, 0x20000, v14
    ds_read_b128 v[216:219], v14 offset:0
    ds_read_b64_tr_b16 v[36:37], v16 offset:20480
    ds_read_b64_tr_b16 v[38:39], v16 offset:20992
    ds_read_b64_tr_b16 v[48:49], v16 offset:28672
    ds_read_b64_tr_b16 v[50:51], v16 offset:29184
    s_waitcnt lgkmcnt(12)
    v_mfma_f32_32x32x16_bf16 v[64:79], v[40:43], v[208:211], v[64:79]
    s_waitcnt lgkmcnt(10)
    v_mfma_f32_32x32x16_bf16 v[80:95], v[52:55], v[208:211], v[80:95]
    s_add_u32 s3, s3, 128
    s_and_b32 s3, s3, 1023
    s_mul_i32 s80, s3, s96
    s_add_u32 s80, s80, s78
    s_add_u32 m0, s82, 0x1c000
    s_nop 0
    buffer_load_dwordx4 v11, s[48:51], s80 offen lds
    v_subrev_u32 v15, 0x20000, v15
    ds_read_b128 v[220:223], v15 offset:0
    ds_read_b64_tr_b16 v[40:41], v16 offset:22528
    ds_read_b64_tr_b16 v[42:43], v16 offset:23040
    ds_read_b64_tr_b16 v[52:53], v16 offset:30720
    ds_read_b64_tr_b16 v[54:55], v16 offset:31232
    s_waitcnt lgkmcnt(12)
    v_mfma_f32_32x32x16_bf16 v[64:79], v[32:35], v[212:215], v[64:79]
    s_waitcnt lgkmcnt(10)
    v_mfma_f32_32x32x16_bf16 v[80:95], v[44:47], v[212:215], v[80:95]
    s_add_u32 s3, s3, 128
    s_and_b32 s3, s3, 1023
    s_mul_i32 s80, s3, s96
    s_add_u32 s80, s80, s78
    s_add_u32 m0, s82, 0x1e000
    s_nop 0
    buffer_load_dwordx4 v11, s[48:51], s80 offen lds
    s_add_u32 s3, s3, 128
    s_and_b32 s3, s3, 1023
    s_waitcnt vmcnt(8) lgkmcnt(0)
    s_barrier
    ds_read_b128 v[224:227], v12 offset:32768
    ds_read_b64_tr_b16 v[32:33], v16 offset:49152
    ds_read_b64_tr_b16 v[34:35], v16 offset:49664
    ds_read_b64_tr_b16 v[44:45], v16 offset:57344
    ds_read_b64_tr_b16 v[46:47], v16 offset:57856
    v_mov_b32 v31, 0
    buffer_load_dword v30, v31, s[56:59], 0 offen sc1
    v_mfma_f32_32x32x16_bf16 v[64:79], v[36:39], v[216:219], v[64:79]
    v_mfma_f32_32x32x16_bf16 v[80:95], v[48:51], v[216:219], v[80:95]
    s_mul_i32 s80, s3, s96
    s_add_u32 s80, s80, s78
    s_add_u32 m0, s82, 0x20000
    s_nop 0
    buffer_load_dwordx4 v11, s[48:51], s80 offen lds
    ds_read_b128 v[228:231], v13 offset:32768
    ds_read_b64_tr_b16 v[36:37], v16 offset:51200
    ds_read_b64_tr_b16 v[38:39], v16 offset:51712
    ds_read_b64_tr_b16 v[48:49], v16 offset:59392
    ds_read_b64_tr_b16 v[50:51], v16 offset:59904
    v_mfma_f32_32x32x16_bf16 v[64:79], v[40:43], v[220:223], v[64:79]
    v_mfma_f32_32x32x16_bf16 v[80:95], v[52:55], v[220:223], v[80:95]
    s_add_u32 s3, s3, 128
    s_and_b32 s3, s3, 1023
    s_mul_i32 s80, s3, s96
    s_add_u32 s80, s80, s78
    s_add_u32 m0, s82, 0x22000
    s_nop 0
    buffer_load_dwordx4 v11, s[48:51], s80 offen lds
    ds_read_b128 v[232:235], v14 offset:32768
    ds_read_b64_tr_b16 v[40:41], v16 offset:53248
    ds_read_b64_tr_b16 v[42:43], v16 offset:53760
    ds_read_b64_tr_b16 v[52:53], v16 offset:61440
    ds_read_b64_tr_b16 v[54:55], v16 offset:61952
    s_waitcnt lgkmcnt(12)
    v_mfma_f32_32x32x16_bf16 v[64:79], v[32:35], v[224:227], v[64:79]
    s_waitcnt lgkmcnt(10)
    v_mfma_f32_32x32x16_bf16 v[80:95], v[44:47], v[224:227], v[80:95]
    s_add_u32 s3, s3, 128
    s_and_b32 s3, s3, 1023
    s_mul_i32 s80, s3, s96
    s_add_u32 s80, s80, s78
    s_add_u32 m0, s82, 0x24000
    s_nop 0
    buffer_load_dwordx4 v11, s[48:51], s80 offen lds
    ds_read_b128 v[236:239], v15 offset:32768
    ds_read_b64_tr_b16 v[32:33], v16 offset:55296
    ds_read_b64_tr_b16 v[34:35], v16 offset:55808
    ds_read_b64_tr_b16 v[44:45], v16 offset:63488
    ds_read_b64_tr_b16 v[46:47], v16 offset:64000
    s_waitcnt lgkmcnt(12)
    v_mfma_f32_32x32x16_bf16 v[64:79], v[36:39], v[228:231], v[64:79]
    s_waitcnt lgkmcnt(10)
    v_mfma_f32_32x32x16_bf16 v[80:95], v[48:51], v[228:231], v[80:95]
    s_add_u32 s3, s3, 128
    s_and_b32 s3, s3, 1023
    s_mul_i32 s80, s3, s96
    s_add_u32 s80, s80, s78
    s_add_u32 m0, s82, 0x26000
    s_nop 0
    buffer_load_dwordx4 v11, s[48:51], s80 offen lds
    s_add_u32 s3, s3, 128
    s_and_b32 s3, s3, 1023
    s_waitcnt vmcnt(9) lgkmcnt(0)
    s_barrier
    v_add_u32 v12, 0x10000, v12
    ds_read_b128 v[240:243], v12 offset:0
    v_add_u32 v16, 0x10000, v16
    ds_read_b64_tr_b16 v[36:37], v16 offset:16384
    ds_read_b64_tr_b16 v[38:39], v16 offset:16896
    ds_read_b64_tr_b16 v[48:49], v16 offset:24576
    ds_read_b64_tr_b16 v[50:51], v16 offset:25088
    v_mfma_f32_32x32x16_bf16 v[64:79], v[40:43], v[232:235], v[64:79]
    v_mfma_f32_32x32x16_bf16 v[80:95], v[52:55], v[232:235], v[80:95]
    v_add_u32 v5, s3, v2
    v_and_b32 v5, 1023, v5
    s_lshl_b32 s71, s65, 13
    s_add_u32 m0, s71, 0x1c00
    s_nop 0
    buffer_load_dwordx4 v5, s[12:15], 0 offen lds
    v_add_u32 v13, 0x10000, v13
    ds_read_b128 v[244:247], v13 offset:0
    ds_read_b64_tr_b16 v[40:41], v16 offset:18432
    ds_read_b64_tr_b16 v[42:43], v16 offset:18944
    ds_read_b64_tr_b16 v[52:53], v16 offset:26624
    ds_read_b64_tr_b16 v[54:55], v16 offset:27136
    v_mfma_f32_32x32x16_bf16 v[64:79], v[32:35], v[236:239], v[64:79]
    v_mfma_f32_32x32x16_bf16 v[80:95], v[44:47], v[236:239], v[80:95]
    v_add_u32 v14, 0x10000, v14
    ds_read_b128 v[248:251], v14 offset:0
    ds_read_b64_tr_b16 v[32:33], v16 offset:20480
    ds_read_b64_tr_b16 v[34:35], v16 offset:20992
    ds_read_b64_tr_b16 v[44:45], v16 offset:28672
    ds_read_b64_tr_b16 v[46:47], v16 offset:29184
    s_waitcnt lgkmcnt(12)
    v_mfma_f32_32x32x16_bf16 v[64:79], v[36:39], v[240:243], v[64:79]
    s_waitcnt lgkmcnt(10)
    v_mfma_f32_32x32x16_bf16 v[80:95], v[48:51], v[240:243], v[80:95]
    v_add_u32 v15, 0x10000, v15
    ds_read_b128 v[252:255], v15 offset:0
    ds_read_b64_tr_b16 v[36:37], v16 offset:22528
    ds_read_b64_tr_b16 v[38:39], v16 offset:23040
    ds_read_b64_tr_b16 v[48:49], v16 offset:30720
    ds_read_b64_tr_b16 v[50:51], v16 offset:31232
    s_waitcnt lgkmcnt(12)
    v_mfma_f32_32x32x16_bf16 v[64:79], v[40:43], v[244:247], v[64:79]
    s_waitcnt lgkmcnt(10)
    v_mfma_f32_32x32x16_bf16 v[80:95], v[52:55], v[244:247], v[80:95]
    s_waitcnt lgkmcnt(7)
    v_mfma_f32_32x32x16_bf16 v[64:79], v[32:35], v[248:251], v[64:79]
    s_waitcnt lgkmcnt(5)
    v_mfma_f32_32x32x16_bf16 v[80:95], v[44:47], v[248:251], v[80:95]
    s_waitcnt lgkmcnt(2)
    v_mfma_f32_32x32x16_bf16 v[64:79], v[36:39], v[252:255], v[64:79]
    s_waitcnt lgkmcnt(0)
    v_mfma_f32_32x32x16_bf16 v[80:95], v[48:51], v[252:255], v[80:95]
    s_mov_b32 s84, 0xc0135761
    s_mov_b32 s85, 0xc0135761
    v_mov_b32 v27, 0xbdd2d3e8
    s_nop 6
    v_pk_mul_f32 v[18:19], v[64:65], v[64:65]
    v_pk_mul_f32 v[20:21], v[66:67], v[66:67]
    v_pk_mul_f32 v[22:23], v[68:69], v[68:69]
    v_pk_mul_f32 v[24:25], v[70:71], v[70:71]
    v_pk_fma_f32 v[18:19], v[18:19], v[26:27], s[84:85]
    v_pk_fma_f32 v[20:21], v[20:21], v[26:27], s[84:85]
    v_pk_fma_f32 v[22:23], v[22:23], v[26:27], s[84:85]
    v_pk_fma_f32 v[24:25], v[24:25], v[26:27], s[84:85]
    v_pk_mul_f32 v[18:19], v[18:19], v[64:65]
    v_pk_mul_f32 v[20:21], v[20:21], v[66:67]
    v_pk_mul_f32 v[22:23], v[22:23], v[68:69]
    v_pk_mul_f32 v[24:25], v[24:25], v[70:71]
    v_exp_f32 v18, v18
    v_exp_f32 v19, v19
    v_exp_f32 v20, v20
    v_exp_f32 v21, v21
    v_exp_f32 v22, v22
    v_exp_f32 v23, v23
    v_exp_f32 v24, v24
    v_exp_f32 v25, v25
    v_pk_add_f32 v[18:19], v[18:19], 1.0 op_sel_hi:[1,0]
    v_pk_add_f32 v[20:21], v[20:21], 1.0 op_sel_hi:[1,0]
    v_pk_add_f32 v[22:23], v[22:23], 1.0 op_sel_hi:[1,0]
    v_pk_add_f32 v[24:25], v[24:25], 1.0 op_sel_hi:[1,0]
    v_rcp_f32 v18, v18
    v_rcp_f32 v19, v19
    v_rcp_f32 v20, v20
    v_rcp_f32 v21, v21
    v_rcp_f32 v22, v22
    v_rcp_f32 v23, v23
    v_rcp_f32 v24, v24
    v_rcp_f32 v25, v25
    v_pk_mul_f32 v[64:65], v[64:65], v[18:19]
    v_pk_mul_f32 v[66:67], v[66:67], v[20:21]
    v_pk_mul_f32 v[68:69], v[68:69], v[22:23]
    v_pk_mul_f32 v[70:71], v[70:71], v[24:25]
    v_pk_mul_f32 v[18:19], v[72:73], v[72:73]
    v_pk_mul_f32 v[20:21], v[74:75], v[74:75]
    v_pk_mul_f32 v[22:23], v[76:77], v[76:77]
    v_pk_mul_f32 v[24:25], v[78:79], v[78:79]
    v_pk_fma_f32 v[18:19], v[18:19], v[26:27], s[84:85]
    v_pk_fma_f32 v[20:21], v[20:21], v[26:27], s[84:85]
    v_pk_fma_f32 v[22:23], v[22:23], v[26:27], s[84:85]
    v_pk_fma_f32 v[24:25], v[24:25], v[26:27], s[84:85]
    v_pk_mul_f32 v[18:19], v[18:19], v[72:73]
    v_pk_mul_f32 v[20:21], v[20:21], v[74:75]
    v_pk_mul_f32 v[22:23], v[22:23], v[76:77]
    v_pk_mul_f32 v[24:25], v[24:25], v[78:79]
    v_exp_f32 v18, v18
    v_exp_f32 v19, v19
    v_exp_f32 v20, v20
    v_exp_f32 v21, v21
    v_exp_f32 v22, v22
    v_exp_f32 v23, v23
    v_exp_f32 v24, v24
    v_exp_f32 v25, v25
    v_pk_add_f32 v[18:19], v[18:19], 1.0 op_sel_hi:[1,0]
    v_pk_add_f32 v[20:21], v[20:21], 1.0 op_sel_hi:[1,0]
    v_pk_add_f32 v[22:23], v[22:23], 1.0 op_sel_hi:[1,0]
    v_pk_add_f32 v[24:25], v[24:25], 1.0 op_sel_hi:[1,0]
    v_rcp_f32 v18, v18
    v_rcp_f32 v19, v19
    v_rcp_f32 v20, v20
    v_rcp_f32 v21, v21
    v_rcp_f32 v22, v22
    v_rcp_f32 v23, v23
    v_rcp_f32 v24, v24
    v_rcp_f32 v25, v25
    v_pk_mul_f32 v[72:73], v[72:73], v[18:19]
    v_pk_mul_f32 v[74:75], v[74:75], v[20:21]
    v_pk_mul_f32 v[76:77], v[76:77], v[22:23]
    v_pk_mul_f32 v[78:79], v[78:79], v[24:25]
    v_pk_mul_f32 v[62:63], v[64:65], v[64:65]
    v_pk_add_f32 v[60:61], v[64:65], v[66:67]
    v_pk_fma_f32 v[62:63], v[66:67], v[66:67], v[62:63]
    v_pk_add_f32 v[60:61], v[60:61], v[68:69]
    v_pk_fma_f32 v[62:63], v[68:69], v[68:69], v[62:63]
    v_pk_add_f32 v[60:61], v[60:61], v[70:71]
    v_pk_fma_f32 v[62:63], v[70:71], v[70:71], v[62:63]
    v_pk_add_f32 v[60:61], v[60:61], v[72:73]
    v_pk_fma_f32 v[62:63], v[72:73], v[72:73], v[62:63]
    v_pk_add_f32 v[60:61], v[60:61], v[74:75]
    v_pk_fma_f32 v[62:63], v[74:75], v[74:75], v[62:63]
    v_pk_add_f32 v[60:61], v[60:61], v[76:77]
    v_pk_fma_f32 v[62:63], v[76:77], v[76:77], v[62:63]
    v_pk_add_f32 v[60:61], v[60:61], v[78:79]
    v_pk_fma_f32 v[62:63], v[78:79], v[78:79], v[62:63]
    v_pk_mul_f32 v[18:19], v[80:81], v[80:81]
    v_pk_mul_f32 v[20:21], v[82:83], v[82:83]
    v_pk_mul_f32 v[22:23], v[84:85], v[84:85]
    v_pk_mul_f32 v[24:25], v[86:87], v[86:87]
    v_pk_fma_f32 v[18:19], v[18:19], v[26:27], s[84:85]
    v_pk_fma_f32 v[20:21], v[20:21], v[26:27], s[84:85]
    v_pk_fma_f32 v[22:23], v[22:23], v[26:27], s[84:85]
    v_pk_fma_f32 v[24:25], v[24:25], v[26:27], s[84:85]
    v_pk_mul_f32 v[18:19], v[18:19], v[80:81]
    v_pk_mul_f32 v[20:21], v[20:21], v[82:83]
    v_pk_mul_f32 v[22:23], v[22:23], v[84:85]
    v_pk_mul_f32 v[24:25], v[24:25], v[86:87]
    v_exp_f32 v18, v18
    v_exp_f32 v19, v19
    v_exp_f32 v20, v20
    v_exp_f32 v21, v21
    v_exp_f32 v22, v22
    v_exp_f32 v23, v23
    v_exp_f32 v24, v24
    v_exp_f32 v25, v25
    v_pk_add_f32 v[18:19], v[18:19], 1.0 op_sel_hi:[1,0]
    v_pk_add_f32 v[20:21], v[20:21], 1.0 op_sel_hi:[1,0]
    v_pk_add_f32 v[22:23], v[22:23], 1.0 op_sel_hi:[1,0]
    v_pk_add_f32 v[24:25], v[24:25], 1.0 op_sel_hi:[1,0]
    v_rcp_f32 v18, v18
    v_rcp_f32 v19, v19
    v_rcp_f32 v20, v20
    v_rcp_f32 v21, v21
    v_rcp_f32 v22, v22
    v_rcp_f32 v23, v23
    v_rcp_f32 v24, v24
    v_rcp_f32 v25, v25
    v_pk_mul_f32 v[80:81], v[80:81], v[18:19]
    v_pk_mul_f32 v[82:83], v[82:83], v[20:21]
    v_pk_mul_f32 v[84:85], v[84:85], v[22:23]
    v_pk_mul_f32 v[86:87], v[86:87], v[24:25]
    v_pk_mul_f32 v[18:19], v[88:89], v[88:89]
    v_pk_mul_f32 v[20:21], v[90:91], v[90:91]
    v_pk_mul_f32 v[22:23], v[92:93], v[92:93]
    v_pk_mul_f32 v[24:25], v[94:95], v[94:95]
    v_pk_fma_f32 v[18:19], v[18:19], v[26:27], s[84:85]
    v_pk_fma_f32 v[20:21], v[20:21], v[26:27], s[84:85]
    v_pk_fma_f32 v[22:23], v[22:23], v[26:27], s[84:85]
    v_pk_fma_f32 v[24:25], v[24:25], v[26:27], s[84:85]
    v_pk_mul_f32 v[18:19], v[18:19], v[88:89]
    v_pk_mul_f32 v[20:21], v[20:21], v[90:91]
    v_pk_mul_f32 v[22:23], v[22:23], v[92:93]
    v_pk_mul_f32 v[24:25], v[24:25], v[94:95]
    v_exp_f32 v18, v18
    v_exp_f32 v19, v19
    v_exp_f32 v20, v20
    v_exp_f32 v21, v21
    v_exp_f32 v22, v22
    v_exp_f32 v23, v23
    v_exp_f32 v24, v24
    v_exp_f32 v25, v25
    v_pk_add_f32 v[18:19], v[18:19], 1.0 op_sel_hi:[1,0]
    v_pk_add_f32 v[20:21], v[20:21], 1.0 op_sel_hi:[1,0]
    v_pk_add_f32 v[22:23], v[22:23], 1.0 op_sel_hi:[1,0]
    v_pk_add_f32 v[24:25], v[24:25], 1.0 op_sel_hi:[1,0]
    v_rcp_f32 v18, v18
    v_rcp_f32 v19, v19
    v_rcp_f32 v20, v20
    v_rcp_f32 v21, v21
    v_rcp_f32 v22, v22
    v_rcp_f32 v23, v23
    v_rcp_f32 v24, v24
    v_rcp_f32 v25, v25
    v_pk_mul_f32 v[88:89], v[88:89], v[18:19]
    v_pk_mul_f32 v[90:91], v[90:91], v[20:21]
    v_pk_mul_f32 v[92:93], v[92:93], v[22:23]
    v_pk_mul_f32 v[94:95], v[94:95], v[24:25]
    v_pk_add_f32 v[60:61], v[60:61], v[80:81]
    v_pk_fma_f32 v[62:63], v[80:81], v[80:81], v[62:63]
    v_pk_add_f32 v[60:61], v[60:61], v[82:83]
    v_pk_fma_f32 v[62:63], v[82:83], v[82:83], v[62:63]
    v_pk_add_f32 v[60:61], v[60:61], v[84:85]
    v_pk_fma_f32 v[62:63], v[84:85], v[84:85], v[62:63]
    v_pk_add_f32 v[60:61], v[60:61], v[86:87]
    v_pk_fma_f32 v[62:63], v[86:87], v[86:87], v[62:63]
    v_pk_add_f32 v[60:61], v[60:61], v[88:89]
    v_pk_fma_f32 v[62:63], v[88:89], v[88:89], v[62:63]
    v_pk_add_f32 v[60:61], v[60:61], v[90:91]
    v_pk_fma_f32 v[62:63], v[90:91], v[90:91], v[62:63]
    v_pk_add_f32 v[60:61], v[60:61], v[92:93]
    v_pk_fma_f32 v[62:63], v[92:93], v[92:93], v[62:63]
    v_pk_add_f32 v[60:61], v[60:61], v[94:95]
    v_pk_fma_f32 v[62:63], v[94:95], v[94:95], v[62:63]
    s_mov_b32 s88, 0
    s_waitcnt vmcnt(5)
    s_branch TG_22
TG_21:
    buffer_load_dword v30, v31, s[56:59], 0 offen sc1
    s_waitcnt vmcnt(0)
TG_22:
    v_readfirstlane_b32 s22, v30
    s_nop 0
    s_cmp_lg_u32 s22, 0
    s_cbranch_scc1 TG_23
    s_sleep 1
    s_add_u32 s88, s88, 1
    s_cmp_lt_u32 s88, 40000
    s_cbranch_scc1 TG_21
TG_23:
    v_add_f32 v28, v60, v61
    v_add_f32 v17, v62, v63
    v_add_f32 v5, v60, v61
    v_add_f32 v6, v62, v63
    v_mov_b32 v57, s22
    v_mov_b32 v59, s22
    v_permlane32_swap_b32 v28, v5
    v_permlane32_swap_b32 v17, v6
    v_add_f32 v56, v28, v5
    v_add_f32 v58, v17, v6
    v_and_b32 v5, 511, v2
    buffer_store_dwordx4 v[56:59], v5, s[52:55], s87 offen sc1
    s_bitcmp1_b32 0x306, s68
    s_cbranch_scc1 FK_ZU
    s_barrier
    s_or_b32 s71, s68, s66
    s_cmp_lg_u32 s71, 0
    s_cbranch_scc0 FK_GATE
    s_sleep 12
    s_branch FK_NOGATE
FK_ZU:
    s_waitcnt lgkmcnt(0)
    s_barrier
    ds_read_b64_tr_b16 v[32:33], v16 offset:32768
    ds_read_b64_tr_b16 v[34:35], v16 offset:33280
    ds_read_b64_tr_b16 v[36:37], v16 offset:34816
    ds_read_b64_tr_b16 v[38:39], v16 offset:35328
    ds_read_b64_tr_b16 v[40:41], v16 offset:36864
    ds_read_b64_tr_b16 v[42:43], v16 offset:37376
    ds_read_b64_tr_b16 v[44:45], v16 offset:38912
    ds_read_b64_tr_b16 v[46:47], v16 offset:39424
    ds_read_b64_tr_b16 v[48:49], v16 offset:40960
    ds_read_b64_tr_b16 v[50:51], v16 offset:41472
    s_waitcnt lgkmcnt(8)
    v_mfma_f32_32x32x16_bf16 v[96:111], v[32:35], v[128:131], 0
    ds_read_b64_tr_b16 v[52:53], v16 offset:43008
    ds_read_b64_tr_b16 v[54:55], v16 offset:43520
    s_waitcnt lgkmcnt(8)
    v_mfma_f32_32x32x16_bf16 v[96:111], v[36:39], v[132:135], v[96:111]
    ds_read_b64_tr_b16 v[32:33], v16 offset:45056
    ds_read_b64_tr_b16 v[34:35], v16 offset:45568
    s_waitcnt lgkmcnt(8)
    v_mfma_f32_32x32x16_bf16 v[96:111], v[40:43], v[136:139], v[96:111]
    ds_read_b64_tr_b16 v[36:37], v16 offset:47104
    ds_read_b64_tr_b16 v[38:39], v16 offset:47616
    s_waitcnt lgkmcnt(8)
    v_mfma_f32_32x32x16_bf16 v[96:111], v[44:47], v[140:143], v[96:111]
    ds_read_b64_tr_b16 v[40:41], v16 offset:49152
    ds_read_b64_tr_b16 v[42:43], v16 offset:49664
    s_waitcnt lgkmcnt(8)
    v_mfma_f32_32x32x16_bf16 v[96:111], v[48:51], v[144:147], v[96:111]
    ds_read_b64_tr_b16 v[44:45], v16 offset:51200
    ds_read_b64_tr_b16 v[46:47], v16 offset:51712
    s_waitcnt lgkmcnt(8)
    v_mfma_f32_32x32x16_bf16 v[96:111], v[52:55], v[148:151], v[96:111]
    ds_read_b64_tr_b16 v[48:49], v16 offset:53248
    ds_read_b64_tr_b16 v[50:51], v16 offset:53760
    s_waitcnt lgkmcnt(8)
    v_mfma_f32_32x32x16_bf16 v[96:111], v[32:35], v[152:155], v[96:111]
    ds_read_b64_tr_b16 v[52:53], v16 offset:55296
    ds_read_b64_tr_b16 v[54:55], v16 offset:55808
    s_waitcnt lgkmcnt(8)
    v_mfma_f32_32x32x16_bf16 v[96:111], v[36:39], v[156:159], v[96:111]
    ds_read_b64_tr_b16 v[32:33], v16 offset:57344
    ds_read_b64_tr_b16 v[34:35], v16 offset:57856
    s_waitcnt lgkmcnt(8)
    v_mfma_f32_32x32x16_bf16 v[96:111], v[40:43], v[160:163], v[96:111]
    ds_read_b64_tr_b16 v[36:37], v16 offset:59392
    ds_read_b64_tr_b16 v[38:39], v16 offset:59904
    s_waitcnt lgkmcnt(8)
    v_mfma_f32_32x32x16_bf16 v[96:111], v[44:47], v[164:167], v[96:111]
    ds_read_b64_tr_b16 v[40:41], v16 offset:61440
    ds_read_b64_tr_b16 v[42:43], v16 offset:61952
    s_waitcnt lgkmcnt(8)
    v_mfma_f32_32x32x16_bf16 v[96:111], v[48:51], v[168:171], v[96:111]
    ds_read_b64_tr_b16 v[44:45], v16 offset:63488
    ds_read_b64_tr_b16 v[46:47], v16 offset:64000
    s_waitcnt lgkmcnt(8)
    v_mfma_f32_32x32x16_bf16 v[96:111], v[52:55], v[172:175], v[96:111]
    s_waitcnt vmcnt(2) lgkmcnt(0)
    s_barrier
    v_add_u32 v16, 0x10000, v16
    ds_read_b64_tr_b16 v[48:49], v16 offset:0
    ds_read_b64_tr_b16 v[50:51], v16 offset:512
    v_mfma_f32_32x32x16_bf16 v[96:111], v[32:35], v[176:179], v[96:111]
    s_mul_i32 s86, s81, 7168
    s_add_u32 s86, s86, 0x1410000
    v_lshrrev_b32 v28, 5, v1
    v_mul_u32_u24 v28, 3072, v28
    v_add_u32 v28, v28, v2
    buffer_load_dwordx4 v[128:131], v28, s[52:55], s86 offen offset:0 sc1
    buffer_load_dwordx4 v[132:135], v28, s[52:55], s86 offen offset:512 sc1
    buffer_load_dwordx4 v[136:139], v28, s[52:55], s86 offen offset:1024 sc1
    buffer_load_dwordx4 v[140:143], v28, s[52:55], s86 offen offset:1536 sc1
    buffer_load_dwordx4 v[144:147], v28, s[52:55], s86 offen offset:2048 sc1
    buffer_load_dwordx4 v[148:151], v28, s[52:55], s86 offen offset:2560 sc1
    buffer_load_dwordx4 v[152:155], v28, s[52:55], s86 offen offset:3072 sc1
    ds_read_b64_tr_b16 v[52:53], v16 offset:2048
    ds_read_b64_tr_b16 v[54:55], v16 offset:2560
    v_mfma_f32_32x32x16_bf16 v[96:111], v[36:39], v[180:183], v[96:111]
    ds_read_b64_tr_b16 v[32:33], v16 offset:4096
    ds_read_b64_tr_b16 v[34:35], v16 offset:4608
    v_mfma_f32_32x32x16_bf16 v[96:111], v[40:43], v[184:187], v[96:111]
    ds_read_b64_tr_b16 v[36:37], v16 offset:6144
    ds_read_b64_tr_b16 v[38:39], v16 offset:6656
    v_mfma_f32_32x32x16_bf16 v[96:111], v[44:47], v[188:191], v[96:111]
    ds_read_b64_tr_b16 v[40:41], v16 offset:8192
    ds_read_b64_tr_b16 v[42:43], v16 offset:8704
    s_waitcnt lgkmcnt(8)
    v_mfma_f32_32x32x16_bf16 v[96:111], v[48:51], v[192:195], v[96:111]
    ds_read_b64_tr_b16 v[44:45], v16 offset:10240
    ds_read_b64_tr_b16 v[46:47], v16 offset:10752
    s_waitcnt lgkmcnt(8)
    v_mfma_f32_32x32x16_bf16 v[96:111], v[52:55], v[196:199], v[96:111]
    ds_read_b64_tr_b16 v[48:49], v16 offset:12288
    ds_read_b64_tr_b16 v[50:51], v16 offset:12800
    s_waitcnt lgkmcnt(8)
    v_mfma_f32_32x32x16_bf16 v[96:111], v[32:35], v[200:203], v[96:111]
    ds_read_b64_tr_b16 v[52:53], v16 offset:14336
    ds_read_b64_tr_b16 v[54:55], v16 offset:14848
    s_waitcnt lgkmcnt(8)
    v_mfma_f32_32x32x16_bf16 v[96:111], v[36:39], v[204:207], v[96:111]
    ds_read_b64_tr_b16 v[32:33], v16 offset:16384
    ds_read_b64_tr_b16 v[34:35], v16 offset:16896
    s_waitcnt lgkmcnt(8)
    v_mfma_f32_32x32x16_bf16 v[96:111], v[40:43], v[208:211], v[96:111]
    ds_read_b64_tr_b16 v[36:37], v16 offset:18432
    ds_read_b64_tr_b16 v[38:39], v16 offset:18944
    s_waitcnt lgkmcnt(8)
    v_mfma_f32_32x32x16_bf16 v[96:111], v[44:47], v[212:215], v[96:111]
    ds_read_b64_tr_b16 v[40:41], v16 offset:20480
    ds_read_b64_tr_b16 v[42:43], v16 offset:20992
    s_waitcnt lgkmcnt(8)
    v_mfma_f32_32x32x16_bf16 v[96:111], v[48:51], v[216:219], v[96:111]
    ds_read_b64_tr_b16 v[44:45], v16 offset:22528
    ds_read_b64_tr_b16 v[46:47], v16 offset:23040
    s_waitcnt lgkmcnt(8)
    v_mfma_f32_32x32x16_bf16 v[96:111], v[52:55], v[220:223], v[96:111]
    ds_read_b64_tr_b16 v[48:49], v16 offset:24576
    ds_read_b64_tr_b16 v[50:51], v16 offset:25088
    s_waitcnt lgkmcnt(8)
    v_mfma_f32_32x32x16_bf16 v[96:111], v[32:35], v[224:227], v[96:111]
    s_lshl_b32 s71, s66, 11
    s_add_u32 s71, s71, 65536
    v_add_u32 v8, s71, v2
    v_lshrrev_b32 v5, 5, v1
    v_and_b32 v6, 15, v1
    ds_read_b64_tr_b16 v[52:53], v16 offset:26624
    v_lshlrev_b32 v6, 4, v6
    v_lshl_add_u32 v6, v5, 8, v6
    s_add_u32 s71, s71, 4096
    v_add_u32 v9, s71, v6
    s_mov_b32 s98, 0xffff
    ds_read_b64_tr_b16 v[54:55], v16 offset:27136
    s_mov_b32 s99, 0xffff
    v_and_b32 v6, 31, v1
    v_bfe_u32 v7, v6, 1, 3
    v_xor_b32 v7, v7, v5
    v_lshlrev_b32 v7, 4, v7
    v_lshlrev_b32 v6, 7, v6
    s_waitcnt lgkmcnt(8)
    v_mfma_f32_32x32x16_bf16 v[96:111], v[36:39], v[228:231], v[96:111]
    s_lshl_b32 s71, s66, 13
    s_add_u32 s71, s71, 98304
    v_add3_u32 v12, v6, v7, s71
    v_xor_b32 v13, 32, v12
    v_xor_b32 v14, 64, v12
    ds_read_b64_tr_b16 v[32:33], v16 offset:28672
    v_xor_b32 v15, 96, v12
    v_lshrrev_b32 v5, 3, v1
    v_lshrrev_b32 v6, 4, v1
    v_and_b32 v7, 7, v1
    v_xor_b32 v7, v7, v6
    v_lshlrev_b32 v7, 4, v7
    ds_read_b64_tr_b16 v[34:35], v16 offset:29184
    s_lshl_b32 s71, s69, 6
    s_lshl_b32 s72, s65, 4
    s_lshl_b32 s73, s66, 5
    s_xor_b32 s72, s72, s73
    s_add_u32 s71, s71, s72
    s_waitcnt lgkmcnt(8)
    v_mfma_f32_32x32x16_bf16 v[96:111], v[40:43], v[232:235], v[96:111]
    v_add_u32 v5, s71, v5
    v_lshlrev_b32 v5, 12, v5
    s_lshl_b32 s71, s66, 11
    v_add3_u32 v10, v5, v7, s71
    v_xor_b32 v11, 64, v10
    v_add_u32 v11, 32768, v11
    ds_read_b64_tr_b16 v[36:37], v16 offset:30720
    s_mov_b32 s94, 0
    s_lshl_b32 s71, s70, 2
    s_add_u32 s71, s71, s65
    s_lshl_b32 s71, s71, 1
    s_add_u32 s71, s71, s66
    ds_read_b64_tr_b16 v[38:39], v16 offset:31232
    s_lshl_b32 s71, s71, 16
    s_add_u32 s96, s71, 0xa00000
    v_and_b32 v5, 27, v1
    v_cmp_eq_u32 vcc, 16, v5
    v_mov_b32 v6, 0x3f803f80
    s_waitcnt lgkmcnt(8)
    v_mfma_f32_32x32x16_bf16 v[96:111], v[44:47], v[236:239], v[96:111]
    v_cndmask_b32 v6, 0, v6, vcc
    v_mov_b32 v208, v6
    v_mov_b32 v209, v6
    v_mov_b32 v210, v6
    v_mov_b32 v211, v6
    v_mov_b32 v212, v6
    s_waitcnt lgkmcnt(6)
    v_mfma_f32_32x32x16_bf16 v[96:111], v[48:51], v[240:243], v[96:111]
    v_mov_b32 v213, v6
    v_mov_b32 v214, v6
    v_mov_b32 v215, v6
    v_mov_b32 v216, v6
    v_mov_b32 v217, v6
    s_waitcnt lgkmcnt(4)
    v_mfma_f32_32x32x16_bf16 v[96:111], v[52:55], v[244:247], v[96:111]
    v_mov_b32 v218, v6
    v_mov_b32 v219, v6
    v_mov_b32 v220, v6
    v_mov_b32 v221, v6
    v_mov_b32 v222, v6
    v_mov_b32 v223, v6
    s_waitcnt lgkmcnt(2)
    v_mfma_f32_32x32x16_bf16 v[96:111], v[32:35], v[248:251], v[96:111]
    v_lshrrev_b32 v5, 3, v1
    v_bfe_u32 v6, v1, 4, 1
    v_lshlrev_b32 v6, 2, v6
    v_and_b32 v7, 7, v1
    v_xor_b32 v7, v7, v6
    s_waitcnt lgkmcnt(0)
    v_mfma_f32_32x32x16_bf16 v[96:111], v[36:39], v[252:255], v[96:111]
    v_lshlrev_b32 v7, 4, v7
    s_lshl_b32 s71, s64, 3
    v_add_u32 v5, s71, v5
    v_lshl_add_u32 v20, v5, 10, v7
    s_lshl_b32 s71, s70, 7
    v_add_u32 v20, s71, v20
    s_branch FK_ZC
FK_GATE:
    v_lshrrev_b32 v5, 5, v1
    v_lshlrev_b32 v5, 4, v5
    s_lshl_b32 s71, s65, 13
    s_add_u32 s71, s71, 7168
    v_add_u32 v5, s71, v5
    s_waitcnt vmcnt(1)
    ds_read_b128 v[48:51], v5 offset:0
    ds_read_b128 v[52:55], v5 offset:32
    ds_read_b128 v[96:99], v5 offset:64
    ds_read_b128 v[100:103], v5 offset:96
    ds_read_b128 v[104:107], v5 offset:128
    s_waitcnt lgkmcnt(4)
    v_mfma_f32_32x32x16_bf16 v[32:47], v[48:51], v[128:131], 0
    ds_read_b128 v[108:111], v5 offset:160
    s_waitcnt lgkmcnt(4)
    v_mfma_f32_32x32x16_bf16 v[32:47], v[52:55], v[132:135], v[32:47]
    ds_read_b128 v[48:51], v5 offset:192
    s_waitcnt lgkmcnt(4)
    v_mfma_f32_32x32x16_bf16 v[32:47], v[96:99], v[136:139], v[32:47]
    ds_read_b128 v[52:55], v5 offset:224
    s_waitcnt lgkmcnt(4)
    v_mfma_f32_32x32x16_bf16 v[32:47], v[100:103], v[140:143], v[32:47]
    ds_read_b128 v[96:99], v5 offset:256
    s_waitcnt lgkmcnt(4)
    v_mfma_f32_32x32x16_bf16 v[32:47], v[104:107], v[144:147], v[32:47]
    ds_read_b128 v[100:103], v5 offset:288
    s_waitcnt lgkmcnt(4)
    v_mfma_f32_32x32x16_bf16 v[32:47], v[108:111], v[148:151], v[32:47]
    ds_read_b128 v[104:107], v5 offset:320
    s_waitcnt lgkmcnt(4)
    v_mfma_f32_32x32x16_bf16 v[32:47], v[48:51], v[152:155], v[32:47]
    ds_read_b128 v[108:111], v5 offset:352
    s_waitcnt lgkmcnt(4)
    v_mfma_f32_32x32x16_bf16 v[32:47], v[52:55], v[156:159], v[32:47]
    ds_read_b128 v[48:51], v5 offset:384
    s_waitcnt lgkmcnt(4)
    v_mfma_f32_32x32x16_bf16 v[32:47], v[96:99], v[160:163], v[32:47]
    ds_read_b128 v[52:55], v5 offset:416
    s_waitcnt lgkmcnt(4)
    v_mfma_f32_32x32x16_bf16 v[32:47], v[100:103], v[164:167], v[32:47]
    ds_read_b128 v[96:99], v5 offset:448
    s_waitcnt lgkmcnt(4)
    v_mfma_f32_32x32x16_bf16 v[32:47], v[104:107], v[168:171], v[32:47]
    ds_read_b128 v[100:103], v5 offset:480
    s_waitcnt lgkmcnt(4)
    v_mfma_f32_32x32x16_bf16 v[32:47], v[108:111], v[172:175], v[32:47]
    ds_read_b128 v[104:107], v5 offset:512
    s_waitcnt lgkmcnt(4)
    v_mfma_f32_32x32x16_bf16 v[32:47], v[48:51], v[176:179], v[32:47]
    ds_read_b128 v[108:111], v5 offset:544
    s_waitcnt lgkmcnt(4)
    v_mfma_f32_32x32x16_bf16 v[32:47], v[52:55], v[180:183], v[32:47]
    ds_read_b128 v[48:51], v5 offset:576
    s_waitcnt lgkmcnt(4)
    v_mfma_f32_32x32x16_bf16 v[32:47], v[96:99], v[184:187], v[32:47]
    ds_read_b128 v[52:55], v5 offset:608
    s_waitcnt lgkmcnt(4)
    v_mfma_f32_32x32x16_bf16 v[32:47], v[100:103], v[188:191], v[32:47]
    ds_read_b128 v[96:99], v5 offset:640
    s_waitcnt lgkmcnt(4)
    v_mfma_f32_32x32x16_bf16 v[32:47], v[104:107], v[192:195], v[32:47]
    ds_read_b128 v[100:103], v5 offset:672
    s_waitcnt lgkmcnt(4)
    v_mfma_f32_32x32x16_bf16 v[32:47], v[108:111], v[196:199], v[32:47]
    ds_read_b128 v[104:107], v5 offset:704
    s_waitcnt lgkmcnt(4)
    v_mfma_f32_32x32x16_bf16 v[32:47], v[48:51], v[200:203], v[32:47]
    ds_read_b128 v[108:111], v5 offset:736
    s_waitcnt lgkmcnt(4)
    v_mfma_f32_32x32x16_bf16 v[32:47], v[52:55], v[204:207], v[32:47]
    ds_read_b128 v[48:51], v5 offset:768
    s_waitcnt lgkmcnt(4)
    v_mfma_f32_32x32x16_bf16 v[32:47], v[96:99], v[208:211], v[32:47]
    ds_read_b128 v[52:55], v5 offset:800
    s_waitcnt lgkmcnt(4)
    v_mfma_f32_32x32x16_bf16 v[32:47], v[100:103], v[212:215], v[32:47]
    ds_read_b128 v[96:99], v5 offset:832
    s_waitcnt lgkmcnt(4)
    v_mfma_f32_32x32x16_bf16 v[32:47], v[104:107], v[216:219], v[32:47]
    ds_read_b128 v[100:103], v5 offset:864
    s_waitcnt lgkmcnt(4)
    v_mfma_f32_32x32x16_bf16 v[32:47], v[108:111], v[220:223], v[32:47]
    ds_read_b128 v[104:107], v5 offset:896
    s_waitcnt lgkmcnt(4)
    v_mfma_f32_32x32x16_bf16 v[32:47], v[48:51], v[224:227], v[32:47]
    ds_read_b128 v[108:111], v5 offset:928
    s_waitcnt lgkmcnt(4)
    v_mfma_f32_32x32x16_bf16 v[32:47], v[52:55], v[228:231], v[32:47]
    ds_read_b128 v[48:51], v5 offset:960
    s_waitcnt lgkmcnt(4)
    v_mfma_f32_32x32x16_bf16 v[32:47], v[96:99], v[232:235], v[32:47]
    ds_read_b128 v[52:55], v5 offset:992
    s_waitcnt lgkmcnt(4)
    v_mfma_f32_32x32x16_bf16 v[32:47], v[100:103], v[236:239], v[32:47]
    s_waitcnt lgkmcnt(3)
    v_mfma_f32_32x32x16_bf16 v[32:47], v[104:107], v[240:243], v[32:47]
    s_waitcnt lgkmcnt(2)
    v_mfma_f32_32x32x16_bf16 v[32:47], v[108:111], v[244:247], v[32:47]
    s_waitcnt lgkmcnt(1)
    v_mfma_f32_32x32x16_bf16 v[32:47], v[48:51], v[248:251], v[32:47]
    s_waitcnt lgkmcnt(0)
    v_mfma_f32_32x32x16_bf16 v[32:47], v[52:55], v[252:255], v[32:47]
    s_nop 11
    v_mul_f32 v5, 0xbfb8aa3b, v32
    v_exp_f32 v5, v5
    s_nop 0
    v_add_f32 v5, 1.0, v5
    v_rcp_f32 v5, v5
    v_and_b32 v6, 31, v1
    v_lshlrev_b32 v6, 2, v6
    s_lshl_b32 s84, s81, 7
    s_add_u32 s84, s84, 0x1400000
    buffer_store_dword v5, v6, s[52:55], s84 offen sc1
FK_NOGATE:
    s_lshl_b32 s71, s66, 11
    s_add_u32 s71, s71, 65536
    v_add_u32 v8, s71, v2
    v_lshrrev_b32 v5, 5, v1
    v_and_b32 v6, 15, v1
    v_lshlrev_b32 v6, 4, v6
    v_lshl_add_u32 v6, v5, 8, v6
    s_add_u32 s71, s71, 4096
    v_add_u32 v9, s71, v6
    s_mov_b32 s98, 0xffff
    s_mov_b32 s99, 0xffff
    v_and_b32 v6, 31, v1
    v_bfe_u32 v7, v6, 1, 3
    v_xor_b32 v7, v7, v5
    v_lshlrev_b32 v7, 4, v7
    v_lshlrev_b32 v6, 7, v6
    s_lshl_b32 s71, s66, 13
    s_add_u32 s71, s71, 98304
    v_add3_u32 v12, v6, v7, s71
    v_xor_b32 v13, 32, v12
    v_xor_b32 v14, 64, v12
    v_xor_b32 v15, 96, v12
    v_lshrrev_b32 v5, 3, v1
    v_lshrrev_b32 v6, 4, v1
    v_and_b32 v7, 7, v1
    v_xor_b32 v7, v7, v6
    v_lshlrev_b32 v7, 4, v7
    s_lshl_b32 s71, s69, 6
    s_lshl_b32 s72, s65, 4
    s_lshl_b32 s73, s66, 5
    s_xor_b32 s72, s72, s73
    s_add_u32 s71, s71, s72
    v_add_u32 v5, s71, v5
    v_lshlrev_b32 v5, 12, v5
    s_lshl_b32 s71, s66, 11
    v_add3_u32 v10, v5, v7, s71
    v_xor_b32 v11, 64, v10
    v_add_u32 v11, 32768, v11
    s_mov_b32 s94, 0
    s_lshl_b32 s71, s70, 2
    s_add_u32 s71, s71, s65
    s_lshl_b32 s71, s71, 1
    s_add_u32 s71, s71, s66
    s_lshl_b32 s71, s71, 16
    s_add_u32 s96, s71, 0xa00000
    v_and_b32 v5, 27, v1
    v_cmp_eq_u32 vcc, 16, v5
    v_mov_b32 v6, 0x3f803f80
    s_nop 0
    v_cndmask_b32 v6, 0, v6, vcc
    v_mov_b32 v208, v6
    v_mov_b32 v209, v6
    v_mov_b32 v210, v6
    v_mov_b32 v211, v6
    v_mov_b32 v212, v6
    v_mov_b32 v213, v6
    v_mov_b32 v214, v6
    v_mov_b32 v215, v6
    v_mov_b32 v216, v6
    v_mov_b32 v217, v6
    v_mov_b32 v218, v6
    s_mul_i32 s86, s81, 7168
    s_add_u32 s86, s86, 0x1410000
    v_lshrrev_b32 v28, 5, v1
    v_mul_u32_u24 v28, 3072, v28
    v_add_u32 v28, v28, v2
    buffer_load_dwordx4 v[128:131], v28, s[52:55], s86 offen offset:0 sc1
    buffer_load_dwordx4 v[132:135], v28, s[52:55], s86 offen offset:512 sc1
    buffer_load_dwordx4 v[136:139], v28, s[52:55], s86 offen offset:1024 sc1
    buffer_load_dwordx4 v[140:143], v28, s[52:55], s86 offen offset:1536 sc1
    buffer_load_dwordx4 v[144:147], v28, s[52:55], s86 offen offset:2048 sc1
    buffer_load_dwordx4 v[148:151], v28, s[52:55], s86 offen offset:2560 sc1
    buffer_load_dwordx4 v[152:155], v28, s[52:55], s86 offen offset:3072 sc1
    v_mov_b32 v219, v6
    v_mov_b32 v220, v6
    v_mov_b32 v221, v6
    v_mov_b32 v222, v6
    v_mov_b32 v223, v6
    v_lshrrev_b32 v5, 3, v1
    v_bfe_u32 v6, v1, 4, 1
    v_lshlrev_b32 v6, 2, v6
    v_and_b32 v7, 7, v1
    v_xor_b32 v7, v7, v6
    v_lshlrev_b32 v7, 4, v7
    s_lshl_b32 s71, s64, 3
    v_add_u32 v5, s71, v5
    v_lshl_add_u32 v20, v5, 10, v7
    s_lshl_b32 s71, s70, 7
    v_add_u32 v20, s71, v20
FK_ZC:
    v_and_b32 v54, 31, v1
    v_lshrrev_b32 v6, 5, v1
    v_mul_u32_u24 v54, 72, v54
    v_lshl_add_u32 v54, v6, 3, v54
    s_lshl_b32 s71, s64, 13
    v_add_u32 v54, s71, v54
    v_bfe_u32 v55, v1, 2, 2
    v_lshl_add_u32 v55, v6, 3, v55
    v_mul_u32_u24 v55, 72, v55
    v_bfe_u32 v6, v1, 4, 1
    v_lshl_add_u32 v55, v6, 5, v55
    v_and_b32 v6, 3, v1
    v_lshl_add_u32 v55, v6, 3, v55
    v_add_u32 v55, s71, v55
    s_lshl_b32 s84, s97, 7
    s_lshl_b32 s85, s81, 1
    s_add_u32 s84, s84, s85
    s_lshl_b32 s84, s84, 10
    s_add_u32 s84, s84, 0xa00000
    s_add_u32 s85, s84, 262144
    s_mov_b32 s88, 0
    s_waitcnt vmcnt(0)
    s_branch NC_25
NL_24:
    v_and_b32 v7, 15, v1
    v_min_u32 v7, 13, v7
    v_lshlrev_b32 v7, 9, v7
    s_sleep 2
    buffer_load_dword v6, v7, s[52:55], s86 offen offset:500 sc1
    s_add_u32 s88, s88, 1
    s_cmp_ge_u32 s88, 40000
    s_cbranch_scc1 ND_26
    s_waitcnt vmcnt(0)
    v_cmp_ne_u32 vcc, s22, v6
    s_nop 0
    s_cmp_lg_u64 vcc, 0
    s_cbranch_scc1 NL_24
    s_mul_i32 s86, s81, 7168
    s_add_u32 s86, s86, 0x1410000
    v_lshrrev_b32 v28, 5, v1
    v_mul_u32_u24 v28, 3072, v28
    v_add_u32 v28, v28, v2
    buffer_load_dwordx4 v[128:131], v28, s[52:55], s86 offen offset:0 sc1
    buffer_load_dwordx4 v[132:135], v28, s[52:55], s86 offen offset:512 sc1
    buffer_load_dwordx4 v[136:139], v28, s[52:55], s86 offen offset:1024 sc1
    buffer_load_dwordx4 v[140:143], v28, s[52:55], s86 offen offset:1536 sc1
    buffer_load_dwordx4 v[144:147], v28, s[52:55], s86 offen offset:2048 sc1
    buffer_load_dwordx4 v[148:151], v28, s[52:55], s86 offen offset:2560 sc1
    buffer_load_dwordx4 v[152:155], v28, s[52:55], s86 offen offset:3072 sc1
    s_waitcnt vmcnt(0)
NC_25:
    v_max3_u32 v6, v129, v131, s22
    v_min3_u32 v7, v129, v131, s22
    v_max3_u32 v6, v6, v133, v135
    v_min3_u32 v7, v7, v133, v135
    v_max3_u32 v6, v6, v137, v139
    v_min3_u32 v7, v7, v137, v139
    v_max3_u32 v6, v6, v141, v143
    v_min3_u32 v7, v7, v141, v143
    v_max3_u32 v6, v6, v145, v147
    v_min3_u32 v7, v7, v145, v147
    v_max3_u32 v6, v6, v149, v151
    v_min3_u32 v7, v7, v149, v151
    v_max3_u32 v6, v6, v153, v155
    v_min3_u32 v7, v7, v153, v155
    v_cmp_ne_u32 vcc, v6, v7
    s_nop 0
    s_cmp_eq_u64 vcc, 0
    s_cbranch_scc1 ND_26
    s_sleep 1
    s_add_u32 s88, s88, 1
    s_cmp_lt_u32 s88, 40000
    s_cbranch_scc1 NL_24
ND_26:
    s_cmp_lg_u32 s64, 0
    s_cbranch_scc1 EI_27
    s_lshl_b32 s71, s16, 7
    s_add_u32 s71, s71, 0x1500000
    v_lshlrev_b32 v31, 2, v1
    v_add_u32 v31, s71, v31
    s_lshl_b32 s72, s17, 3
    s_add_u32 s71, s71, s72
    s_add_u32 s71, s71, 4096
    s_mov_b32 exec_lo, 0
    v_and_b32 v31, 4, v31
    v_add_u32 v31, s71, v31
    s_mov_b32 exec_lo, -1
    buffer_load_dword v30, v31, s[52:55], 0 offen sc1
EI_27:
    v_add_f32 v48, v128, v132
    v_add_f32 v50, v130, v134
    v_add_f32 v49, v136, v140
    v_add_f32 v51, v138, v142
    v_add_f32 v48, v48, v144
    v_add_f32 v50, v50, v146
    v_add_f32 v49, v49, v148
    v_add_f32 v51, v51, v150
    v_add_f32 v48, v48, v152
    v_add_f32 v50, v50, v154
    v_add_f32 v48, v48, v49
    v_add_f32 v50, v50, v51
    v_mov_b32 v49, v48
    v_mov_b32 v51, v50
    s_nop 0
    v_permlane32_swap_b32 v48, v49
    v_permlane32_swap_b32 v50, v51
    v_add_f32 v48, v48, v49
    v_add_f32 v50, v50, v51
    v_mul_f32 v48, 0x3a924925, v48
    v_mul_f32 v50, 0x3a924925, v50
    v_fma_f32 v50, -v48, v48, v50
    v_max_f32 v50, 0, v50
    v_add_f32 v50, 0x3727c5ac, v50
    v_rsq_f32 v52, v50
    s_nop 0
    v_mul_f32 v53, -v48, v52
    v_fma_f32 v64, v64, v52, v53
    v_fma_f32 v65, v65, v52, v53
    v_fma_f32 v66, v66, v52, v53
    v_fma_f32 v67, v67, v52, v53
    v_fma_f32 v68, v68, v52, v53
    v_fma_f32 v69, v69, v52, v53
    v_fma_f32 v70, v70, v52, v53
    v_fma_f32 v71, v71, v52, v53
    v_fma_f32 v72, v72, v52, v53
    v_fma_f32 v73, v73, v52, v53
    v_fma_f32 v74, v74, v52, v53
    v_fma_f32 v75, v75, v52, v53
    v_fma_f32 v76, v76, v52, v53
    v_fma_f32 v77, v77, v52, v53
    v_fma_f32 v78, v78, v52, v53
    v_fma_f32 v79, v79, v52, v53
    v_cvt_pk_bf16_f32 v128, v64, v65
    v_cvt_pk_bf16_f32 v129, v66, v67
    v_cvt_pk_bf16_f32 v130, v68, v69
    v_cvt_pk_bf16_f32 v131, v70, v71
    v_cvt_pk_bf16_f32 v132, v72, v73
    v_cvt_pk_bf16_f32 v133, v74, v75
    v_cvt_pk_bf16_f32 v134, v76, v77
    v_cvt_pk_bf16_f32 v135, v78, v79
    ds_write_b64 v54, v[128:129] offset:0
    ds_write_b64 v54, v[130:131] offset:16
    ds_write_b64 v54, v[132:133] offset:32
    ds_write_b64 v54, v[134:135] offset:48
    v_fma_f32 v80, v80, v52, v53
    v_fma_f32 v81, v81, v52, v53
    v_fma_f32 v82, v82, v52, v53
    v_fma_f32 v83, v83, v52, v53
    v_fma_f32 v84, v84, v52, v53
    v_fma_f32 v85, v85, v52, v53
    v_fma_f32 v86, v86, v52, v53
    v_fma_f32 v87, v87, v52, v53
    v_fma_f32 v88, v88, v52, v53
    v_fma_f32 v89, v89, v52, v53
    v_fma_f32 v90, v90, v52, v53
    v_fma_f32 v91, v91, v52, v53
    v_fma_f32 v92, v92, v52, v53
    v_fma_f32 v93, v93, v52, v53
    v_fma_f32 v94, v94, v52, v53
    v_fma_f32 v95, v95, v52, v53
    v_cvt_pk_bf16_f32 v136, v80, v81
    v_cvt_pk_bf16_f32 v137, v82, v83
    v_cvt_pk_bf16_f32 v138, v84, v85
    v_cvt_pk_bf16_f32 v139, v86, v87
    v_cvt_pk_bf16_f32 v140, v88, v89
    v_cvt_pk_bf16_f32 v141, v90, v91
    v_cvt_pk_bf16_f32 v142, v92, v93
    v_cvt_pk_bf16_f32 v143, v94, v95
    ds_write_b64 v54, v[136:137] offset:2304
    ds_write_b64 v54, v[138:139] offset:2320
    ds_write_b64 v54, v[140:141] offset:2336
    ds_write_b64 v54, v[142:143] offset:2352
    s_waitcnt lgkmcnt(4)
    ds_read_b64_tr_b16 v[192:193], v55 offset:0
    ds_read_b64_tr_b16 v[194:195], v55 offset:288
    ds_read_b64_tr_b16 v[196:197], v55 offset:1152
    ds_read_b64_tr_b16 v[198:199], v55 offset:1440
    s_waitcnt lgkmcnt(4)
    ds_read_b64_tr_b16 v[200:201], v55 offset:2304
    ds_read_b64_tr_b16 v[202:203], v55 offset:2592
    ds_read_b64_tr_b16 v[204:205], v55 offset:3456
    ds_read_b64_tr_b16 v[206:207], v55 offset:3744
    s_waitcnt lgkmcnt(6)
    buffer_store_dwordx4 v[192:195], v2, s[52:55], s84 offen offset:0 sc1
    s_waitcnt lgkmcnt(4)
    buffer_store_dwordx4 v[196:199], v2, s[52:55], s84 offen offset:1024 sc1
    s_waitcnt lgkmcnt(2)
    buffer_store_dwordx4 v[200:203], v2, s[52:55], s85 offen offset:0 sc1
    s_waitcnt lgkmcnt(0)
    buffer_store_dwordx4 v[204:207], v2, s[52:55], s85 offen offset:1024 sc1
    s_cmp_lg_u32 s64, 0
    s_cbranch_scc1 EN_31
    s_mov_b32 s88, 0
    s_waitcnt vmcnt(4)
    s_branch PC_29
PL_28:
    buffer_load_dword v30, v31, s[52:55], 0 offen sc1
    s_waitcnt vmcnt(0)
PC_29:
    v_cmp_ne_u32 vcc, s22, v30
    s_nop 0
    s_and_b32 vcc_lo, vcc_lo, 0x03030303
    s_cmp_eq_u64 vcc, 0
    s_cbranch_scc1 PD_30
    s_sleep 1
    s_add_u32 s88, s88, 1
    s_cmp_lt_u32 s88, 40000
    s_cbranch_scc1 PL_28
PD_30:
EN_31:
    s_barrier
    s_add_u32 m0, s91, 0x0
    s_nop 0
    buffer_load_dwordx4 v29, s[52:55], s95 offen sc1 lds
    s_add_u32 s95, s95, 2048
    s_lshl_b32 s90, s17, 3
    s_lshl_b32 s71, s65, 1
    s_add_u32 s90, s90, s71
    s_add_u32 s90, s90, s66
    s_lshl_b32 s71, s16, 16
    s_lshl_b32 s72, s90, 10
    s_add_u32 s75, s71, s72
    s_xor_b32 s76, s75, 1024
    s_add_u32 m0, s91, 0x2000
    s_nop 0
    buffer_load_dwordx4 v29, s[52:55], s95 offen sc1 lds
    s_add_u32 s95, s95, 2048
    s_xor_b32 s91, s91, 16384
    s_add_u32 m0, s91, 0x0
    s_nop 0
    buffer_load_dwordx4 v29, s[52:55], s95 offen sc1 lds
    s_add_u32 s95, s95, 2048
    s_mov_b32 s40, s28
    s_mov_b32 s41, s29
    s_mov_b32 s42, 0x1000
    s_mov_b32 s43, 0x00020000
    s_mov_b32 s4, s30
    s_mov_b32 s5, s31
    s_mov_b32 s6, 0xe0000
    s_mov_b32 s7, 0x00020000
    s_mov_b32 s8, s20
    s_mov_b32 s9, s21
    s_mov_b32 s10, 0x80000
    s_mov_b32 s11, 0x00020000
    s_mov_b32 s12, s34
    s_mov_b32 s13, s35
    s_mov_b32 s14, 0x200000
    s_mov_b32 s15, 0x00020000
    s_bitcmp1_b32 0x306, s68
    s_cbranch_scc0 FK_ZV1
    s_mov_b32 s86, 0xc0135761
    s_mov_b32 s87, 0xc0135761
    v_mov_b32 v27, 0xbdd2d3e8
    s_lshr_b32 s84, s78, 6
    s_add_u32 s84, s84, s66
    s_mul_i32 s85, s81, 28
    s_add_u32 s84, s84, s85
    s_lshl_b32 s84, s84, 11
    s_add_u32 s84, s84, 0x600000
    v_pk_mul_f32 v[32:33], v[96:97], v[96:97]
    v_pk_mul_f32 v[34:35], v[98:99], v[98:99]
    v_pk_mul_f32 v[36:37], v[100:101], v[100:101]
    v_pk_mul_f32 v[38:39], v[102:103], v[102:103]
    v_pk_fma_f32 v[32:33], v[32:33], v[26:27], s[86:87]
    v_pk_fma_f32 v[34:35], v[34:35], v[26:27], s[86:87]
    v_pk_fma_f32 v[36:37], v[36:37], v[26:27], s[86:87]
    v_pk_fma_f32 v[38:39], v[38:39], v[26:27], s[86:87]
    v_pk_mul_f32 v[32:33], v[32:33], v[96:97]
    v_pk_mul_f32 v[34:35], v[34:35], v[98:99]
    v_pk_mul_f32 v[36:37], v[36:37], v[100:101]
    v_pk_mul_f32 v[38:39], v[38:39], v[102:103]
    v_exp_f32 v32, v32
    v_exp_f32 v33, v33
    v_exp_f32 v34, v34
    s_branch FK_ZV0
FK_ZV1:
    s_sleep 5
FK_ZV0:
    buffer_load_dwordx4 v[112:115], v2, s[52:55], s76 offen sc1
    buffer_load_dwordx4 v[116:119], v2, s[52:55], s75 offen sc1
    s_bitcmp1_b32 0x306, s68
    s_cbranch_scc0 FK_ZV
    v_exp_f32 v35, v35
    v_exp_f32 v36, v36
    v_exp_f32 v37, v37
    v_exp_f32 v38, v38
    v_exp_f32 v39, v39
    v_pk_add_f32 v[32:33], v[32:33], 1.0 op_sel_hi:[1,0]
    v_pk_add_f32 v[34:35], v[34:35], 1.0 op_sel_hi:[1,0]
    v_pk_add_f32 v[36:37], v[36:37], 1.0 op_sel_hi:[1,0]
    v_pk_add_f32 v[38:39], v[38:39], 1.0 op_sel_hi:[1,0]
    v_rcp_f32 v32, v32
    v_rcp_f32 v33, v33
    v_rcp_f32 v34, v34
    v_rcp_f32 v35, v35
    v_rcp_f32 v36, v36
    v_rcp_f32 v37, v37
    v_rcp_f32 v38, v38
    v_rcp_f32 v39, v39
    v_pk_mul_f32 v[96:97], v[96:97], v[32:33]
    v_pk_mul_f32 v[98:99], v[98:99], v[34:35]
    v_pk_mul_f32 v[100:101], v[100:101], v[36:37]
    v_pk_mul_f32 v[102:103], v[102:103], v[38:39]
    v_pk_mul_f32 v[32:33], v[104:105], v[104:105]
    v_pk_mul_f32 v[34:35], v[106:107], v[106:107]
    v_pk_mul_f32 v[36:37], v[108:109], v[108:109]
    v_pk_mul_f32 v[38:39], v[110:111], v[110:111]
    v_pk_fma_f32 v[32:33], v[32:33], v[26:27], s[86:87]
    v_pk_fma_f32 v[34:35], v[34:35], v[26:27], s[86:87]
    v_pk_fma_f32 v[36:37], v[36:37], v[26:27], s[86:87]
    v_pk_fma_f32 v[38:39], v[38:39], v[26:27], s[86:87]
    v_pk_mul_f32 v[32:33], v[32:33], v[104:105]
    v_pk_mul_f32 v[34:35], v[34:35], v[106:107]
    v_pk_mul_f32 v[36:37], v[36:37], v[108:109]
    v_pk_mul_f32 v[38:39], v[38:39], v[110:111]
    v_exp_f32 v32, v32
    v_exp_f32 v33, v33
    v_exp_f32 v34, v34
    v_exp_f32 v35, v35
    v_exp_f32 v36, v36
    v_exp_f32 v37, v37
    v_exp_f32 v38, v38
    v_exp_f32 v39, v39
    v_pk_add_f32 v[32:33], v[32:33], 1.0 op_sel_hi:[1,0]
    v_pk_add_f32 v[34:35], v[34:35], 1.0 op_sel_hi:[1,0]
    v_pk_add_f32 v[36:37], v[36:37], 1.0 op_sel_hi:[1,0]
    v_pk_add_f32 v[38:39], v[38:39], 1.0 op_sel_hi:[1,0]
    v_rcp_f32 v32, v32
    v_rcp_f32 v33, v33
    v_rcp_f32 v34, v34
    v_rcp_f32 v35, v35
    v_rcp_f32 v36, v36
    v_rcp_f32 v37, v37
    v_rcp_f32 v38, v38
    v_rcp_f32 v39, v39
    v_pk_mul_f32 v[104:105], v[104:105], v[32:33]
    v_pk_mul_f32 v[106:107], v[106:107], v[34:35]
    v_pk_mul_f32 v[108:109], v[108:109], v[36:37]
    v_pk_mul_f32 v[110:111], v[110:111], v[38:39]
    v_cvt_pk_bf16_f32 v56, v96, v97
    v_cvt_pk_bf16_f32 v57, v98, v99
    v_cvt_pk_bf16_f32 v58, v100, v101
    v_cvt_pk_bf16_f32 v59, v102, v103
    v_cvt_pk_bf16_f32 v60, v104, v105
    v_cvt_pk_bf16_f32 v61, v106, v107
    v_cvt_pk_bf16_f32 v62, v108, v109
    v_cvt_pk_bf16_f32 v63, v110, v111
    buffer_store_dwordx4 v[56:59], v2, s[52:55], s84 offen offset:0 sc1
    buffer_store_dwordx4 v[60:63], v2, s[52:55], s84 offen offset:1024 sc1
    s_waitcnt vmcnt(2)
    s_branch FK_ENTRY_B
FK_ZV:
    s_waitcnt vmcnt(0)
    s_branch FK_ENTRY_B
FK_R4:
    s_lshr_b32 s84, s78, 6
    s_add_u32 s84, s84, s66
    s_mul_i32 s85, s81, 28
    s_add_u32 s84, s84, s85
    s_lshl_b32 s84, s84, 11
    s_add_u32 s84, s84, 0x600000
    s_nop 1
    v_mul_f32 v18, v96, v96
    v_mul_f32 v19, v97, v97
    v_mul_f32 v20, v98, v98
    v_mul_f32 v21, v99, v99
    v_mul_f32 v22, v100, v100
    v_mul_f32 v23, v101, v101
    v_mul_f32 v24, v102, v102
    v_mul_f32 v25, v103, v103
    v_fmaak_f32 v18, v26, v18, 0xc0135761
    v_fmaak_f32 v19, v26, v19, 0xc0135761
    v_fmaak_f32 v20, v26, v20, 0xc0135761
    v_fmaak_f32 v21, v26, v21, 0xc0135761
    v_fmaak_f32 v22, v26, v22, 0xc0135761
    v_fmaak_f32 v23, v26, v23, 0xc0135761
    v_fmaak_f32 v24, v26, v24, 0xc0135761
    v_fmaak_f32 v25, v26, v25, 0xc0135761
    v_mul_f32 v18, v18, v96
    v_mul_f32 v19, v19, v97
    v_mul_f32 v20, v20, v98
    v_mul_f32 v21, v21, v99
    v_mul_f32 v22, v22, v100
    v_mul_f32 v23, v23, v101
    v_mul_f32 v24, v24, v102
    v_mul_f32 v25, v25, v103
    v_exp_f32 v18, v18
    v_exp_f32 v19, v19
    v_exp_f32 v20, v20
    v_exp_f32 v21, v21
    v_exp_f32 v22, v22
    v_exp_f32 v23, v23
    v_exp_f32 v24, v24
    v_exp_f32 v25, v25
    v_add_f32 v18, 1.0, v18
    v_add_f32 v19, 1.0, v19
    v_add_f32 v20, 1.0, v20
    v_add_f32 v21, 1.0, v21
    v_add_f32 v22, 1.0, v22
    v_add_f32 v23, 1.0, v23
    v_add_f32 v24, 1.0, v24
    v_add_f32 v25, 1.0, v25
    v_rcp_f32 v18, v18
    v_rcp_f32 v19, v19
    v_rcp_f32 v20, v20
    v_rcp_f32 v21, v21
    v_rcp_f32 v22, v22
    v_rcp_f32 v23, v23
    v_rcp_f32 v24, v24
    v_rcp_f32 v25, v25
    v_mul_f32 v96, v96, v18
    v_mul_f32 v97, v97, v19
    v_mul_f32 v98, v98, v20
    v_mul_f32 v99, v99, v21
    v_mul_f32 v100, v100, v22
    v_mul_f32 v101, v101, v23
    v_mul_f32 v102, v102, v24
    v_mul_f32 v103, v103, v25
    v_mul_f32 v18, v104, v104
    v_mul_f32 v19, v105, v105
    s_cmp_lg_u32 s64, 0
    s_cbranch_scc1 EI_32
    s_lshl_b32 s71, s16, 7
    s_add_u32 s71, s71, 0x1500000
    v_lshlrev_b32 v31, 2, v1
    v_add_u32 v31, s71, v31
    s_lshl_b32 s72, s17, 3
    s_add_u32 s71, s71, s72
    s_add_u32 s71, s71, 4096
    s_mov_b32 exec_lo, 0
    v_and_b32 v31, 4, v31
    v_add_u32 v31, s71, v31
    s_mov_b32 exec_lo, -1
    buffer_load_dword v30, v31, s[52:55], 0 offen sc1
EI_32:
    v_mul_f32 v20, v106, v106
    v_mul_f32 v21, v107, v107
    v_mul_f32 v22, v108, v108
    v_mul_f32 v23, v109, v109
    v_mul_f32 v24, v110, v110
    v_mul_f32 v25, v111, v111
    v_fmaak_f32 v18, v26, v18, 0xc0135761
    v_fmaak_f32 v19, v26, v19, 0xc0135761
    v_fmaak_f32 v20, v26, v20, 0xc0135761
    v_fmaak_f32 v21, v26, v21, 0xc0135761
    v_fmaak_f32 v22, v26, v22, 0xc0135761
    v_fmaak_f32 v23, v26, v23, 0xc0135761
    v_fmaak_f32 v24, v26, v24, 0xc0135761
    v_fmaak_f32 v25, v26, v25, 0xc0135761
    v_mul_f32 v18, v18, v104
    v_mul_f32 v19, v19, v105
    v_mul_f32 v20, v20, v106
    v_mul_f32 v21, v21, v107
    v_mul_f32 v22, v22, v108
    v_mul_f32 v23, v23, v109
    v_mul_f32 v24, v24, v110
    v_mul_f32 v25, v25, v111
    v_exp_f32 v18, v18
    v_exp_f32 v19, v19
    v_exp_f32 v20, v20
    v_exp_f32 v21, v21
    v_exp_f32 v22, v22
    v_exp_f32 v23, v23
    v_exp_f32 v24, v24
    v_exp_f32 v25, v25
    v_add_f32 v18, 1.0, v18
    v_add_f32 v19, 1.0, v19
    v_add_f32 v20, 1.0, v20
    v_add_f32 v21, 1.0, v21
    v_add_f32 v22, 1.0, v22
    v_add_f32 v23, 1.0, v23
    v_add_f32 v24, 1.0, v24
    v_add_f32 v25, 1.0, v25
    v_rcp_f32 v18, v18
    v_rcp_f32 v19, v19
    v_rcp_f32 v20, v20
    v_rcp_f32 v21, v21
    v_rcp_f32 v22, v22
    v_rcp_f32 v23, v23
    v_rcp_f32 v24, v24
    v_rcp_f32 v25, v25
    v_mul_f32 v104, v104, v18
    v_mul_f32 v105, v105, v19
    v_mul_f32 v106, v106, v20
    v_mul_f32 v107, v107, v21
    v_mul_f32 v108, v108, v22
    v_mul_f32 v109, v109, v23
    v_mul_f32 v110, v110, v24
    v_mul_f32 v111, v111, v25
    v_cvt_pk_bf16_f32 v56, v96, v97
    v_cvt_pk_bf16_f32 v57, v98, v99
    v_cvt_pk_bf16_f32 v58, v100, v101
    v_cvt_pk_bf16_f32 v59, v102, v103
    v_cvt_pk_bf16_f32 v60, v104, v105
    v_cvt_pk_bf16_f32 v61, v106, v107
    v_cvt_pk_bf16_f32 v62, v108, v109
    v_cvt_pk_bf16_f32 v63, v110, v111
    buffer_store_dwordx4 v[56:59], v2, s[52:55], s84 offen offset:0 sc1
    buffer_store_dwordx4 v[60:63], v2, s[52:55], s84 offen offset:1024 sc1
    s_cmp_lg_u32 s64, 0
    s_cbranch_scc1 EN_36
    s_mov_b32 s88, 0
    s_waitcnt vmcnt(2)
    s_branch PC_34
PL_33:
    buffer_load_dword v30, v31, s[52:55], 0 offen sc1
    s_waitcnt vmcnt(0)
PC_34:
    v_cmp_ne_u32 vcc, s22, v30
    s_nop 0
    s_and_b32 vcc_lo, vcc_lo, 0x03030303
    s_cmp_eq_u64 vcc, 0
    s_cbranch_scc1 PD_35
    s_sleep 1
    s_add_u32 s88, s88, 1
    s_cmp_lt_u32 s88, 40000
    s_cbranch_scc1 PL_33
PD_35:
EN_36:
    s_barrier
    s_add_u32 m0, s91, 0x0
    s_nop 0
    buffer_load_dwordx4 v29, s[52:55], s95 offen sc1 lds
    s_add_u32 s95, s95, 2048
    s_lshl_b32 s90, s17, 3
    s_lshl_b32 s71, s65, 1
    s_add_u32 s90, s90, s71
    s_add_u32 s90, s90, s66
    s_lshl_b32 s71, s16, 16
    s_lshl_b32 s72, s90, 10
    s_add_u32 s75, s71, s72
    s_xor_b32 s76, s75, 1024
    s_add_u32 m0, s91, 0x2000
    s_nop 0
    buffer_load_dwordx4 v29, s[52:55], s95 offen sc1 lds
    s_add_u32 s95, s95, 2048
    s_xor_b32 s91, s91, 16384
    s_add_u32 m0, s91, 0x0
    s_nop 0
    buffer_load_dwordx4 v29, s[52:55], s95 offen sc1 lds
    s_add_u32 s95, s95, 2048
FK_ENTRY_A:
    s_lshl_b32 s71, s66, 11
    s_add_u32 s71, s71, 65536
    v_add_u32 v8, s71, v2
    v_lshrrev_b32 v5, 5, v1
    v_and_b32 v6, 15, v1
    v_lshlrev_b32 v6, 4, v6
    v_lshl_add_u32 v6, v5, 8, v6
    s_add_u32 s71, s71, 4096
    v_add_u32 v9, s71, v6
    s_mov_b32 s98, 0xffff
    s_mov_b32 s99, 0xffff
    v_and_b32 v6, 31, v1
    v_bfe_u32 v7, v6, 1, 3
    v_xor_b32 v7, v7, v5
    v_lshlrev_b32 v7, 4, v7
    v_lshlrev_b32 v6, 7, v6
    s_lshl_b32 s71, s66, 13
    s_add_u32 s71, s71, 98304
    v_add3_u32 v12, v6, v7, s71
    v_xor_b32 v13, 32, v12
    v_xor_b32 v14, 64, v12
    v_xor_b32 v15, 96, v12
    v_lshrrev_b32 v5, 3, v1
    v_lshrrev_b32 v6, 4, v1
    v_and_b32 v7, 7, v1
    v_xor_b32 v7, v7, v6
    v_lshlrev_b32 v7, 4, v7
    s_lshl_b32 s71, s69, 6
    s_lshl_b32 s72, s65, 4
    s_lshl_b32 s73, s66, 5
    s_xor_b32 s72, s72, s73
    s_add_u32 s71, s71, s72
    v_add_u32 v5, s71, v5
    v_lshlrev_b32 v5, 12, v5
    s_lshl_b32 s71, s66, 11
    v_add3_u32 v10, v5, v7, s71
    v_xor_b32 v11, 64, v10
    v_add_u32 v11, 32768, v11
    s_mov_b32 s94, 0
    s_lshl_b32 s71, s70, 2
    s_add_u32 s71, s71, s65
    s_lshl_b32 s71, s71, 1
    s_add_u32 s71, s71, s66
    s_lshl_b32 s71, s71, 16
    s_add_u32 s96, s71, 0xa00000
    v_and_b32 v5, 27, v1
    v_cmp_eq_u32 vcc, 16, v5
    v_mov_b32 v6, 0x3f803f80
    s_nop 0
    v_cndmask_b32 v6, 0, v6, vcc
    v_mov_b32 v208, v6
    v_mov_b32 v209, v6
    v_mov_b32 v210, v6
    v_mov_b32 v211, v6
    v_mov_b32 v212, v6
    v_mov_b32 v213, v6
    v_mov_b32 v214, v6
    v_mov_b32 v215, v6
    v_mov_b32 v216, v6
    v_mov_b32 v217, v6
    v_mov_b32 v218, v6
    v_mov_b32 v219, v6
    v_mov_b32 v220, v6
    v_mov_b32 v221, v6
    v_mov_b32 v222, v6
    v_mov_b32 v223, v6
    s_mov_b32 s40, s28
    s_mov_b32 s41, s29
    s_mov_b32 s42, 0x1000
    s_mov_b32 s43, 0x00020000
    s_mov_b32 s4, s30
    s_mov_b32 s5, s31
    s_mov_b32 s6, 0xe0000
    s_mov_b32 s7, 0x00020000
    s_mov_b32 s8, s20
    s_mov_b32 s9, s21
    s_mov_b32 s10, 0x80000
    s_mov_b32 s11, 0x00020000
    s_mov_b32 s12, s34
    s_mov_b32 s13, s35
    s_mov_b32 s14, 0x200000
    s_mov_b32 s15, 0x00020000
    v_lshrrev_b32 v5, 3, v1
    v_bfe_u32 v6, v1, 4, 1
    v_lshlrev_b32 v6, 2, v6
    v_and_b32 v7, 7, v1
    v_xor_b32 v7, v7, v6
    v_lshlrev_b32 v7, 4, v7
    s_lshl_b32 s71, s64, 3
    v_add_u32 v5, s71, v5
    v_lshl_add_u32 v20, v5, 10, v7
    s_lshl_b32 s71, s70, 7
    v_add_u32 v20, s71, v20
    buffer_load_dwordx4 v[112:115], v2, s[52:55], s76 offen sc1
    buffer_load_dwordx4 v[116:119], v2, s[52:55], s75 offen sc1
    s_waitcnt vmcnt(0)
FK_ENTRY_A2:
FK_ENTRY_B:
    v_add_u32 v24, 65536, v2
    s_barrier
    ds_read_b128 v[124:127], v24
    ds_read_b128 v[120:123], v8 offset:0
    s_mov_b64 exec, s[98:99]
    ds_read_b128 v[208:211], v9 offset:0
    ds_read_b128 v[212:215], v9 offset:512
    s_mov_b64 exec, -1
    s_cmp_lg_u32 s23, 0
    s_cbranch_scc1 FK_NOZF
    s_cmp_lg_u32 s64, 0
    s_cbranch_scc1 FL_37
    v_mov_b32 v5, s22
    s_mov_b64 exec, 0xff000000
    buffer_store_dword v5, v3, s[52:55], 0 offen sc1
    s_mov_b64 exec, -1
FL_37:
FK_NOZF:
    s_cmp_lg_u32 s64, 0
    s_cbranch_scc1 KS_38
    buffer_load_dword v30, v31, s[52:55], 0 offen sc1
KS_38:
    s_mov_b32 s88, 0
    s_branch FK_QC
FK_QL:
    buffer_load_dwordx4 v[112:115], v2, s[52:55], s76 offen sc1
    buffer_load_dwordx4 v[116:119], v2, s[52:55], s75 offen sc1
    s_waitcnt vmcnt(0)
FK_QC:
    v_max3_u32 v5, v112, v113, v114
    v_max3_u32 v6, v115, v116, v117
    v_max3_u32 v5, v5, v118, v119
    v_max_u32 v5, v5, v6
    v_cmp_eq_u32 vcc, -1, v5
    s_nop 0
    s_cmp_eq_u64 vcc, 0
    s_cbranch_scc1 FK_QD
    s_add_u32 s88, s88, 1
    s_cmp_lt_u32 s88, 40000
    s_cbranch_scc1 FK_QL
FK_QD:
    s_waitcnt lgkmcnt(3)
    v_mfma_f32_32x32x16_bf16 v[128:143], v[124:127], v[112:115], 0
    v_mfma_f32_32x32x16_bf16 v[192:207], v[124:127], v[116:119], 0
    s_lshl_b32 s71, s69, 6
    s_lshl_b32 s72, s70, 3
    s_add_u32 s71, s71, s72
    s_add_u32 s71, s71, s64
    s_lshl_b32 s71, s71, 12
    v_bfe_u32 v7, v1, 2, 3
    v_lshrrev_b32 v27, 5, v1
    v_lshlrev_b32 v7, 7, v7
    v_lshl_add_u32 v7, v27, 11, v7
    buffer_load_dword v27, v7, s[60:63], s71 offen offset:0
    s_lshl_b32 s72, s69, 1
    s_add_u32 s72, s72, s66
    v_and_b32 v18, 31, v1
    v_lshlrev_b32 v18, 1, v18
    s_lshl_b32 s71, s72, 6
    buffer_load_ushort v18, v18, s[40:43], s71 offen
    v_mov_b64 v[80:81], 0
    v_mov_b64 v[82:83], 0
    v_mov_b64 v[84:85], 0
    v_mov_b64 v[86:87], 0
    v_mov_b64 v[88:89], 0
    v_mov_b64 v[90:91], 0
    v_mov_b64 v[92:93], 0
    v_mov_b64 v[94:95], 0
    v_max3_f32 v5, v128, v129, v130
    v_max3_f32 v5, v5, v131, v132
    v_max3_f32 v5, v5, v133, v134
    v_max3_f32 v6, v192, v193, v135
    v_max3_f32 v6, v6, v194, v195
    v_max3_f32 v6, v6, v196, v197
    v_max3_f32 v6, v6, v198, v199
    v_max_f32 v7, v5, v6
    v_max_f32 v5, v5, v6
    s_nop 1
    v_permlane32_swap_b32 v5, v7
    v_min_f32 v192, neg(v5), neg(v7)
    v_min_f32 v193, neg(v5), neg(v7)
    v_mov_b64 v[194:195], v[192:193]
    v_mov_b64 v[196:197], v[192:193]
    v_mov_b64 v[198:199], v[192:193]
    v_mov_b64 v[200:201], v[192:193]
    v_mov_b64 v[202:203], v[192:193]
    v_mov_b64 v[204:205], v[192:193]
    v_mov_b64 v[206:207], v[192:193]
    s_waitcnt lgkmcnt(2)
    s_nop 0
    v_mfma_f32_32x32x16_bf16 v[128:143], v[120:123], v[112:115], v[192:207]
    s_lshr_b32 s72, s64, 1
    v_lshrrev_b32 v6, 5, v1
    v_bfe_u32 v5, v1, 2, 2
    v_lshl_add_u32 v7, v6, 2, v5
    v_lshlrev_b32 v7, 7, v7
    v_lshrrev_b32 v5, 1, v5
    v_lshl_add_u32 v7, v5, 6, v7
    v_bfe_u32 v5, v1, 4, 1
    v_lshl_add_u32 v7, v5, 5, v7
    v_and_b32 v5, 3, v1
    v_lshl_add_u32 v7, v5, 3, v7
    s_lshl_b32 s71, s72, 11
    s_add_u32 s71, s71, 98304
    v_add_u32 v21, s71, v7
    v_xor_b32 v22, 64, v21
    s_cmp_ge_u32 s70, 7
    s_cbranch_scc1 FK_NOSP
    v_exp_f32 v128, v128
    v_exp_f32 v129, v129
    v_exp_f32 v130, v130
    v_mfma_f32_32x32x16_bf16 v[144:159], v[120:123], v[116:119], v[192:207]
    v_exp_f32 v131, v131
    v_exp_f32 v132, v132
    v_exp_f32 v133, v133
    ds_read_b128 v[124:127], v8 offset:1024
    v_cvt_pk_bf16_f32 v224, v128, v129
    v_exp_f32 v134, v134
    v_exp_f32 v135, v135
    v_cvt_pk_bf16_f32 v225, v130, v131
    v_cvt_pk_bf16_f32 v226, v132, v133
    s_setprio 1
    v_exp_f32 v136, v136
    v_exp_f32 v137, v137
    v_exp_f32 v138, v138
    v_cvt_pk_bf16_f32 v227, v134, v135
    v_exp_f32 v139, v139
    v_exp_f32 v140, v140
    v_exp_f32 v141, v141
    s_waitcnt lgkmcnt(2)
    v_cvt_pk_bf16_f32 v228, v136, v137
    v_mfma_f32_32x32x16_bf16 v[160:175], v[208:211], v[224:227], 0
    v_exp_f32 v142, v142
    v_exp_f32 v143, v143
    v_cvt_pk_bf16_f32 v229, v138, v139
    v_cvt_pk_bf16_f32 v230, v140, v141
    v_exp_f32 v144, v144
    v_exp_f32 v145, v145
    v_exp_f32 v146, v146
    s_waitcnt lgkmcnt(0)
    v_cvt_pk_bf16_f32 v231, v142, v143
    v_mfma_f32_32x32x16_bf16 v[128:143], v[124:127], v[112:115], v[192:207]
    s_setprio 0
    v_exp_f32 v147, v147
    v_exp_f32 v148, v148
    v_exp_f32 v149, v149
    v_cvt_pk_bf16_f32 v224, v144, v145
    v_exp_f32 v150, v150
    v_exp_f32 v151, v151
    v_cvt_pk_bf16_f32 v225, v146, v147
    v_cvt_pk_bf16_f32 v226, v148, v149
    v_mfma_f32_32x32x16_bf16 v[160:175], v[212:215], v[228:231], v[160:175]
    v_exp_f32 v152, v152
    v_exp_f32 v153, v153
    v_exp_f32 v154, v154
    s_mov_b64 exec, s[98:99]
    ds_read_b128 v[216:219], v9 offset:1024
    ds_read_b128 v[220:223], v9 offset:1536
    s_mov_b64 exec, -1
    v_cvt_pk_bf16_f32 v227, v150, v151
    v_exp_f32 v155, v155
    v_exp_f32 v156, v156
    v_exp_f32 v157, v157
    v_cvt_pk_bf16_f32 v228, v152, v153
    s_cmp_lg_u32 s64, 0
    s_cbranch_scc1 KSP_42
    s_mov_b32 s88, 0
    s_waitcnt vmcnt(2)
    s_branch PC_40
PL_39:
    buffer_load_dword v30, v31, s[52:55], 0 offen sc1
    s_waitcnt vmcnt(0)
PC_40:
    v_cmp_ne_u32 vcc, s22, v30
    s_nop 0
    s_cmp_eq_u64 vcc, 0
    s_cbranch_scc1 PD_41
    s_sleep 1
    s_add_u32 s88, s88, 1
    s_cmp_lt_u32 s88, 40000
    s_cbranch_scc1 PL_39
PD_41:
KSP_42:
    s_barrier
    v_mfma_f32_32x32x16_bf16 v[176:191], v[208:211], v[224:227], 0
    s_setprio 3
    v_exp_f32 v158, v158
    v_exp_f32 v159, v159
    v_cvt_pk_bf16_f32 v229, v154, v155
    v_cvt_pk_bf16_f32 v230, v156, v157
    s_add_u32 m0, s91, 0x2000
    v_exp_f32 v128, v128
    v_exp_f32 v129, v129
    v_exp_f32 v130, v130
    buffer_load_dwordx4 v29, s[52:55], s95 offen sc1 lds
    v_cvt_pk_bf16_f32 v231, v158, v159
    v_mfma_f32_32x32x16_bf16 v[144:159], v[124:127], v[116:119], v[192:207]
    s_add_u32 s95, s95, 2048
    s_xor_b32 s91, s91, 16384
    v_exp_f32 v131, v131
    v_exp_f32 v132, v132
    v_exp_f32 v133, v133
    ds_read_b128 v[120:123], v8 offset:8192
    v_cvt_pk_bf16_f32 v224, v128, v129
    s_add_u32 m0, s83, 0x18000
    v_exp_f32 v134, v134
    v_exp_f32 v135, v135
    v_cvt_pk_bf16_f32 v225, v130, v131
    v_cvt_pk_bf16_f32 v226, v132, v133
    buffer_load_dwordx4 v10, s[60:63], s94 offen lds
    v_mfma_f32_32x32x16_bf16 v[176:191], v[212:215], v[228:231], v[176:191]
    s_setprio 2
    v_exp_f32 v136, v136
    v_exp_f32 v137, v137
    v_exp_f32 v138, v138
    v_cvt_pk_bf16_f32 v227, v134, v135
    s_add_u32 m0, s83, 0x18400
    v_exp_f32 v139, v139
    v_exp_f32 v140, v140
    v_exp_f32 v141, v141
    buffer_load_dwordx4 v11, s[60:63], s94 offen lds
    s_waitcnt lgkmcnt(2)
    v_cvt_pk_bf16_f32 v228, v136, v137
    v_mfma_f32_32x32x16_bf16 v[160:175], v[216:219], v[224:227], v[160:175]
    s_add_u32 s94, s94, 128
    v_exp_f32 v142, v142
    v_exp_f32 v143, v143
    v_cvt_pk_bf16_f32 v229, v138, v139
    v_cvt_pk_bf16_f32 v230, v140, v141
    v_and_b32 v31, 7, v1
    v_lshlrev_b32 v31, 2, v31
    s_lshr_b32 s71, s69, 2
    s_lshl_b32 s71, s71, 10
    s_lshl_b32 s72, s70, 2
    s_add_u32 s72, s72, s66
    s_lshl_b32 s72, s72, 5
    s_add_u32 s71, s71, s72
    s_add_u32 s71, s71, 0x1508000
    v_add_u32 v31, s71, v31
    s_waitcnt vmcnt(5)
    buffer_load_dword v30, v31, s[52:55], 0 offen sc1
    v_exp_f32 v144, v144
    v_exp_f32 v145, v145
    v_exp_f32 v146, v146
    s_waitcnt lgkmcnt(0)
    v_cvt_pk_bf16_f32 v231, v142, v143
    v_mfma_f32_32x32x16_bf16 v[128:143], v[120:123], v[112:115], v[192:207]
    s_setprio 1
    v_exp_f32 v147, v147
    v_exp_f32 v148, v148
    v_exp_f32 v149, v149
    v_cvt_pk_bf16_f32 v224, v144, v145
    v_exp_f32 v150, v150
    v_exp_f32 v151, v151
    v_cvt_pk_bf16_f32 v225, v146, v147
    v_cvt_pk_bf16_f32 v226, v148, v149
    v_mfma_f32_32x32x16_bf16 v[160:175], v[220:223], v[228:231], v[160:175]
    v_exp_f32 v152, v152
    v_exp_f32 v153, v153
    v_exp_f32 v154, v154
    s_mov_b64 exec, s[98:99]
    ds_read_b128 v[208:211], v9 offset:8192
    ds_read_b128 v[212:215], v9 offset:8704
    s_mov_b64 exec, -1
    v_cvt_pk_bf16_f32 v227, v150, v151
    v_exp_f32 v155, v155
    v_exp_f32 v156, v156
    v_exp_f32 v157, v157
    v_cvt_pk_bf16_f32 v228, v152, v153
    v_mfma_f32_32x32x16_bf16 v[176:191], v[216:219], v[224:227], v[176:191]
    s_setprio 0
    v_exp_f32 v158, v158
    v_exp_f32 v159, v159
    v_cvt_pk_bf16_f32 v229, v154, v155
    v_cvt_pk_bf16_f32 v230, v156, v157
    v_exp_f32 v128, v128
    v_exp_f32 v129, v129
    v_exp_f32 v130, v130
    v_cvt_pk_bf16_f32 v231, v158, v159
    v_mfma_f32_32x32x16_bf16 v[144:159], v[120:123], v[116:119], v[192:207]
    v_exp_f32 v131, v131
    v_exp_f32 v132, v132
    v_exp_f32 v133, v133
    ds_read_b128 v[124:127], v8 offset:9216
    v_cvt_pk_bf16_f32 v224, v128, v129
    v_exp_f32 v134, v134
    v_exp_f32 v135, v135
    v_cvt_pk_bf16_f32 v225, v130, v131
    v_cvt_pk_bf16_f32 v226, v132, v133
    s_barrier
    v_mfma_f32_32x32x16_bf16 v[176:191], v[220:223], v[228:231], v[176:191]
    s_setprio 3
    v_exp_f32 v136, v136
    v_exp_f32 v137, v137
    v_exp_f32 v138, v138
    s_cmp_lg_u32 s64, 0
    s_cbranch_scc1 FL_43
    v_mov_b32 v5, s22
    s_mov_b64 exec, 0x10000
    buffer_store_dword v5, v3, s[52:55], 0 offen sc1
    s_mov_b64 exec, -1
FL_43:
    s_add_u32 m0, s91, 0x0
    s_nop 0
    buffer_load_dwordx4 v29, s[52:55], s95 offen sc1 lds
    s_add_u32 s95, s95, 2048
    s_add_u32 m0, s83, 0x1c000
    s_nop 0
    buffer_load_dwordx4 v10, s[60:63], s94 offen lds
    s_add_u32 m0, s83, 0x1c400
    s_nop 0
    buffer_load_dwordx4 v11, s[60:63], s94 offen lds
    s_add_u32 s94, s94, 128
    s_mov_b32 s88, 0
    s_waitcnt vmcnt(3)
    s_branch PC_45
PL_44:
    buffer_load_dword v30, v31, s[52:55], 0 offen sc1
    s_waitcnt vmcnt(0)
PC_45:
    v_cmp_ne_u32 vcc, s22, v30
    s_nop 0
    s_cmp_eq_u64 vcc, 0
    s_cbranch_scc1 PD_46
    s_sleep 1
    s_add_u32 s88, s88, 1
    s_cmp_lt_u32 s88, 40000
    s_cbranch_scc1 PL_44
PD_46:
    v_cvt_pk_bf16_f32 v227, v134, v135
    v_exp_f32 v139, v139
    v_exp_f32 v140, v140
    v_exp_f32 v141, v141
    buffer_load_dwordx4 v[96:99], v2, s[52:55], s96 offen offset:0 sc1
    s_waitcnt lgkmcnt(2)
    v_cvt_pk_bf16_f32 v228, v136, v137
    v_mfma_f32_32x32x16_bf16 v[160:175], v[208:211], v[224:227], v[160:175]
    v_exp_f32 v142, v142
    v_exp_f32 v143, v143
    v_cvt_pk_bf16_f32 v229, v138, v139
    v_cvt_pk_bf16_f32 v230, v140, v141
    v_exp_f32 v144, v144
    v_exp_f32 v145, v145
    v_exp_f32 v146, v146
    buffer_load_dwordx4 v[100:103], v2, s[52:55], s96 offen offset:1024 sc1
    s_waitcnt lgkmcnt(0)
    v_cvt_pk_bf16_f32 v231, v142, v143
    v_mfma_f32_32x32x16_bf16 v[128:143], v[124:127], v[112:115], v[192:207]
    s_setprio 2
    v_exp_f32 v147, v147
    v_exp_f32 v148, v148
    v_exp_f32 v149, v149
    v_cvt_pk_bf16_f32 v224, v144, v145
    v_exp_f32 v150, v150
    v_exp_f32 v151, v151
    v_cvt_pk_bf16_f32 v225, v146, v147
    v_cvt_pk_bf16_f32 v226, v148, v149
    buffer_load_dwordx4 v[104:107], v2, s[52:55], s96 offen offset:2048 sc1
    v_mfma_f32_32x32x16_bf16 v[160:175], v[212:215], v[228:231], v[160:175]
    v_exp_f32 v152, v152
    v_exp_f32 v153, v153
    v_exp_f32 v154, v154
    s_mov_b64 exec, s[98:99]
    ds_read_b128 v[216:219], v9 offset:9216
    ds_read_b128 v[220:223], v9 offset:9728
    s_mov_b64 exec, -1
    v_cvt_pk_bf16_f32 v227, v150, v151
    v_exp_f32 v155, v155
    v_exp_f32 v156, v156
    v_exp_f32 v157, v157
    buffer_load_dwordx4 v[108:111], v2, s[52:55], s96 offen offset:3072 sc1
    v_cvt_pk_bf16_f32 v228, v152, v153
    v_mfma_f32_32x32x16_bf16 v[176:191], v[208:211], v[224:227], v[176:191]
    s_add_u32 s96, s96, 4096
    s_setprio 1
    v_exp_f32 v158, v158
    v_exp_f32 v159, v159
    v_cvt_pk_bf16_f32 v229, v154, v155
    v_cvt_pk_bf16_f32 v230, v156, v157
    v_xor_b32 v8, 16384, v8
    v_exp_f32 v128, v128
    v_exp_f32 v129, v129
    v_exp_f32 v130, v130
    buffer_load_dwordx4 v[32:35], v2, s[52:55], s96 offen offset:0 sc1
    v_cvt_pk_bf16_f32 v231, v158, v159
    v_mfma_f32_32x32x16_bf16 v[144:159], v[124:127], v[116:119], v[192:207]
    v_exp_f32 v131, v131
    v_exp_f32 v132, v132
    v_exp_f32 v133, v133
    ds_read_b128 v[120:123], v8 offset:0
    v_cvt_pk_bf16_f32 v224, v128, v129
    v_exp_f32 v134, v134
    v_exp_f32 v135, v135
    v_cvt_pk_bf16_f32 v225, v130, v131
    v_cvt_pk_bf16_f32 v226, v132, v133
    buffer_load_dwordx4 v[36:39], v2, s[52:55], s96 offen offset:1024 sc1
    v_mfma_f32_32x32x16_bf16 v[176:191], v[212:215], v[228:231], v[176:191]
    s_setprio 0
    v_exp_f32 v136, v136
    v_exp_f32 v137, v137
    v_exp_f32 v138, v138
    v_cvt_pk_bf16_f32 v227, v134, v135
    v_exp_f32 v139, v139
    v_exp_f32 v140, v140
    v_exp_f32 v141, v141
    buffer_load_dwordx4 v[40:43], v2, s[52:55], s96 offen offset:2048 sc1
    s_waitcnt lgkmcnt(2)
    v_cvt_pk_bf16_f32 v228, v136, v137
    v_mfma_f32_32x32x16_bf16 v[160:175], v[216:219], v[224:227], v[160:175]
    v_exp_f32 v142, v142
    v_exp_f32 v143, v143
    v_cvt_pk_bf16_f32 v229, v138, v139
    v_cvt_pk_bf16_f32 v230, v140, v141
    buffer_load_dwordx4 v[44:47], v2, s[52:55], s96 offen offset:3072 sc1
    v_lshlrev_b32 v64, 16, v18
    v_lshlrev_b32 v65, 16, v18
    v_mov_b64 v[66:67], v[64:65]
    v_mov_b64 v[68:69], v[64:65]
    v_mov_b64 v[70:71], v[64:65]
    v_mov_b64 v[72:73], v[64:65]
    v_mov_b64 v[74:75], v[64:65]
    v_mov_b64 v[76:77], v[64:65]
    v_mov_b64 v[78:79], v[64:65]
    s_lshl_b32 s71, s69, 6
    s_lshl_b32 s72, s70, 3
    s_add_u32 s71, s71, s72
    s_add_u32 s71, s71, s64
    s_lshl_b32 s71, s71, 12
    v_bfe_u32 v7, v1, 2, 3
    v_lshrrev_b32 v26, 5, v1
    v_lshlrev_b32 v7, 7, v7
    v_lshl_add_u32 v7, v26, 11, v7
    buffer_load_dword v26, v7, s[60:63], s71 offen offset:1024
    v_xor_b32 v9, 16384, v9
    s_add_u32 s96, s96, 4096
    v_exp_f32 v144, v144
    v_exp_f32 v145, v145
    v_exp_f32 v146, v146
    v_cvt_pk_bf16_f32 v231, v142, v143
    s_waitcnt lgkmcnt(0)
    s_barrier
    v_mfma_f32_32x32x16_bf16 v[128:143], v[120:123], v[112:115], v[192:207]
    s_setprio 3
    v_exp_f32 v147, v147
    v_exp_f32 v148, v148
    v_exp_f32 v149, v149
    ds_read_b128 v[232:235], v12 offset:0
    ds_read_b128 v[236:239], v12 offset:4096
    v_cvt_pk_bf16_f32 v224, v144, v145
    s_add_u32 m0, s83, 0x20000
    v_exp_f32 v150, v150
    v_exp_f32 v151, v151
    v_cvt_pk_bf16_f32 v225, v146, v147
    v_cvt_pk_bf16_f32 v226, v148, v149
    buffer_load_dwordx4 v10, s[60:63], s94 offen lds
    v_mfma_f32_32x32x16_bf16 v[160:175], v[220:223], v[228:231], v[160:175]
    v_exp_f32 v152, v152
    v_exp_f32 v153, v153
    v_exp_f32 v154, v154
    s_mov_b64 exec, s[98:99]
    ds_read_b128 v[208:211], v9 offset:0
    ds_read_b128 v[212:215], v9 offset:512
    s_mov_b64 exec, -1
    v_cvt_pk_bf16_f32 v227, v150, v151
    s_add_u32 m0, s83, 0x20400
    v_exp_f32 v155, v155
    v_exp_f32 v156, v156
    v_exp_f32 v157, v157
    buffer_load_dwordx4 v11, s[60:63], s94 offen lds
    v_cvt_pk_bf16_f32 v228, v152, v153
    v_mfma_f32_32x32x16_bf16 v[176:191], v[216:219], v[224:227], v[176:191]
    s_add_u32 s94, s94, 128
    s_setprio 2
    v_exp_f32 v158, v158
    v_exp_f32 v159, v159
    v_cvt_pk_bf16_f32 v229, v154, v155
    v_cvt_pk_bf16_f32 v230, v156, v157
    ds_read_b128 v[240:243], v13 offset:0
    ds_read_b128 v[244:247], v13 offset:4096
    s_waitcnt vmcnt(10) lgkmcnt(5)
    s_mov_b32 s97, 0
FK_LOOP_S1:
    v_mfma_f32_32x32x16_bf16 v[64:79], v[96:99], v[232:235], v[64:79]
    v_exp_f32 v128, v128
    v_exp_f32 v129, v129
    v_exp_f32 v130, v130
    s_nop 0
    buffer_load_dwordx4 v[48:51], v2, s[52:55], s96 offen offset:0 sc1
    v_cvt_pk_bf16_f32 v231, v158, v159
    v_mfma_f32_32x32x16_bf16 v[144:159], v[120:123], v[116:119], v[192:207]
    v_exp_f32 v131, v131
    v_exp_f32 v132, v132
    v_exp_f32 v133, v133
    ds_read_b128 v[124:127], v8 offset:1024
    s_waitcnt lgkmcnt(5)
    v_cvt_pk_bf16_f32 v224, v128, v129
    v_mfma_f32_32x32x16_bf16 v[80:95], v[96:99], v[236:239], v[80:95]
    v_exp_f32 v134, v134
    v_exp_f32 v135, v135
    v_cvt_pk_bf16_f32 v225, v130, v131
    v_cvt_pk_bf16_f32 v226, v132, v133
    s_nop 1
    v_mfma_f32_32x32x16_bf16 v[176:191], v[220:223], v[228:231], v[176:191]
    s_setprio 1
    v_exp_f32 v136, v136
    v_exp_f32 v137, v137
    v_exp_f32 v138, v138
    ds_read_b128 v[232:235], v14 offset:0
    ds_read_b128 v[236:239], v14 offset:4096
    s_waitcnt vmcnt(10) lgkmcnt(4)
    v_cvt_pk_bf16_f32 v227, v134, v135
    v_mfma_f32_32x32x16_bf16 v[64:79], v[100:103], v[240:243], v[64:79]
    v_exp_f32 v139, v139
    v_exp_f32 v140, v140
    v_exp_f32 v141, v141
    s_nop 0
    buffer_load_dwordx4 v[52:55], v2, s[52:55], s96 offen offset:1024 sc1
    v_cvt_pk_bf16_f32 v228, v136, v137
    v_mfma_f32_32x32x16_bf16 v[160:175], v[208:211], v[224:227], v[160:175]
    v_exp_f32 v142, v142
    v_exp_f32 v143, v143
    v_cvt_pk_bf16_f32 v229, v138, v139
    v_cvt_pk_bf16_f32 v230, v140, v141
    s_nop 0
    s_waitcnt lgkmcnt(3)
    v_mfma_f32_32x32x16_bf16 v[80:95], v[100:103], v[244:247], v[80:95]
    v_exp_f32 v144, v144
    v_exp_f32 v145, v145
    v_exp_f32 v146, v146
    s_nop 0
    s_waitcnt lgkmcnt(2)
    v_cvt_pk_bf16_f32 v231, v142, v143
    v_mfma_f32_32x32x16_bf16 v[128:143], v[124:127], v[112:115], v[192:207]
    s_setprio 0
    v_exp_f32 v147, v147
    v_exp_f32 v148, v148
    v_exp_f32 v149, v149
    ds_read_b128 v[240:243], v15 offset:0
    ds_read_b128 v[244:247], v15 offset:4096
    s_waitcnt vmcnt(10) lgkmcnt(3)
    v_cvt_pk_bf16_f32 v224, v144, v145
    v_mfma_f32_32x32x16_bf16 v[64:79], v[104:107], v[232:235], v[64:79]
    v_exp_f32 v150, v150
    v_exp_f32 v151, v151
    v_cvt_pk_bf16_f32 v225, v146, v147
    v_cvt_pk_bf16_f32 v226, v148, v149
    s_nop 0
    buffer_load_dwordx4 v[56:59], v2, s[52:55], s96 offen offset:2048 sc1
    v_mfma_f32_32x32x16_bf16 v[160:175], v[212:215], v[228:231], v[160:175]
    v_exp_f32 v152, v152
    v_exp_f32 v153, v153
    v_exp_f32 v154, v154
    s_mov_b64 exec, s[98:99]
    ds_read_b128 v[216:219], v9 offset:1024
    ds_read_b128 v[220:223], v9 offset:1536
    s_mov_b64 exec, -1
    s_waitcnt lgkmcnt(4)
    v_cvt_pk_bf16_f32 v227, v150, v151
    v_mfma_f32_32x32x16_bf16 v[80:95], v[104:107], v[236:239], v[80:95]
    v_exp_f32 v155, v155
    v_exp_f32 v156, v156
    v_exp_f32 v157, v157
    v_cvt_pk_bf16_f32 v228, v152, v153
    s_waitcnt vmcnt(7) lgkmcnt(2)
    s_barrier
    v_mfma_f32_32x32x16_bf16 v[176:191], v[208:211], v[224:227], v[176:191]
    s_setprio 3
    v_exp_f32 v158, v158
    v_exp_f32 v159, v159
    v_cvt_pk_bf16_f32 v229, v154, v155
    v_cvt_pk_bf16_f32 v230, v156, v157
    ds_read_b128 v[232:235], v12 offset:16384
    ds_read_b128 v[236:239], v12 offset:20480
    s_waitcnt vmcnt(10)
    v_mfma_f32_32x32x16_bf16 v[64:79], v[108:111], v[240:243], v[64:79]
    v_exp_f32 v128, v128
    v_exp_f32 v129, v129
    v_exp_f32 v130, v130
    s_nop 0
    buffer_load_dwordx4 v[60:63], v2, s[52:55], s96 offen offset:3072 sc1
    v_cvt_pk_bf16_f32 v231, v158, v159
    v_mfma_f32_32x32x16_bf16 v[144:159], v[124:127], v[116:119], v[192:207]
    s_add_u32 s96, s96, 4096
    v_exp_f32 v131, v131
    v_exp_f32 v132, v132
    v_exp_f32 v133, v133
    s_nop 0
    ds_read_b128 v[120:123], v8 offset:8192
    v_cvt_pk_bf16_f32 v224, v128, v129
    v_mfma_f32_32x32x16_bf16 v[80:95], v[108:111], v[244:247], v[80:95]
    s_add_u32 m0, s91, 0x2000
    v_exp_f32 v134, v134
    v_exp_f32 v135, v135
    v_cvt_pk_bf16_f32 v225, v130, v131
    v_cvt_pk_bf16_f32 v226, v132, v133
    s_nop 0
    buffer_load_dwordx4 v29, s[52:55], s95 offen sc1 lds
    v_mfma_f32_32x32x16_bf16 v[176:191], v[212:215], v[228:231], v[176:191]
    s_add_u32 s95, s95, 2048
    s_xor_b32 s91, s91, 16384
    s_setprio 2
    v_exp_f32 v136, v136
    v_exp_f32 v137, v137
    v_exp_f32 v138, v138
    ds_read_b128 v[240:243], v13 offset:16384
    ds_read_b128 v[244:247], v13 offset:20480
    s_waitcnt vmcnt(11) lgkmcnt(4)
    v_cvt_pk_bf16_f32 v227, v134, v135
    v_mfma_f32_32x32x16_bf16 v[64:79], v[32:35], v[232:235], v[64:79]
    v_exp_f32 v139, v139
    v_exp_f32 v140, v140
    v_exp_f32 v141, v141
    s_nop 0
    buffer_load_dwordx4 v[96:99], v2, s[52:55], s96 offen offset:0 sc1
    v_cvt_pk_bf16_f32 v228, v136, v137
    v_mfma_f32_32x32x16_bf16 v[160:175], v[216:219], v[224:227], v[160:175]
    v_exp_f32 v142, v142
    v_exp_f32 v143, v143
    v_cvt_pk_bf16_f32 v229, v138, v139
    v_cvt_pk_bf16_f32 v230, v140, v141
    s_nop 0
    s_waitcnt lgkmcnt(3)
    v_mfma_f32_32x32x16_bf16 v[80:95], v[32:35], v[236:239], v[80:95]
    s_add_u32 m0, s83, 0x18000
    v_exp_f32 v144, v144
    v_exp_f32 v145, v145
    v_exp_f32 v146, v146
    buffer_load_dwordx4 v10, s[60:63], s94 offen lds
    s_waitcnt lgkmcnt(2)
    v_cvt_pk_bf16_f32 v231, v142, v143
    v_mfma_f32_32x32x16_bf16 v[128:143], v[120:123], v[112:115], v[192:207]
    s_setprio 1
    v_exp_f32 v147, v147
    v_exp_f32 v148, v148
    v_exp_f32 v149, v149
    ds_read_b128 v[232:235], v14 offset:16384
    ds_read_b128 v[236:239], v14 offset:20480
    s_waitcnt vmcnt(12) lgkmcnt(3)
    v_cvt_pk_bf16_f32 v224, v144, v145
    v_mfma_f32_32x32x16_bf16 v[64:79], v[36:39], v[240:243], v[64:79]
    v_exp_f32 v150, v150
    v_exp_f32 v151, v151
    v_cvt_pk_bf16_f32 v225, v146, v147
    v_cvt_pk_bf16_f32 v226, v148, v149
    s_nop 0
    buffer_load_dwordx4 v[100:103], v2, s[52:55], s96 offen offset:1024 sc1
    v_mfma_f32_32x32x16_bf16 v[160:175], v[220:223], v[228:231], v[160:175]
    v_exp_f32 v152, v152
    v_exp_f32 v153, v153
    v_exp_f32 v154, v154
    s_mov_b64 exec, s[98:99]
    ds_read_b128 v[208:211], v9 offset:8192
    ds_read_b128 v[212:215], v9 offset:8704
    s_mov_b64 exec, -1
    s_waitcnt lgkmcnt(4)
    v_cvt_pk_bf16_f32 v227, v150, v151
    v_mfma_f32_32x32x16_bf16 v[80:95], v[36:39], v[244:247], v[80:95]
    s_add_u32 m0, s83, 0x18400
    v_exp_f32 v155, v155
    v_exp_f32 v156, v156
    v_exp_f32 v157, v157
    s_nop 0
    buffer_load_dwordx4 v11, s[60:63], s94 offen lds
    v_cvt_pk_bf16_f32 v228, v152, v153
    v_mfma_f32_32x32x16_bf16 v[176:191], v[216:219], v[224:227], v[176:191]
    s_add_u32 s94, s94, 128
    s_setprio 0
    v_exp_f32 v158, v158
    v_exp_f32 v159, v159
    v_cvt_pk_bf16_f32 v229, v154, v155
    v_cvt_pk_bf16_f32 v230, v156, v157
    ds_read_b128 v[240:243], v15 offset:16384
    ds_read_b128 v[244:247], v15 offset:20480
    s_waitcnt vmcnt(12) lgkmcnt(5)
    v_mfma_f32_32x32x16_bf16 v[64:79], v[40:43], v[232:235], v[64:79]
    v_exp_f32 v128, v128
    v_exp_f32 v129, v129
    v_exp_f32 v130, v130
    s_nop 0
    buffer_load_dwordx4 v[104:107], v2, s[52:55], s96 offen offset:2048 sc1
    v_cvt_pk_bf16_f32 v231, v158, v159
    v_mfma_f32_32x32x16_bf16 v[144:159], v[120:123], v[116:119], v[192:207]
    v_exp_f32 v131, v131
    v_exp_f32 v132, v132
    v_exp_f32 v133, v133
    ds_read_b128 v[124:127], v8 offset:9216
    s_waitcnt lgkmcnt(5)
    v_cvt_pk_bf16_f32 v224, v128, v129
    v_mfma_f32_32x32x16_bf16 v[80:95], v[40:43], v[236:239], v[80:95]
    v_exp_f32 v134, v134
    v_exp_f32 v135, v135
    v_cvt_pk_bf16_f32 v225, v130, v131
    v_cvt_pk_bf16_f32 v226, v132, v133
    s_waitcnt vmcnt(10) lgkmcnt(1)
    s_barrier
    v_mfma_f32_32x32x16_bf16 v[176:191], v[220:223], v[228:231], v[176:191]
    s_setprio 3
    v_exp_f32 v136, v136
    v_exp_f32 v137, v137
    v_exp_f32 v138, v138
    ds_read_b128 v[232:235], v12 offset:32768
    ds_read_b128 v[236:239], v12 offset:36864
    v_cvt_pk_bf16_f32 v227, v134, v135
    v_mfma_f32_32x32x16_bf16 v[64:79], v[44:47], v[240:243], v[64:79]
    v_exp_f32 v139, v139
    v_exp_f32 v140, v140
    v_exp_f32 v141, v141
    s_nop 0
    buffer_load_dwordx4 v[108:111], v2, s[52:55], s96 offen offset:3072 sc1
    v_cvt_pk_bf16_f32 v228, v136, v137
    v_mfma_f32_32x32x16_bf16 v[160:175], v[208:211], v[224:227], v[160:175]
    s_add_u32 s96, s96, 4096
    v_exp_f32 v142, v142
    v_exp_f32 v143, v143
    v_cvt_pk_bf16_f32 v229, v138, v139
    v_cvt_pk_bf16_f32 v230, v140, v141
    s_nop 1
    v_mfma_f32_32x32x16_bf16 v[80:95], v[44:47], v[244:247], v[80:95]
    s_add_u32 m0, s91, 0x0
    v_exp_f32 v144, v144
    v_exp_f32 v145, v145
    v_exp_f32 v146, v146
    buffer_load_dwordx4 v29, s[52:55], s95 offen sc1 lds
    s_waitcnt lgkmcnt(2)
    v_cvt_pk_bf16_f32 v231, v142, v143
    v_mfma_f32_32x32x16_bf16 v[128:143], v[124:127], v[112:115], v[192:207]
    s_add_u32 s95, s95, 2048
    s_setprio 2
    v_exp_f32 v147, v147
    v_exp_f32 v148, v148
    v_exp_f32 v149, v149
    ds_read_b128 v[240:243], v13 offset:32768
    ds_read_b128 v[244:247], v13 offset:36864
    s_waitcnt vmcnt(11) lgkmcnt(3)
    v_cvt_pk_bf16_f32 v224, v144, v145
    v_mfma_f32_32x32x16_bf16 v[64:79], v[48:51], v[232:235], v[64:79]
    v_exp_f32 v150, v150
    v_exp_f32 v151, v151
    v_cvt_pk_bf16_f32 v225, v146, v147
    v_cvt_pk_bf16_f32 v226, v148, v149
    s_nop 0
    buffer_load_dwordx4 v[32:35], v2, s[52:55], s96 offen offset:0 sc1
    v_mfma_f32_32x32x16_bf16 v[160:175], v[212:215], v[228:231], v[160:175]
    v_exp_f32 v152, v152
    v_exp_f32 v153, v153
    v_exp_f32 v154, v154
    s_mov_b64 exec, s[98:99]
    ds_read_b128 v[216:219], v9 offset:9216
    ds_read_b128 v[220:223], v9 offset:9728
    s_mov_b64 exec, -1
    s_waitcnt lgkmcnt(4)
    v_cvt_pk_bf16_f32 v227, v150, v151
    v_mfma_f32_32x32x16_bf16 v[80:95], v[48:51], v[236:239], v[80:95]
    s_add_u32 m0, s83, 0x1c000
    v_exp_f32 v155, v155
    v_exp_f32 v156, v156
    v_exp_f32 v157, v157
    s_nop 0
    buffer_load_dwordx4 v10, s[60:63], s94 offen lds
    v_cvt_pk_bf16_f32 v228, v152, v153
    v_mfma_f32_32x32x16_bf16 v[176:191], v[208:211], v[224:227], v[176:191]
    s_setprio 1
    v_exp_f32 v158, v158
    v_exp_f32 v159, v159
    v_cvt_pk_bf16_f32 v229, v154, v155
    v_cvt_pk_bf16_f32 v230, v156, v157
    ds_read_b128 v[232:235], v14 offset:32768
    ds_read_b128 v[236:239], v14 offset:36864
    s_waitcnt vmcnt(12) lgkmcnt(5)
    v_xor_b32 v8, 16384, v8
    v_mfma_f32_32x32x16_bf16 v[64:79], v[52:55], v[240:243], v[64:79]
    v_exp_f32 v128, v128
    v_exp_f32 v129, v129
    v_exp_f32 v130, v130
    s_nop 0
    buffer_load_dwordx4 v[36:39], v2, s[52:55], s96 offen offset:1024 sc1
    v_cvt_pk_bf16_f32 v231, v158, v159
    v_mfma_f32_32x32x16_bf16 v[144:159], v[124:127], v[116:119], v[192:207]
    v_exp_f32 v131, v131
    v_exp_f32 v132, v132
    v_exp_f32 v133, v133
    ds_read_b128 v[120:123], v8 offset:0
    s_waitcnt lgkmcnt(5)
    v_cvt_pk_bf16_f32 v224, v128, v129
    v_mfma_f32_32x32x16_bf16 v[80:95], v[52:55], v[244:247], v[80:95]
    s_add_u32 m0, s83, 0x1c400
    v_exp_f32 v134, v134
    v_exp_f32 v135, v135
    v_cvt_pk_bf16_f32 v225, v130, v131
    v_cvt_pk_bf16_f32 v226, v132, v133
    s_nop 0
    buffer_load_dwordx4 v11, s[60:63], s94 offen lds
    v_mfma_f32_32x32x16_bf16 v[176:191], v[212:215], v[228:231], v[176:191]
    s_add_u32 s94, s94, 128
    s_setprio 0
    v_exp_f32 v136, v136
    v_exp_f32 v137, v137
    v_exp_f32 v138, v138
    ds_read_b128 v[240:243], v15 offset:32768
    ds_read_b128 v[244:247], v15 offset:36864
    s_waitcnt vmcnt(13) lgkmcnt(4)
    v_cvt_pk_bf16_f32 v227, v134, v135
    v_mfma_f32_32x32x16_bf16 v[64:79], v[56:59], v[232:235], v[64:79]
    v_exp_f32 v139, v139
    v_exp_f32 v140, v140
    v_exp_f32 v141, v141
    s_nop 0
    buffer_load_dwordx4 v[40:43], v2, s[52:55], s96 offen offset:2048 sc1
    v_cvt_pk_bf16_f32 v228, v136, v137
    v_mfma_f32_32x32x16_bf16 v[160:175], v[216:219], v[224:227], v[160:175]
    v_exp_f32 v142, v142
    v_exp_f32 v143, v143
    v_cvt_pk_bf16_f32 v229, v138, v139
    v_cvt_pk_bf16_f32 v230, v140, v141
    s_nop 0
    s_waitcnt lgkmcnt(3)
    v_xor_b32 v9, 16384, v9
    v_mfma_f32_32x32x16_bf16 v[80:95], v[56:59], v[236:239], v[80:95]
    v_exp_f32 v144, v144
    v_exp_f32 v145, v145
    v_exp_f32 v146, v146
    v_cvt_pk_bf16_f32 v231, v142, v143
    s_waitcnt vmcnt(8) lgkmcnt(0)
    s_barrier
    v_mfma_f32_32x32x16_bf16 v[128:143], v[120:123], v[112:115], v[192:207]
    s_setprio 3
    v_exp_f32 v147, v147
    v_exp_f32 v148, v148
    v_exp_f32 v149, v149
    ds_read_b128 v[232:235], v12 offset:0
    ds_read_b128 v[236:239], v12 offset:4096
    v_cvt_pk_bf16_f32 v224, v144, v145
    v_mfma_f32_32x32x16_bf16 v[64:79], v[60:63], v[240:243], v[64:79]
    v_exp_f32 v150, v150
    v_exp_f32 v151, v151
    v_cvt_pk_bf16_f32 v225, v146, v147
    v_cvt_pk_bf16_f32 v226, v148, v149
    s_nop 0
    buffer_load_dwordx4 v[44:47], v2, s[52:55], s96 offen offset:3072 sc1
    v_mfma_f32_32x32x16_bf16 v[160:175], v[220:223], v[228:231], v[160:175]
    s_add_u32 s96, s96, 4096
    v_exp_f32 v152, v152
    v_exp_f32 v153, v153
    v_exp_f32 v154, v154
    s_mov_b64 exec, s[98:99]
    ds_read_b128 v[208:211], v9 offset:0
    ds_read_b128 v[212:215], v9 offset:512
    s_mov_b64 exec, -1
    v_cvt_pk_bf16_f32 v227, v150, v151
    v_mfma_f32_32x32x16_bf16 v[80:95], v[60:63], v[244:247], v[80:95]
    s_add_u32 m0, s83, 0x20000
    v_exp_f32 v155, v155
    v_exp_f32 v156, v156
    v_exp_f32 v157, v157
    s_nop 0
    buffer_load_dwordx4 v10, s[60:63], s94 offen lds
    v_cvt_pk_bf16_f32 v228, v152, v153
    v_mfma_f32_32x32x16_bf16 v[176:191], v[216:219], v[224:227], v[176:191]
    s_add_u32 m0, s83, 0x20400
    s_setprio 2
    v_exp_f32 v158, v158
    v_exp_f32 v159, v159
    v_cvt_pk_bf16_f32 v229, v154, v155
    v_cvt_pk_bf16_f32 v230, v156, v157
    buffer_load_dwordx4 v11, s[60:63], s94 offen lds
    s_add_u32 s94, s94, 128
    ds_read_b128 v[240:243], v13 offset:0
    ds_read_b128 v[244:247], v13 offset:4096
    s_waitcnt lgkmcnt(5)
    s_add_u32 s97, s97, 1
    s_cmp_lt_u32 s97, 4
    s_cbranch_scc1 FK_LOOP_S1
    v_mfma_f32_32x32x16_bf16 v[64:79], v[96:99], v[232:235], v[64:79]
    v_exp_f32 v128, v128
    v_exp_f32 v129, v129
    v_exp_f32 v130, v130
    s_nop 0
    buffer_load_dwordx4 v[48:51], v2, s[52:55], s96 offen offset:0 sc1
    v_cvt_pk_bf16_f32 v231, v158, v159
    v_mfma_f32_32x32x16_bf16 v[144:159], v[120:123], v[116:119], v[192:207]
    v_exp_f32 v131, v131
    v_exp_f32 v132, v132
    v_exp_f32 v133, v133
    ds_read_b128 v[124:127], v8 offset:1024
    s_waitcnt lgkmcnt(5)
    v_cvt_pk_bf16_f32 v224, v128, v129
    v_mfma_f32_32x32x16_bf16 v[80:95], v[96:99], v[236:239], v[80:95]
    v_exp_f32 v134, v134
    v_exp_f32 v135, v135
    v_cvt_pk_bf16_f32 v225, v130, v131
    v_cvt_pk_bf16_f32 v226, v132, v133
    s_nop 1
    v_mfma_f32_32x32x16_bf16 v[176:191], v[220:223], v[228:231], v[176:191]
    s_setprio 1
    v_exp_f32 v136, v136
    v_exp_f32 v137, v137
    v_exp_f32 v138, v138
    ds_read_b128 v[232:235], v14 offset:0
    ds_read_b128 v[236:239], v14 offset:4096
    s_waitcnt lgkmcnt(4)
    v_cvt_pk_bf16_f32 v227, v134, v135
    v_mfma_f32_32x32x16_bf16 v[64:79], v[100:103], v[240:243], v[64:79]
    v_exp_f32 v139, v139
    v_exp_f32 v140, v140
    v_exp_f32 v141, v141
    s_nop 0
    buffer_load_dwordx4 v[52:55], v2, s[52:55], s96 offen offset:1024 sc1
    v_cvt_pk_bf16_f32 v228, v136, v137
    v_mfma_f32_32x32x16_bf16 v[160:175], v[208:211], v[224:227], v[160:175]
    v_exp_f32 v142, v142
    v_exp_f32 v143, v143
    v_cvt_pk_bf16_f32 v229, v138, v139
    v_cvt_pk_bf16_f32 v230, v140, v141
    s_nop 0
    s_waitcnt lgkmcnt(3)
    v_mfma_f32_32x32x16_bf16 v[80:95], v[100:103], v[244:247], v[80:95]
    v_exp_f32 v144, v144
    v_exp_f32 v145, v145
    v_exp_f32 v146, v146
    s_nop 0
    s_waitcnt lgkmcnt(2)
    v_cvt_pk_bf16_f32 v231, v142, v143
    v_mfma_f32_32x32x16_bf16 v[128:143], v[124:127], v[112:115], v[192:207]
    s_setprio 0
    v_exp_f32 v147, v147
    v_exp_f32 v148, v148
    v_exp_f32 v149, v149
    ds_read_b128 v[240:243], v15 offset:0
    ds_read_b128 v[244:247], v15 offset:4096
    s_waitcnt vmcnt(12) lgkmcnt(3)
    v_cvt_pk_bf16_f32 v224, v144, v145
    v_mfma_f32_32x32x16_bf16 v[64:79], v[104:107], v[232:235], v[64:79]
    v_exp_f32 v150, v150
    v_exp_f32 v151, v151
    v_cvt_pk_bf16_f32 v225, v146, v147
    v_cvt_pk_bf16_f32 v226, v148, v149
    s_nop 0
    buffer_load_dwordx4 v[56:59], v2, s[52:55], s96 offen offset:2048 sc1
    v_mfma_f32_32x32x16_bf16 v[160:175], v[212:215], v[228:231], v[160:175]
    v_exp_f32 v152, v152
    v_exp_f32 v153, v153
    v_exp_f32 v154, v154
    s_mov_b64 exec, s[98:99]
    ds_read_b128 v[216:219], v9 offset:1024
    ds_read_b128 v[220:223], v9 offset:1536
    s_mov_b64 exec, -1
    s_waitcnt lgkmcnt(4)
    v_cvt_pk_bf16_f32 v227, v150, v151
    v_mfma_f32_32x32x16_bf16 v[80:95], v[104:107], v[236:239], v[80:95]
    v_exp_f32 v155, v155
    v_exp_f32 v156, v156
    v_exp_f32 v157, v157
    v_cvt_pk_bf16_f32 v228, v152, v153
    s_waitcnt vmcnt(7) lgkmcnt(2)
    s_barrier
    v_mfma_f32_32x32x16_bf16 v[176:191], v[208:211], v[224:227], v[176:191]
    s_setprio 3
    v_exp_f32 v158, v158
    v_exp_f32 v159, v159
    v_cvt_pk_bf16_f32 v229, v154, v155
    v_cvt_pk_bf16_f32 v230, v156, v157
    ds_read_b128 v[232:235], v12 offset:16384
    ds_read_b128 v[236:239], v12 offset:20480
    v_mfma_f32_32x32x16_bf16 v[64:79], v[108:111], v[240:243], v[64:79]
    v_exp_f32 v128, v128
    v_exp_f32 v129, v129
    v_exp_f32 v130, v130
    s_nop 0
    buffer_load_dwordx4 v[60:63], v2, s[52:55], s96 offen offset:3072 sc1
    v_cvt_pk_bf16_f32 v231, v158, v159
    v_mfma_f32_32x32x16_bf16 v[144:159], v[124:127], v[116:119], v[192:207]
    s_add_u32 s96, s96, 4096
    v_exp_f32 v131, v131
    v_exp_f32 v132, v132
    v_exp_f32 v133, v133
    s_nop 0
    ds_read_b128 v[120:123], v8 offset:8192
    v_cvt_pk_bf16_f32 v224, v128, v129
    v_mfma_f32_32x32x16_bf16 v[80:95], v[108:111], v[244:247], v[80:95]
    s_add_u32 m0, s91, 0x2000
    v_exp_f32 v134, v134
    v_exp_f32 v135, v135
    v_cvt_pk_bf16_f32 v225, v130, v131
    v_cvt_pk_bf16_f32 v226, v132, v133
    s_nop 0
    buffer_load_dwordx4 v29, s[52:55], s95 offen sc1 lds
    v_mfma_f32_32x32x16_bf16 v[176:191], v[212:215], v[228:231], v[176:191]
    s_add_u32 s95, s95, 2048
    s_xor_b32 s91, s91, 16384
    s_setprio 2
    v_exp_f32 v136, v136
    v_exp_f32 v137, v137
    v_exp_f32 v138, v138
    ds_read_b128 v[240:243], v13 offset:16384
    ds_read_b128 v[244:247], v13 offset:20480
    s_waitcnt lgkmcnt(4)
    v_cvt_pk_bf16_f32 v227, v134, v135
    v_mfma_f32_32x32x16_bf16 v[64:79], v[32:35], v[232:235], v[64:79]
    v_exp_f32 v139, v139
    v_exp_f32 v140, v140
    v_exp_f32 v141, v141
    s_nop 0
    buffer_load_dwordx4 v[96:99], v2, s[52:55], s96 offen offset:0 sc1
    v_cvt_pk_bf16_f32 v228, v136, v137
    v_mfma_f32_32x32x16_bf16 v[160:175], v[216:219], v[224:227], v[160:175]
    v_exp_f32 v142, v142
    v_exp_f32 v143, v143
    v_cvt_pk_bf16_f32 v229, v138, v139
    v_cvt_pk_bf16_f32 v230, v140, v141
    s_nop 0
    s_waitcnt lgkmcnt(3)
    s_cmp_lg_u32 s64, 0
    s_cbranch_scc1 MPI_86
    v_lshlrev_b32 v31, 2, v1
    s_lshr_b32 s71, s69, 1
    s_lshl_b32 s71, s71, 7
    s_add_u32 s71, s71, 0x1502000
    s_mov_b32 exec_hi, 0
    v_and_b32 v31, 63, v31
    v_add_u32 v31, s71, v31
    s_not_b64 exec, exec
    v_add_u32 v31, 0x1503f80, v31
    s_mov_b64 exec, -1
    buffer_load_dword v30, v31, s[52:55], 0 offen sc1
MPI_86:
    v_mfma_f32_32x32x16_bf16 v[80:95], v[32:35], v[236:239], v[80:95]
    s_add_u32 m0, s83, 0x18000
    v_exp_f32 v144, v144
    v_exp_f32 v145, v145
    v_exp_f32 v146, v146
    buffer_load_dwordx4 v10, s[60:63], s94 offen lds
    s_waitcnt lgkmcnt(2)
    v_cvt_pk_bf16_f32 v231, v142, v143
    v_mfma_f32_32x32x16_bf16 v[128:143], v[120:123], v[112:115], v[192:207]
    s_mov_b32 s80, 0x60000
    s_add_u32 m0, s82, 0x24000
    s_setprio 1
    v_exp_f32 v147, v147
    v_exp_f32 v148, v148
    v_exp_f32 v149, v149
    ds_read_b128 v[232:235], v14 offset:16384
    ds_read_b128 v[236:239], v14 offset:20480
    buffer_load_dwordx4 v20, s[4:7], s80 offen lds
    s_waitcnt lgkmcnt(3)
    v_cvt_pk_bf16_f32 v224, v144, v145
    v_mfma_f32_32x32x16_bf16 v[64:79], v[36:39], v[240:243], v[64:79]
    v_exp_f32 v150, v150
    v_exp_f32 v151, v151
    v_cvt_pk_bf16_f32 v225, v146, v147
    v_cvt_pk_bf16_f32 v226, v148, v149
    s_nop 0
    buffer_load_dwordx4 v[100:103], v2, s[52:55], s96 offen offset:1024 sc1
    v_mfma_f32_32x32x16_bf16 v[160:175], v[220:223], v[228:231], v[160:175]
    v_exp_f32 v152, v152
    v_exp_f32 v153, v153
    v_exp_f32 v154, v154
    s_mov_b64 exec, s[98:99]
    ds_read_b128 v[208:211], v9 offset:8192
    ds_read_b128 v[212:215], v9 offset:8704
    s_mov_b64 exec, -1
    s_waitcnt lgkmcnt(4)
    v_cvt_pk_bf16_f32 v227, v150, v151
    v_mfma_f32_32x32x16_bf16 v[80:95], v[36:39], v[244:247], v[80:95]
    s_add_u32 m0, s83, 0x18400
    v_exp_f32 v155, v155
    v_exp_f32 v156, v156
    v_exp_f32 v157, v157
    s_nop 0
    buffer_load_dwordx4 v11, s[60:63], s94 offen lds
    v_cvt_pk_bf16_f32 v228, v152, v153
    v_mfma_f32_32x32x16_bf16 v[176:191], v[216:219], v[224:227], v[176:191]
    s_add_u32 s94, s94, 128
    s_mov_b32 s80, 0x70000
    s_setprio 0
    v_exp_f32 v158, v158
    v_exp_f32 v159, v159
    v_cvt_pk_bf16_f32 v229, v154, v155
    v_cvt_pk_bf16_f32 v230, v156, v157
    ds_read_b128 v[240:243], v15 offset:16384
    ds_read_b128 v[244:247], v15 offset:20480
    s_add_u32 m0, s82, 0x26000
    s_nop 0
    buffer_load_dwordx4 v20, s[8:11], s80 offen lds
    s_waitcnt vmcnt(14) lgkmcnt(5)
    v_mfma_f32_32x32x16_bf16 v[64:79], v[40:43], v[232:235], v[64:79]
    v_exp_f32 v128, v128
    v_exp_f32 v129, v129
    v_exp_f32 v130, v130
    s_nop 0
    buffer_load_dwordx4 v[104:107], v2, s[52:55], s96 offen offset:2048 sc1
    v_cvt_pk_bf16_f32 v231, v158, v159
    v_mfma_f32_32x32x16_bf16 v[144:159], v[120:123], v[116:119], v[192:207]
    v_exp_f32 v131, v131
    v_exp_f32 v132, v132
    v_exp_f32 v133, v133
    ds_read_b128 v[124:127], v8 offset:9216
    s_waitcnt lgkmcnt(5)
    v_cvt_pk_bf16_f32 v224, v128, v129
    v_mfma_f32_32x32x16_bf16 v[80:95], v[40:43], v[236:239], v[80:95]
    v_exp_f32 v134, v134
    v_exp_f32 v135, v135
    v_cvt_pk_bf16_f32 v225, v130, v131
    v_cvt_pk_bf16_f32 v226, v132, v133
    s_waitcnt vmcnt(12) lgkmcnt(1)
    s_cmp_lg_u32 s64, 0
    s_cbranch_scc1 MPP_85
    s_mov_b32 s88, 0
    s_waitcnt vmcnt(6)
    s_branch PC_83
PL_82:
    buffer_load_dword v30, v31, s[52:55], 0 offen sc1
    s_waitcnt vmcnt(0)
PC_83:
    v_cmp_ne_u32 vcc, s22, v30
    s_nop 0
    s_cmp_eq_u64 vcc, 0
    s_cbranch_scc1 PD_84
    s_sleep 1
    s_add_u32 s88, s88, 1
    s_cmp_lt_u32 s88, 40000
    s_cbranch_scc1 PL_82
PD_84:
MPP_85:
    s_barrier
    v_mfma_f32_32x32x16_bf16 v[176:191], v[220:223], v[228:231], v[176:191]
    s_setprio 3
    v_exp_f32 v136, v136
    v_exp_f32 v137, v137
    v_exp_f32 v138, v138
    ds_read_b128 v[232:235], v12 offset:32768
    ds_read_b128 v[236:239], v12 offset:36864
    v_cvt_pk_bf16_f32 v227, v134, v135
    v_mfma_f32_32x32x16_bf16 v[64:79], v[44:47], v[240:243], v[64:79]
    v_exp_f32 v139, v139
    v_exp_f32 v140, v140
    v_exp_f32 v141, v141
    s_nop 0
    buffer_load_dwordx4 v[108:111], v2, s[52:55], s96 offen offset:3072 sc1
    v_cvt_pk_bf16_f32 v228, v136, v137
    v_mfma_f32_32x32x16_bf16 v[160:175], v[208:211], v[224:227], v[160:175]
    s_add_u32 s96, s96, 4096
    v_exp_f32 v142, v142
    v_exp_f32 v143, v143
    v_cvt_pk_bf16_f32 v229, v138, v139
    v_cvt_pk_bf16_f32 v230, v140, v141
    s_nop 1
    v_mfma_f32_32x32x16_bf16 v[80:95], v[44:47], v[244:247], v[80:95]
    s_add_u32 m0, s91, 0x0
    v_exp_f32 v144, v144
    v_exp_f32 v145, v145
    v_exp_f32 v146, v146
    buffer_load_dwordx4 v29, s[52:55], s95 offen sc1 lds
    s_waitcnt lgkmcnt(2)
    v_cvt_pk_bf16_f32 v231, v142, v143
    v_mfma_f32_32x32x16_bf16 v[128:143], v[124:127], v[112:115], v[192:207]
    s_add_u32 s95, s95, 2048
    s_setprio 2
    v_exp_f32 v147, v147
    v_exp_f32 v148, v148
    v_exp_f32 v149, v149
    ds_read_b128 v[240:243], v13 offset:32768
    ds_read_b128 v[244:247], v13 offset:36864
    s_waitcnt vmcnt(13) lgkmcnt(3)
    v_cvt_pk_bf16_f32 v224, v144, v145
    v_mfma_f32_32x32x16_bf16 v[64:79], v[48:51], v[232:235], v[64:79]
    s_mov_b32 s80, 0x30000
    s_add_u32 m0, s82, 0x1e000
    v_exp_f32 v150, v150
    v_exp_f32 v151, v151
    v_cvt_pk_bf16_f32 v225, v146, v147
    v_cvt_pk_bf16_f32 v226, v148, v149
    s_nop 0
    buffer_load_dwordx4 v20, s[4:7], s80 offen lds
    v_mfma_f32_32x32x16_bf16 v[160:175], v[212:215], v[228:231], v[160:175]
    v_exp_f32 v152, v152
    v_exp_f32 v153, v153
    v_exp_f32 v154, v154
    s_mov_b64 exec, s[98:99]
    ds_read_b128 v[216:219], v9 offset:9216
    ds_read_b128 v[220:223], v9 offset:9728
    s_mov_b64 exec, -1
    s_waitcnt lgkmcnt(4)
    v_cvt_pk_bf16_f32 v227, v150, v151
    v_mfma_f32_32x32x16_bf16 v[80:95], v[48:51], v[236:239], v[80:95]
    s_mov_b32 s80, 0x20000
    s_add_u32 m0, s82, 0x1c000
    v_exp_f32 v155, v155
    v_exp_f32 v156, v156
    v_exp_f32 v157, v157
    s_nop 0
    buffer_load_dwordx4 v20, s[4:7], s80 offen lds
    v_cvt_pk_bf16_f32 v228, v152, v153
    v_mfma_f32_32x32x16_bf16 v[176:191], v[208:211], v[224:227], v[176:191]
    s_setprio 1
    v_exp_f32 v158, v158
    v_exp_f32 v159, v159
    v_cvt_pk_bf16_f32 v229, v154, v155
    v_cvt_pk_bf16_f32 v230, v156, v157
    ds_read_b128 v[232:235], v14 offset:32768
    ds_read_b128 v[236:239], v14 offset:36864
    s_waitcnt vmcnt(14) lgkmcnt(5)
    s_lshl_b32 s72, s69, 1
    s_add_u32 s72, s72, s66
    s_lshl_b32 s73, s70, 2
    s_add_u32 s73, s73, s65
    s_mul_i32 s71, s72, 28
    s_add_u32 s71, s71, s73
    s_lshl_b32 s71, s71, 11
    s_add_u32 s71, s71, 0x600000
    buffer_load_dwordx4 v[32:35], v2, s[52:55], s71 offen offset:0 sc1
    buffer_load_dwordx4 v[36:39], v2, s[52:55], s71 offen offset:1024 sc1
    s_mul_i32 s71, s72, 44
    s_add_u32 s71, s71, s73
    s_lshl_b32 s71, s71, 11
    s_add_u32 s89, s71, 0xe08000
    v_xor_b32 v8, 16384, v8
    v_mfma_f32_32x32x16_bf16 v[64:79], v[52:55], v[240:243], v[64:79]
    v_exp_f32 v128, v128
    v_exp_f32 v129, v129
    v_exp_f32 v130, v130
    s_nop 1
    v_cvt_pk_bf16_f32 v231, v158, v159
    v_mfma_f32_32x32x16_bf16 v[144:159], v[124:127], v[116:119], v[192:207]
    v_exp_f32 v131, v131
    v_exp_f32 v132, v132
    v_exp_f32 v133, v133
    ds_read_b128 v[120:123], v8 offset:0
    s_waitcnt lgkmcnt(5)
    v_cvt_pk_bf16_f32 v224, v128, v129
    v_mfma_f32_32x32x16_bf16 v[80:95], v[52:55], v[244:247], v[80:95]
    v_exp_f32 v134, v134
    v_exp_f32 v135, v135
    v_cvt_pk_bf16_f32 v225, v130, v131
    v_cvt_pk_bf16_f32 v226, v132, v133
    s_nop 1
    v_mfma_f32_32x32x16_bf16 v[176:191], v[212:215], v[228:231], v[176:191]
    s_setprio 0
    v_exp_f32 v136, v136
    v_exp_f32 v137, v137
    v_exp_f32 v138, v138
    ds_read_b128 v[240:243], v15 offset:32768
    ds_read_b128 v[244:247], v15 offset:36864
    s_waitcnt vmcnt(15) lgkmcnt(4)
    v_cvt_pk_bf16_f32 v227, v134, v135
    v_mfma_f32_32x32x16_bf16 v[64:79], v[56:59], v[232:235], v[64:79]
    v_exp_f32 v139, v139
    v_exp_f32 v140, v140
    v_exp_f32 v141, v141
    s_nop 1
    v_cvt_pk_bf16_f32 v228, v136, v137
    v_mfma_f32_32x32x16_bf16 v[160:175], v[216:219], v[224:227], v[160:175]
    v_exp_f32 v142, v142
    v_exp_f32 v143, v143
    v_cvt_pk_bf16_f32 v229, v138, v139
    v_cvt_pk_bf16_f32 v230, v140, v141
    s_nop 0
    s_waitcnt lgkmcnt(3)
    v_xor_b32 v9, 16384, v9
    v_mfma_f32_32x32x16_bf16 v[80:95], v[56:59], v[236:239], v[80:95]
    v_exp_f32 v144, v144
    v_exp_f32 v145, v145
    v_exp_f32 v146, v146
    v_cvt_pk_bf16_f32 v231, v142, v143
    s_waitcnt vmcnt(8) lgkmcnt(0)
    s_barrier
    v_mfma_f32_32x32x16_bf16 v[128:143], v[120:123], v[112:115], v[192:207]
    s_setprio 3
    v_exp_f32 v147, v147
    v_exp_f32 v148, v148
    v_exp_f32 v149, v149
    ds_read_b128 v[232:235], v12 offset:0
    ds_read_b128 v[236:239], v12 offset:4096
    v_cvt_pk_bf16_f32 v224, v144, v145
    v_mfma_f32_32x32x16_bf16 v[64:79], v[60:63], v[240:243], v[64:79]
    s_mov_b32 s80, 0x40000
    s_add_u32 m0, s82, 0x20000
    v_exp_f32 v150, v150
    v_exp_f32 v151, v151
    v_cvt_pk_bf16_f32 v225, v146, v147
    v_cvt_pk_bf16_f32 v226, v148, v149
    s_nop 0
    buffer_load_dwordx4 v20, s[4:7], s80 offen lds
    v_mfma_f32_32x32x16_bf16 v[160:175], v[220:223], v[228:231], v[160:175]
    v_exp_f32 v152, v152
    v_exp_f32 v153, v153
    v_exp_f32 v154, v154
    s_mov_b64 exec, s[98:99]
    ds_read_b128 v[208:211], v9 offset:0
    ds_read_b128 v[212:215], v9 offset:512
    s_mov_b64 exec, -1
    v_cvt_pk_bf16_f32 v227, v150, v151
    v_mfma_f32_32x32x16_bf16 v[80:95], v[60:63], v[244:247], v[80:95]
    v_exp_f32 v155, v155
    v_exp_f32 v156, v156
    v_exp_f32 v157, v157
    s_nop 1
    v_cvt_pk_bf16_f32 v228, v152, v153
    v_mfma_f32_32x32x16_bf16 v[176:191], v[216:219], v[224:227], v[176:191]
    s_setprio 2
    v_exp_f32 v158, v158
    v_exp_f32 v159, v159
    v_cvt_pk_bf16_f32 v229, v154, v155
    v_cvt_pk_bf16_f32 v230, v156, v157
    ds_read_b128 v[240:243], v13 offset:0
    ds_read_b128 v[244:247], v13 offset:4096
    s_waitcnt lgkmcnt(5)
    v_mfma_f32_32x32x16_bf16 v[64:79], v[96:99], v[232:235], v[64:79]
    s_mov_b32 s80, 0x50000
    s_add_u32 m0, s82, 0x22000
    v_exp_f32 v128, v128
    v_exp_f32 v129, v129
    v_exp_f32 v130, v130
    s_nop 0
    buffer_load_dwordx4 v20, s[4:7], s80 offen lds
    v_cvt_pk_bf16_f32 v231, v158, v159
    v_mfma_f32_32x32x16_bf16 v[144:159], v[120:123], v[116:119], v[192:207]
    v_exp_f32 v131, v131
    v_exp_f32 v132, v132
    v_exp_f32 v133, v133
    ds_read_b128 v[124:127], v8 offset:1024
    s_waitcnt lgkmcnt(5)
    v_cvt_pk_bf16_f32 v224, v128, v129
    v_mfma_f32_32x32x16_bf16 v[80:95], v[96:99], v[236:239], v[80:95]
    v_exp_f32 v134, v134
    v_exp_f32 v135, v135
    v_cvt_pk_bf16_f32 v225, v130, v131
    v_cvt_pk_bf16_f32 v226, v132, v133
    s_nop 1
    v_mfma_f32_32x32x16_bf16 v[176:191], v[220:223], v[228:231], v[176:191]
    s_setprio 1
    v_exp_f32 v136, v136
    v_exp_f32 v137, v137
    v_exp_f32 v138, v138
    ds_read_b128 v[232:235], v14 offset:0
    ds_read_b128 v[236:239], v14 offset:4096
    s_waitcnt lgkmcnt(4)
    v_cvt_pk_bf16_f32 v227, v134, v135
    v_mfma_f32_32x32x16_bf16 v[64:79], v[100:103], v[240:243], v[64:79]
    v_exp_f32 v139, v139
    v_exp_f32 v140, v140
    v_exp_f32 v141, v141
    s_nop 1
    v_cvt_pk_bf16_f32 v228, v136, v137
    v_mfma_f32_32x32x16_bf16 v[160:175], v[208:211], v[224:227], v[160:175]
    v_exp_f32 v142, v142
    v_exp_f32 v143, v143
    v_cvt_pk_bf16_f32 v229, v138, v139
    v_cvt_pk_bf16_f32 v230, v140, v141
    s_nop 0
    s_waitcnt lgkmcnt(3)
    v_mfma_f32_32x32x16_bf16 v[80:95], v[100:103], v[244:247], v[80:95]
    v_exp_f32 v144, v144
    v_exp_f32 v145, v145
    v_exp_f32 v146, v146
    s_nop 0
    s_waitcnt lgkmcnt(2)
    v_cvt_pk_bf16_f32 v231, v142, v143
    v_mfma_f32_32x32x16_bf16 v[128:143], v[124:127], v[112:115], v[192:207]
    s_setprio 0
    v_exp_f32 v147, v147
    v_exp_f32 v148, v148
    v_exp_f32 v149, v149
    ds_read_b128 v[240:243], v15 offset:0
    ds_read_b128 v[244:247], v15 offset:4096
    s_waitcnt vmcnt(8) lgkmcnt(3)
    v_cvt_pk_bf16_f32 v224, v144, v145
    v_mfma_f32_32x32x16_bf16 v[64:79], v[104:107], v[232:235], v[64:79]
    v_exp_f32 v150, v150
    v_exp_f32 v151, v151
    v_cvt_pk_bf16_f32 v225, v146, v147
    v_cvt_pk_bf16_f32 v226, v148, v149
    s_nop 1
    v_mfma_f32_32x32x16_bf16 v[160:175], v[212:215], v[228:231], v[160:175]
    v_exp_f32 v152, v152
    v_exp_f32 v153, v153
    v_exp_f32 v154, v154
    s_mov_b64 exec, s[98:99]
    ds_read_b128 v[216:219], v9 offset:1024
    ds_read_b128 v[220:223], v9 offset:1536
    s_mov_b64 exec, -1
    s_waitcnt lgkmcnt(4)
    v_cvt_pk_bf16_f32 v227, v150, v151
    v_mfma_f32_32x32x16_bf16 v[80:95], v[104:107], v[236:239], v[80:95]
    v_exp_f32 v155, v155
    v_exp_f32 v156, v156
    v_exp_f32 v157, v157
    v_cvt_pk_bf16_f32 v228, v152, v153
    s_waitcnt lgkmcnt(2)
    s_barrier
    v_mfma_f32_32x32x16_bf16 v[176:191], v[208:211], v[224:227], v[176:191]
    s_setprio 3
    v_exp_f32 v158, v158
    v_exp_f32 v159, v159
    v_cvt_pk_bf16_f32 v229, v154, v155
    v_cvt_pk_bf16_f32 v230, v156, v157
    s_nop 0
    s_waitcnt vmcnt(7)
    s_waitcnt vmcnt(3)
    v_lshlrev_b32 v40, 16, v32
    v_and_b32 v41, 0xffff0000, v32
    v_lshlrev_b32 v42, 16, v33
    v_and_b32 v43, 0xffff0000, v33
    v_lshlrev_b32 v44, 16, v34
    v_and_b32 v45, 0xffff0000, v34
    v_lshlrev_b32 v46, 16, v35
    v_and_b32 v47, 0xffff0000, v35
    s_waitcnt vmcnt(2)
    v_lshlrev_b32 v48, 16, v36
    v_and_b32 v49, 0xffff0000, v36
    v_lshlrev_b32 v50, 16, v37
    v_and_b32 v51, 0xffff0000, v37
    v_lshlrev_b32 v52, 16, v38
    v_and_b32 v53, 0xffff0000, v38
    v_lshlrev_b32 v54, 16, v39
    v_and_b32 v55, 0xffff0000, v39
    v_mfma_f32_32x32x16_bf16 v[64:79], v[108:111], v[240:243], v[64:79]
    s_mov_b32 s80, 0x0
    s_add_u32 m0, s82, 0x18000
    v_exp_f32 v128, v128
    v_exp_f32 v129, v129
    v_exp_f32 v130, v130
    s_nop 0
    buffer_load_dwordx4 v20, s[4:7], s80 offen lds
    v_cvt_pk_bf16_f32 v231, v158, v159
    v_mfma_f32_32x32x16_bf16 v[144:159], v[124:127], v[116:119], v[192:207]
    v_exp_f32 v131, v131
    v_exp_f32 v132, v132
    v_exp_f32 v133, v133
    s_nop 0
    ds_read_b128 v[120:123], v8 offset:8192
    v_cvt_pk_bf16_f32 v224, v128, v129
    v_mfma_f32_32x32x16_bf16 v[80:95], v[108:111], v[244:247], v[80:95]
    s_add_u32 m0, s91, 0x2000
    v_exp_f32 v134, v134
    v_exp_f32 v135, v135
    v_cvt_pk_bf16_f32 v225, v130, v131
    v_cvt_pk_bf16_f32 v226, v132, v133
    s_nop 0
    buffer_load_dwordx4 v29, s[52:55], s95 offen sc1 lds
    v_mfma_f32_32x32x16_bf16 v[176:191], v[212:215], v[228:231], v[176:191]
    s_add_u32 s95, s95, 2048
    s_xor_b32 s91, s91, 16384
    s_setprio 2
    v_exp_f32 v136, v136
    v_exp_f32 v137, v137
    v_exp_f32 v138, v138
    v_cvt_pk_bf16_f32 v227, v134, v135
    s_mov_b32 s80, 0x10000
    s_add_u32 m0, s82, 0x1a000
    v_exp_f32 v139, v139
    v_exp_f32 v140, v140
    v_exp_f32 v141, v141
    buffer_load_dwordx4 v20, s[4:7], s80 offen lds
    s_waitcnt lgkmcnt(2)
    v_cvt_pk_bf16_f32 v228, v136, v137
    v_mfma_f32_32x32x16_bf16 v[160:175], v[216:219], v[224:227], v[160:175]
    v_exp_f32 v142, v142
    v_exp_f32 v143, v143
    v_cvt_pk_bf16_f32 v229, v138, v139
    v_cvt_pk_bf16_f32 v230, v140, v141
    s_lshl_b32 s71, s64, 13
    v_add_u32 v5, s71, v2
    ds_write_b128 v5, v[80:83] offset:0
    ds_write_b128 v5, v[84:87] offset:1024
    ds_write_b128 v5, v[88:91] offset:2048
    ds_write_b128 v5, v[92:95] offset:3072
    v_xor_b32 v19, 32768, v5
    v_exp_f32 v144, v144
    v_exp_f32 v145, v145
    v_exp_f32 v146, v146
    s_waitcnt lgkmcnt(4)
    v_cvt_pk_bf16_f32 v231, v142, v143
    v_mfma_f32_32x32x16_bf16 v[128:143], v[120:123], v[112:115], v[192:207]
    s_setprio 1
    v_exp_f32 v147, v147
    v_exp_f32 v148, v148
    v_exp_f32 v149, v149
    v_cvt_pk_bf16_f32 v224, v144, v145
    v_exp_f32 v150, v150
    v_exp_f32 v151, v151
    v_cvt_pk_bf16_f32 v225, v146, v147
    v_cvt_pk_bf16_f32 v226, v148, v149
    s_waitcnt lgkmcnt(0)
    s_barrier
    v_mfma_f32_32x32x16_bf16 v[160:175], v[220:223], v[228:231], v[160:175]
    v_exp_f32 v152, v152
    v_exp_f32 v153, v153
    v_exp_f32 v154, v154
    s_mov_b64 exec, s[98:99]
    ds_read_b128 v[208:211], v9 offset:8192
    ds_read_b128 v[212:215], v9 offset:8704
    s_mov_b64 exec, -1
    ds_read_b128 v[96:99], v19 offset:0
    ds_read_b128 v[100:103], v19 offset:1024
    ds_read_b128 v[104:107], v19 offset:2048
    ds_read_b128 v[108:111], v19 offset:3072
    v_cvt_pk_bf16_f32 v227, v150, v151
    v_exp_f32 v155, v155
    v_exp_f32 v156, v156
    v_exp_f32 v157, v157
    v_cvt_pk_bf16_f32 v228, v152, v153
    v_mfma_f32_32x32x16_bf16 v[176:191], v[216:219], v[224:227], v[176:191]
    s_setprio 0
    v_exp_f32 v158, v158
    v_exp_f32 v159, v159
    v_cvt_pk_bf16_f32 v229, v154, v155
    v_cvt_pk_bf16_f32 v230, v156, v157
    s_waitcnt lgkmcnt(3)
    v_pk_add_f32 v[64:65], v[64:65], v[96:97]
    v_pk_add_f32 v[66:67], v[66:67], v[98:99]
    s_waitcnt lgkmcnt(2)
    v_pk_add_f32 v[68:69], v[68:69], v[100:101]
    v_pk_add_f32 v[70:71], v[70:71], v[102:103]
    v_pk_mul_f32 v[64:65], v[64:65], v[40:41]
    v_pk_mul_f32 v[66:67], v[66:67], v[42:43]
    v_pk_mul_f32 v[68:69], v[68:69], v[44:45]
    v_pk_mul_f32 v[70:71], v[70:71], v[46:47]
    v_cvt_pk_bf16_f32 v32, v64, v65
    v_cvt_pk_bf16_f32 v33, v66, v67
    v_cvt_pk_bf16_f32 v34, v68, v69
    v_cvt_pk_bf16_f32 v35, v70, v71
    buffer_store_dwordx4 v[32:35], v2, s[52:55], s89 offen offset:0 sc1
    s_waitcnt lgkmcnt(1)
    v_pk_add_f32 v[72:73], v[72:73], v[104:105]
    v_pk_add_f32 v[74:75], v[74:75], v[106:107]
    s_waitcnt lgkmcnt(0)
    v_pk_add_f32 v[76:77], v[76:77], v[108:109]
    v_pk_add_f32 v[78:79], v[78:79], v[110:111]
    v_pk_mul_f32 v[72:73], v[72:73], v[48:49]
    v_pk_mul_f32 v[74:75], v[74:75], v[50:51]
    v_pk_mul_f32 v[76:77], v[76:77], v[52:53]
    v_pk_mul_f32 v[78:79], v[78:79], v[54:55]
    v_cvt_pk_bf16_f32 v36, v72, v73
    v_cvt_pk_bf16_f32 v37, v74, v75
    v_cvt_pk_bf16_f32 v38, v76, v77
    v_cvt_pk_bf16_f32 v39, v78, v79
    buffer_store_dwordx4 v[36:39], v2, s[52:55], s89 offen offset:1024 sc1
    v_exp_f32 v128, v128
    v_exp_f32 v129, v129
    v_exp_f32 v130, v130
    v_cvt_pk_bf16_f32 v231, v158, v159
    v_mfma_f32_32x32x16_bf16 v[144:159], v[120:123], v[116:119], v[192:207]
    v_exp_f32 v131, v131
    v_exp_f32 v132, v132
    v_exp_f32 v133, v133
    ds_read_b128 v[124:127], v8 offset:9216
    v_cvt_pk_bf16_f32 v224, v128, v129
    v_exp_f32 v134, v134
    v_exp_f32 v135, v135
    v_cvt_pk_bf16_f32 v225, v130, v131
    v_cvt_pk_bf16_f32 v226, v132, v133
    s_barrier
    v_mfma_f32_32x32x16_bf16 v[176:191], v[220:223], v[228:231], v[176:191]
    s_setprio 3
    v_exp_f32 v136, v136
    v_exp_f32 v137, v137
    v_exp_f32 v138, v138
    v_cvt_pk_bf16_f32 v227, v134, v135
    s_mov_b32 s80, 0x70000
    s_add_u32 m0, s82, 0x0
    v_exp_f32 v139, v139
    v_exp_f32 v140, v140
    v_exp_f32 v141, v141
    buffer_load_dwordx4 v20, s[4:7], s80 offen lds
    v_cvt_pk_bf16_f32 v228, v136, v137
    v_mfma_f32_32x32x16_bf16 v[160:175], v[208:211], v[224:227], v[160:175]
    v_exp_f32 v142, v142
    v_exp_f32 v143, v143
    v_cvt_pk_bf16_f32 v229, v138, v139
    v_cvt_pk_bf16_f32 v230, v140, v141
    s_mov_b32 s80, 0x80000
    s_add_u32 m0, s82, 0x2000
    v_exp_f32 v144, v144
    v_exp_f32 v145, v145
    v_exp_f32 v146, v146
    buffer_load_dwordx4 v20, s[4:7], s80 offen lds
    s_waitcnt lgkmcnt(0)
    v_cvt_pk_bf16_f32 v231, v142, v143
    v_mfma_f32_32x32x16_bf16 v[128:143], v[124:127], v[112:115], v[192:207]
    s_setprio 2
    v_exp_f32 v147, v147
    v_exp_f32 v148, v148
    v_exp_f32 v149, v149
    v_cvt_pk_bf16_f32 v224, v144, v145
    s_mov_b32 s80, 0x90000
    s_add_u32 m0, s82, 0x4000
    v_exp_f32 v150, v150
    v_exp_f32 v151, v151
    v_cvt_pk_bf16_f32 v225, v146, v147
    v_cvt_pk_bf16_f32 v226, v148, v149
    buffer_load_dwordx4 v20, s[4:7], s80 offen lds
    v_mfma_f32_32x32x16_bf16 v[160:175], v[212:215], v[228:231], v[160:175]
    v_exp_f32 v152, v152
    v_exp_f32 v153, v153
    v_exp_f32 v154, v154
    s_mov_b64 exec, s[98:99]
    ds_read_b128 v[216:219], v9 offset:9216
    ds_read_b128 v[220:223], v9 offset:9728
    s_mov_b64 exec, -1
    v_cvt_pk_bf16_f32 v227, v150, v151
    s_mov_b32 s80, 0xa0000
    s_add_u32 m0, s82, 0x6000
    v_exp_f32 v155, v155
    v_exp_f32 v156, v156
    v_exp_f32 v157, v157
    buffer_load_dwordx4 v20, s[4:7], s80 offen lds
    v_cvt_pk_bf16_f32 v228, v152, v153
    v_mfma_f32_32x32x16_bf16 v[176:191], v[208:211], v[224:227], v[176:191]
    s_setprio 1
    v_exp_f32 v158, v158
    v_exp_f32 v159, v159
    v_cvt_pk_bf16_f32 v229, v154, v155
    v_cvt_pk_bf16_f32 v230, v156, v157
    s_and_b32 s78, s64, 1
    s_lshr_b32 s79, s64, 1
    s_lshl_b32 s71, s69, 1
    s_add_u32 s71, s71, s78
    s_mul_i32 s71, s71, 88
    s_add_u32 s71, s71, s79
    s_lshl_b32 s77, s71, 10
    s_add_u32 s77, s77, 0xe08000
    v_xor_b32 v8, 16384, v8
    s_mov_b32 s80, 0xb0000
    s_add_u32 m0, s82, 0x8000
    v_exp_f32 v128, v128
    v_exp_f32 v129, v129
    v_exp_f32 v130, v130
    buffer_load_dwordx4 v20, s[4:7], s80 offen lds
    v_cvt_pk_bf16_f32 v231, v158, v159
    v_mfma_f32_32x32x16_bf16 v[144:159], v[124:127], v[116:119], v[192:207]
    v_exp_f32 v131, v131
    v_exp_f32 v132, v132
    v_exp_f32 v133, v133
    ds_read_b128 v[120:123], v8 offset:0
    v_cvt_pk_bf16_f32 v224, v128, v129
    s_mov_b32 s80, 0xc0000
    s_add_u32 m0, s82, 0xa000
    v_exp_f32 v134, v134
    v_exp_f32 v135, v135
    v_cvt_pk_bf16_f32 v225, v130, v131
    v_cvt_pk_bf16_f32 v226, v132, v133
    buffer_load_dwordx4 v20, s[4:7], s80 offen lds
    v_mfma_f32_32x32x16_bf16 v[176:191], v[212:215], v[228:231], v[176:191]
    s_setprio 0
    v_exp_f32 v136, v136
    v_exp_f32 v137, v137
    v_exp_f32 v138, v138
    v_cvt_pk_bf16_f32 v227, v134, v135
    s_mov_b32 s80, 0xd0000
    s_add_u32 m0, s82, 0xc000
    v_exp_f32 v139, v139
    v_exp_f32 v140, v140
    v_exp_f32 v141, v141
    buffer_load_dwordx4 v20, s[4:7], s80 offen lds
    s_waitcnt lgkmcnt(2)
    v_cvt_pk_bf16_f32 v228, v136, v137
    v_mfma_f32_32x32x16_bf16 v[160:175], v[216:219], v[224:227], v[160:175]
    v_exp_f32 v142, v142
    v_exp_f32 v143, v143
    v_cvt_pk_bf16_f32 v229, v138, v139
    v_cvt_pk_bf16_f32 v230, v140, v141
    v_xor_b32 v9, 16384, v9
    v_exp_f32 v144, v144
    v_exp_f32 v145, v145
    v_exp_f32 v146, v146
    v_cvt_pk_bf16_f32 v231, v142, v143
    s_waitcnt vmcnt(9) lgkmcnt(0)
    s_barrier
    v_mfma_f32_32x32x16_bf16 v[128:143], v[120:123], v[112:115], v[192:207]
    s_setprio 3
    v_exp_f32 v147, v147
    v_exp_f32 v148, v148
    v_exp_f32 v149, v149
    v_cvt_pk_bf16_f32 v224, v144, v145
    s_add_u32 s84, s77, 8192
    v_exp_f32 v150, v150
    v_exp_f32 v151, v151
    v_cvt_pk_bf16_f32 v225, v146, v147
    v_cvt_pk_bf16_f32 v226, v148, v149
    buffer_load_dwordx4 v[40:43], v2, s[52:55], s84 offen sc1
    v_mfma_f32_32x32x16_bf16 v[160:175], v[220:223], v[228:231], v[160:175]
    s_add_u32 s84, s77, 12288
    v_exp_f32 v152, v152
    v_exp_f32 v153, v153
    v_exp_f32 v154, v154
    s_mov_b64 exec, s[98:99]
    ds_read_b128 v[208:211], v9 offset:0
    ds_read_b128 v[212:215], v9 offset:512
    s_mov_b64 exec, -1
    buffer_load_dwordx4 v[44:47], v2, s[52:55], s84 offen sc1
    v_cvt_pk_bf16_f32 v227, v150, v151
    s_mov_b32 s80, 0x60000
    s_add_u32 m0, s82, 0xe000
    v_exp_f32 v155, v155
    v_exp_f32 v156, v156
    v_exp_f32 v157, v157
    buffer_load_dwordx4 v20, s[8:11], s80 offen lds
    s_add_u32 s84, s77, 16384
    buffer_load_dwordx4 v[48:51], v2, s[52:55], s84 offen sc1
    s_add_u32 s84, s77, 20480
    buffer_load_dwordx4 v[52:55], v2, s[52:55], s84 offen sc1
    v_cvt_pk_bf16_f32 v228, v152, v153
    v_mfma_f32_32x32x16_bf16 v[176:191], v[216:219], v[224:227], v[176:191]
    s_add_u32 s84, s77, 0
    s_setprio 2
    v_exp_f32 v158, v158
    v_exp_f32 v159, v159
    v_cvt_pk_bf16_f32 v229, v154, v155
    v_cvt_pk_bf16_f32 v230, v156, v157
    buffer_load_dwordx4 v[32:35], v2, s[52:55], s84 offen sc1
    s_add_u32 s84, s77, 4096
    buffer_load_dwordx4 v[36:39], v2, s[52:55], s84 offen sc1
    s_add_u32 s84, s77, 24576
    v_exp_f32 v128, v128
    v_exp_f32 v129, v129
    v_exp_f32 v130, v130
    buffer_load_dwordx4 v[56:59], v2, s[52:55], s84 offen sc1
    v_cvt_pk_bf16_f32 v231, v158, v159
    v_mfma_f32_32x32x16_bf16 v[144:159], v[120:123], v[116:119], v[192:207]
    v_exp_f32 v131, v131
    v_exp_f32 v132, v132
    v_exp_f32 v133, v133
    ds_read_b128 v[124:127], v8 offset:1024
    v_cvt_pk_bf16_f32 v224, v128, v129
    v_exp_f32 v134, v134
    v_exp_f32 v135, v135
    v_cvt_pk_bf16_f32 v225, v130, v131
    v_cvt_pk_bf16_f32 v226, v132, v133
    v_mfma_f32_32x32x16_bf16 v[176:191], v[220:223], v[228:231], v[176:191]
    s_setprio 1
    v_exp_f32 v136, v136
    v_exp_f32 v137, v137
    v_exp_f32 v138, v138
    ds_read_b64_tr_b16 v[232:233], v21 offset:0
    ds_read_b64_tr_b16 v[234:235], v21 offset:1024
    ds_read_b64_tr_b16 v[236:237], v22 offset:0
    ds_read_b64_tr_b16 v[238:239], v22 offset:1024
    v_cvt_pk_bf16_f32 v227, v134, v135
    v_exp_f32 v139, v139
    v_exp_f32 v140, v140
    v_exp_f32 v141, v141
    s_waitcnt lgkmcnt(6)
    v_cvt_pk_bf16_f32 v228, v136, v137
    v_mfma_f32_32x32x16_bf16 v[160:175], v[208:211], v[224:227], v[160:175]
    v_exp_f32 v142, v142
    v_exp_f32 v143, v143
    v_cvt_pk_bf16_f32 v229, v138, v139
    v_cvt_pk_bf16_f32 v230, v140, v141
    s_mov_b32 s88, 0
    s_waitcnt vmcnt(0)
    s_branch UC_102
UC_101:
    s_add_u32 s84, s77, 0
    v_and_b32 v5, 7, v1
    v_min_u32 v5, 6, v5
    v_lshlrev_b32 v5, 12, v5
    s_sleep 2
    buffer_load_dword v6, v5, s[52:55], s84 offen offset:1020 sc1
    s_add_u32 s88, s88, 1
    s_cmp_ge_u32 s88, 40000
    s_cbranch_scc1 UC_103
    s_waitcnt vmcnt(0)
    v_cmp_eq_u32 vcc, -1, v6
    s_nop 0
    s_cmp_lg_u64 vcc, 0
    s_cbranch_scc1 UC_101
    s_add_u32 s84, s77, 0
    buffer_load_dwordx4 v[32:35], v2, s[52:55], s84 offen sc1
    s_add_u32 s84, s77, 4096
    buffer_load_dwordx4 v[36:39], v2, s[52:55], s84 offen sc1
    s_add_u32 s84, s77, 8192
    buffer_load_dwordx4 v[40:43], v2, s[52:55], s84 offen sc1
    s_add_u32 s84, s77, 12288
    buffer_load_dwordx4 v[44:47], v2, s[52:55], s84 offen sc1
    s_add_u32 s84, s77, 16384
    buffer_load_dwordx4 v[48:51], v2, s[52:55], s84 offen sc1
    s_add_u32 s84, s77, 20480
    buffer_load_dwordx4 v[52:55], v2, s[52:55], s84 offen sc1
    s_add_u32 s84, s77, 24576
    buffer_load_dwordx4 v[56:59], v2, s[52:55], s84 offen sc1
    s_waitcnt vmcnt(0)
UC_102:
    v_max3_u32 v5, v32, v33, v34
    v_max3_u32 v6, v35, v36, v37
    v_max3_u32 v5, v5, v38, v39
    v_max3_u32 v6, v6, v40, v41
    v_max3_u32 v5, v5, v42, v43
    v_max3_u32 v6, v6, v44, v45
    v_max3_u32 v5, v5, v46, v47
    v_max3_u32 v6, v6, v48, v49
    v_max3_u32 v5, v5, v50, v51
    v_max3_u32 v6, v6, v52, v53
    v_max3_u32 v5, v5, v54, v55
    v_max3_u32 v6, v6, v56, v57
    v_max3_u32 v5, v5, v58, v59
    v_max_u32 v5, v5, v6
    v_cmp_eq_u32 vcc, -1, v5
    s_nop 0
    s_cmp_lg_u64 vcc, 0
    s_cbranch_scc1 UC_101
UC_103:
    v_exp_f32 v144, v144
    v_exp_f32 v145, v145
    v_exp_f32 v146, v146
    s_waitcnt lgkmcnt(4)
    v_cvt_pk_bf16_f32 v231, v142, v143
    v_mfma_f32_32x32x16_bf16 v[128:143], v[124:127], v[112:115], v[192:207]
    s_setprio 0
    v_exp_f32 v147, v147
    v_exp_f32 v148, v148
    v_exp_f32 v149, v149
    ds_read_b64_tr_b16 v[240:241], v21 offset:8192
    ds_read_b64_tr_b16 v[242:243], v21 offset:9216
    ds_read_b64_tr_b16 v[244:245], v22 offset:8192
    ds_read_b64_tr_b16 v[246:247], v22 offset:9216
    s_waitcnt lgkmcnt(6)
    v_cvt_pk_bf16_f32 v224, v144, v145
    v_mfma_f32_32x32x16_bf16 v[64:79], v[232:235], v[32:35], 0
    v_exp_f32 v150, v150
    v_exp_f32 v151, v151
    v_cvt_pk_bf16_f32 v225, v146, v147
    v_cvt_pk_bf16_f32 v226, v148, v149
    s_nop 1
    v_mfma_f32_32x32x16_bf16 v[160:175], v[212:215], v[228:231], v[160:175]
    v_exp_f32 v152, v152
    v_exp_f32 v153, v153
    v_exp_f32 v154, v154
    s_mov_b64 exec, s[98:99]
    ds_read_b128 v[216:219], v9 offset:1024
    ds_read_b128 v[220:223], v9 offset:1536
    s_mov_b64 exec, -1
    s_waitcnt lgkmcnt(6)
    v_cvt_pk_bf16_f32 v227, v150, v151
    v_mfma_f32_32x32x16_bf16 v[80:95], v[236:239], v[32:35], 0
    v_exp_f32 v155, v155
    v_exp_f32 v156, v156
    v_exp_f32 v157, v157
    v_cvt_pk_bf16_f32 v228, v152, v153
    s_waitcnt lgkmcnt(2)
    s_barrier
    v_mfma_f32_32x32x16_bf16 v[176:191], v[208:211], v[224:227], v[176:191]
    s_setprio 3
    v_exp_f32 v158, v158
    v_exp_f32 v159, v159
    v_cvt_pk_bf16_f32 v229, v154, v155
    v_cvt_pk_bf16_f32 v230, v156, v157
    s_xor_b32 s91, s91, 16384
    ds_read_b64_tr_b16 v[232:233], v21 offset:16384
    ds_read_b64_tr_b16 v[234:235], v21 offset:17408
    ds_read_b64_tr_b16 v[236:237], v22 offset:16384
    ds_read_b64_tr_b16 v[238:239], v22 offset:17408
    v_mfma_f32_32x32x16_bf16 v[64:79], v[240:243], v[36:39], v[64:79]
    s_mov_b32 s80, 0x0
    s_add_u32 m0, s82, 0x18000
    v_exp_f32 v128, v128
    v_exp_f32 v129, v129
    v_exp_f32 v130, v130
    s_nop 0
    buffer_load_dwordx4 v20, s[8:11], s80 offen lds
    v_cvt_pk_bf16_f32 v231, v158, v159
    v_mfma_f32_32x32x16_bf16 v[144:159], v[124:127], v[116:119], v[192:207]
    v_exp_f32 v131, v131
    v_exp_f32 v132, v132
    v_exp_f32 v133, v133
    s_nop 0
    ds_read_b128 v[120:123], v8 offset:8192
    v_cvt_pk_bf16_f32 v224, v128, v129
    v_mfma_f32_32x32x16_bf16 v[80:95], v[244:247], v[36:39], v[80:95]
    s_add_u32 s84, s77, 28672
    v_exp_f32 v134, v134
    v_exp_f32 v135, v135
    v_cvt_pk_bf16_f32 v225, v130, v131
    v_cvt_pk_bf16_f32 v226, v132, v133
    s_nop 0
    buffer_load_dwordx4 v[60:63], v2, s[52:55], s84 offen sc1
    v_mfma_f32_32x32x16_bf16 v[176:191], v[212:215], v[228:231], v[176:191]
    s_setprio 2
    v_exp_f32 v136, v136
    v_exp_f32 v137, v137
    v_exp_f32 v138, v138
    ds_read_b64_tr_b16 v[240:241], v21 offset:24576
    ds_read_b64_tr_b16 v[242:243], v21 offset:25600
    ds_read_b64_tr_b16 v[244:245], v22 offset:24576
    ds_read_b64_tr_b16 v[246:247], v22 offset:25600
    s_waitcnt lgkmcnt(7)
    v_cvt_pk_bf16_f32 v227, v134, v135
    v_mfma_f32_32x32x16_bf16 v[64:79], v[232:235], v[40:43], v[64:79]
    s_add_u32 s84, s77, 45056
    v_exp_f32 v139, v139
    v_exp_f32 v140, v140
    v_exp_f32 v141, v141
    s_nop 0
    buffer_load_dwordx4 v[108:111], v2, s[52:55], s84 offen sc1
    v_cvt_pk_bf16_f32 v228, v136, v137
    v_mfma_f32_32x32x16_bf16 v[160:175], v[216:219], v[224:227], v[160:175]
    s_add_u32 s84, s77, 49152
    v_exp_f32 v142, v142
    v_exp_f32 v143, v143
    v_cvt_pk_bf16_f32 v229, v138, v139
    v_cvt_pk_bf16_f32 v230, v140, v141
    buffer_load_dwordx4 v[248:251], v2, s[52:55], s84 offen sc1
    s_waitcnt lgkmcnt(5)
    v_mfma_f32_32x32x16_bf16 v[80:95], v[236:239], v[40:43], v[80:95]
    s_add_u32 s84, s77, 32768
    v_exp_f32 v144, v144
    v_exp_f32 v145, v145
    v_exp_f32 v146, v146
    buffer_load_dwordx4 v[96:99], v2, s[52:55], s84 offen sc1
    s_waitcnt lgkmcnt(4)
    v_cvt_pk_bf16_f32 v231, v142, v143
    v_mfma_f32_32x32x16_bf16 v[128:143], v[120:123], v[112:115], v[192:207]
    s_add_u32 s84, s77, 53248
    s_setprio 1
    v_exp_f32 v147, v147
    v_exp_f32 v148, v148
    v_exp_f32 v149, v149
    ds_read_b64_tr_b16 v[232:233], v21 offset:32768
    ds_read_b64_tr_b16 v[234:235], v21 offset:33792
    ds_read_b64_tr_b16 v[236:237], v22 offset:32768
    ds_read_b64_tr_b16 v[238:239], v22 offset:33792
    buffer_load_dwordx4 v[252:255], v2, s[52:55], s84 offen sc1
    s_waitcnt lgkmcnt(6)
    v_cvt_pk_bf16_f32 v224, v144, v145
    v_mfma_f32_32x32x16_bf16 v[64:79], v[240:243], v[44:47], v[64:79]
    s_mov_b32 s80, 0x10000
    s_add_u32 m0, s82, 0x1a000
    v_exp_f32 v150, v150
    v_exp_f32 v151, v151
    v_cvt_pk_bf16_f32 v225, v146, v147
    v_cvt_pk_bf16_f32 v226, v148, v149
    s_nop 0
    buffer_load_dwordx4 v20, s[8:11], s80 offen lds
    v_mfma_f32_32x32x16_bf16 v[160:175], v[220:223], v[228:231], v[160:175]
    s_lshl_b32 s71, s69, 1
    s_add_u32 s71, s71, s78
    v_exp_f32 v152, v152
    v_exp_f32 v153, v153
    v_exp_f32 v154, v154
    s_mov_b64 exec, s[98:99]
    ds_read_b128 v[208:211], v9 offset:8192
    ds_read_b128 v[212:215], v9 offset:8704
    s_mov_b64 exec, -1
    s_lshl_b32 s71, s71, 7
    s_add_u32 s71, s71, 0x1400000
    v_and_b32 v23, 31, v1
    v_lshlrev_b32 v23, 2, v23
    buffer_load_dword v23, v23, s[52:55], s71 offen sc1
    s_waitcnt lgkmcnt(6)
    v_cvt_pk_bf16_f32 v227, v150, v151
    v_mfma_f32_32x32x16_bf16 v[80:95], v[244:247], v[44:47], v[80:95]
    s_add_u32 s84, s77, 36864
    v_exp_f32 v155, v155
    v_exp_f32 v156, v156
    v_exp_f32 v157, v157
    s_nop 0
    buffer_load_dwordx4 v[100:103], v2, s[52:55], s84 offen sc1
    v_cvt_pk_bf16_f32 v228, v152, v153
    v_mfma_f32_32x32x16_bf16 v[176:191], v[216:219], v[224:227], v[176:191]
    s_setprio 0
    v_exp_f32 v158, v158
    v_exp_f32 v159, v159
    v_cvt_pk_bf16_f32 v229, v154, v155
    v_cvt_pk_bf16_f32 v230, v156, v157
    ds_read_b64_tr_b16 v[240:241], v21 offset:40960
    ds_read_b64_tr_b16 v[242:243], v21 offset:41984
    ds_read_b64_tr_b16 v[244:245], v22 offset:40960
    ds_read_b64_tr_b16 v[246:247], v22 offset:41984
    s_waitcnt lgkmcnt(8)
    v_mfma_f32_32x32x16_bf16 v[64:79], v[232:235], v[48:51], v[64:79]
    s_add_u32 s84, s77, 40960
    v_exp_f32 v128, v128
    v_exp_f32 v129, v129
    v_exp_f32 v130, v130
    s_nop 0
    buffer_load_dwordx4 v[104:107], v2, s[52:55], s84 offen sc1
    v_cvt_pk_bf16_f32 v231, v158, v159
    v_mfma_f32_32x32x16_bf16 v[144:159], v[120:123], v[116:119], v[192:207]
    v_exp_f32 v131, v131
    v_exp_f32 v132, v132
    v_exp_f32 v133, v133
    ds_read_b128 v[124:127], v8 offset:9216
    s_waitcnt lgkmcnt(7)
    v_cvt_pk_bf16_f32 v224, v128, v129
    v_mfma_f32_32x32x16_bf16 v[80:95], v[236:239], v[48:51], v[80:95]
    v_exp_f32 v134, v134
    v_exp_f32 v135, v135
    v_cvt_pk_bf16_f32 v225, v130, v131
    v_cvt_pk_bf16_f32 v226, v132, v133
    s_waitcnt lgkmcnt(1)
    s_barrier
    v_mfma_f32_32x32x16_bf16 v[176:191], v[220:223], v[228:231], v[176:191]
    s_setprio 3
    v_exp_f32 v136, v136
    v_exp_f32 v137, v137
    v_exp_f32 v138, v138
    ds_read_b64_tr_b16 v[232:233], v21 offset:49152
    ds_read_b64_tr_b16 v[234:235], v21 offset:50176
    ds_read_b64_tr_b16 v[236:237], v22 offset:49152
    ds_read_b64_tr_b16 v[238:239], v22 offset:50176
    v_cvt_pk_bf16_f32 v227, v134, v135
    v_mfma_f32_32x32x16_bf16 v[64:79], v[240:243], v[52:55], v[64:79]
    s_mov_b32 s80, 0x30000
    s_add_u32 m0, s82, 0x1e000
    v_exp_f32 v139, v139
    v_exp_f32 v140, v140
    v_exp_f32 v141, v141
    s_nop 0
    buffer_load_dwordx4 v20, s[8:11], s80 offen lds
    v_cvt_pk_bf16_f32 v228, v136, v137
    v_mfma_f32_32x32x16_bf16 v[160:175], v[208:211], v[224:227], v[160:175]
    v_exp_f32 v142, v142
    v_exp_f32 v143, v143
    v_cvt_pk_bf16_f32 v229, v138, v139
    v_cvt_pk_bf16_f32 v230, v140, v141
    s_nop 1
    v_mfma_f32_32x32x16_bf16 v[80:95], v[244:247], v[52:55], v[80:95]
    s_mov_b32 s80, 0x20000
    s_add_u32 m0, s82, 0x1c000
    v_exp_f32 v144, v144
    v_exp_f32 v145, v145
    v_exp_f32 v146, v146
    buffer_load_dwordx4 v20, s[8:11], s80 offen lds
    s_waitcnt lgkmcnt(4)
    v_cvt_pk_bf16_f32 v231, v142, v143
    v_mfma_f32_32x32x16_bf16 v[128:143], v[124:127], v[112:115], v[192:207]
    s_mov_b32 s80, 0x40000
    s_add_u32 m0, s82, 0x20000
    s_setprio 2
    v_exp_f32 v147, v147
    v_exp_f32 v148, v148
    v_exp_f32 v149, v149
    v_subrev_u32 v21, 98304, v21
    v_subrev_u32 v22, 98304, v22
    ds_read_b64_tr_b16 v[240:241], v21 offset:0
    ds_read_b64_tr_b16 v[242:243], v21 offset:1024
    ds_read_b64_tr_b16 v[244:245], v22 offset:0
    ds_read_b64_tr_b16 v[246:247], v22 offset:1024
    buffer_load_dwordx4 v20, s[8:11], s80 offen lds
    s_waitcnt lgkmcnt(6)
    v_cvt_pk_bf16_f32 v224, v144, v145
    v_mfma_f32_32x32x16_bf16 v[64:79], v[232:235], v[56:59], v[64:79]
    s_mov_b32 s80, 0x50000
    s_add_u32 m0, s82, 0x22000
    v_exp_f32 v150, v150
    v_exp_f32 v151, v151
    v_cvt_pk_bf16_f32 v225, v146, v147
    v_cvt_pk_bf16_f32 v226, v148, v149
    s_nop 0
    buffer_load_dwordx4 v20, s[8:11], s80 offen lds
    v_mfma_f32_32x32x16_bf16 v[160:175], v[212:215], v[228:231], v[160:175]
    v_exp_f32 v152, v152
    v_exp_f32 v153, v153
    v_exp_f32 v154, v154
    s_mov_b64 exec, s[98:99]
    ds_read_b128 v[216:219], v9 offset:9216
    ds_read_b128 v[220:223], v9 offset:9728
    s_mov_b64 exec, -1
    s_waitcnt lgkmcnt(6)
    v_cvt_pk_bf16_f32 v227, v150, v151
    v_mfma_f32_32x32x16_bf16 v[80:95], v[236:239], v[56:59], v[80:95]
    v_exp_f32 v155, v155
    v_exp_f32 v156, v156
    v_exp_f32 v157, v157
    s_nop 1
    v_cvt_pk_bf16_f32 v228, v152, v153
    v_mfma_f32_32x32x16_bf16 v[176:191], v[208:211], v[224:227], v[176:191]
    s_setprio 1
    v_exp_f32 v158, v158
    v_exp_f32 v159, v159
    v_cvt_pk_bf16_f32 v229, v154, v155
    v_cvt_pk_bf16_f32 v230, v156, v157
    ds_read_b64_tr_b16 v[232:233], v21 offset:8192
    ds_read_b64_tr_b16 v[234:235], v21 offset:9216
    ds_read_b64_tr_b16 v[236:237], v22 offset:8192
    ds_read_b64_tr_b16 v[238:239], v22 offset:9216
    s_waitcnt lgkmcnt(8)
    s_mov_b32 s88, 0
    s_waitcnt vmcnt(4)
    s_branch UC_105
UC_104:
    s_add_u32 s84, s77, 28672
    v_and_b32 v5, 7, v1
    v_min_u32 v5, 6, v5
    v_lshlrev_b32 v5, 12, v5
    s_sleep 2
    buffer_load_dword v6, v5, s[52:55], s84 offen offset:1020 sc1
    s_add_u32 s88, s88, 1
    s_cmp_ge_u32 s88, 40000
    s_cbranch_scc1 UC_106
    s_waitcnt vmcnt(0)
    v_cmp_eq_u32 vcc, -1, v6
    s_nop 0
    s_cmp_lg_u64 vcc, 0
    s_cbranch_scc1 UC_104
    s_add_u32 s84, s77, 28672
    buffer_load_dwordx4 v[60:63], v2, s[52:55], s84 offen sc1
    s_add_u32 s84, s77, 32768
    buffer_load_dwordx4 v[96:99], v2, s[52:55], s84 offen sc1
    s_add_u32 s84, s77, 36864
    buffer_load_dwordx4 v[100:103], v2, s[52:55], s84 offen sc1
    s_add_u32 s84, s77, 40960
    buffer_load_dwordx4 v[104:107], v2, s[52:55], s84 offen sc1
    s_add_u32 s84, s77, 45056
    buffer_load_dwordx4 v[108:111], v2, s[52:55], s84 offen sc1
    s_add_u32 s84, s77, 49152
    buffer_load_dwordx4 v[248:251], v2, s[52:55], s84 offen sc1
    s_add_u32 s84, s77, 53248
    buffer_load_dwordx4 v[252:255], v2, s[52:55], s84 offen sc1
    s_waitcnt vmcnt(0)
UC_105:
    v_max3_u32 v5, v60, v61, v62
    v_max3_u32 v6, v63, v96, v97
    v_max3_u32 v5, v5, v98, v99
    v_max3_u32 v6, v6, v100, v101
    v_max3_u32 v5, v5, v102, v103
    v_max3_u32 v6, v6, v104, v105
    v_max3_u32 v5, v5, v106, v107
    v_max3_u32 v6, v6, v108, v109
    v_max3_u32 v5, v5, v110, v111
    v_max3_u32 v6, v6, v248, v249
    v_max3_u32 v5, v5, v250, v251
    v_max3_u32 v6, v6, v252, v253
    v_max3_u32 v5, v5, v254, v255
    v_max_u32 v5, v5, v6
    v_cmp_eq_u32 vcc, -1, v5
    s_nop 0
    s_cmp_lg_u64 vcc, 0
    s_cbranch_scc1 UC_104
UC_106:
    v_mfma_f32_32x32x16_bf16 v[64:79], v[240:243], v[60:63], v[64:79]
    v_exp_f32 v128, v128
    v_exp_f32 v129, v129
    v_exp_f32 v130, v130
    s_nop 1
    v_cvt_pk_bf16_f32 v231, v158, v159
    v_mfma_f32_32x32x16_bf16 v[144:159], v[124:127], v[116:119], v[192:207]
    v_exp_f32 v131, v131
    v_exp_f32 v132, v132
    v_exp_f32 v133, v133
    s_nop 0
    s_waitcnt lgkmcnt(6)
    v_cvt_pk_bf16_f32 v224, v128, v129
    v_mfma_f32_32x32x16_bf16 v[80:95], v[244:247], v[60:63], v[80:95]
    v_exp_f32 v134, v134
    v_exp_f32 v135, v135
    v_cvt_pk_bf16_f32 v225, v130, v131
    v_cvt_pk_bf16_f32 v226, v132, v133
    s_nop 1
    v_mfma_f32_32x32x16_bf16 v[176:191], v[212:215], v[228:231], v[176:191]
    s_setprio 0
    v_exp_f32 v136, v136
    v_exp_f32 v137, v137
    v_exp_f32 v138, v138
    ds_read_b64_tr_b16 v[240:241], v21 offset:16384
    ds_read_b64_tr_b16 v[242:243], v21 offset:17408
    ds_read_b64_tr_b16 v[244:245], v22 offset:16384
    ds_read_b64_tr_b16 v[246:247], v22 offset:17408
    s_waitcnt lgkmcnt(6)
    v_cvt_pk_bf16_f32 v227, v134, v135
    v_mfma_f32_32x32x16_bf16 v[64:79], v[232:235], v[96:99], v[64:79]
    v_exp_f32 v139, v139
    v_exp_f32 v140, v140
    v_exp_f32 v141, v141
    s_nop 1
    v_cvt_pk_bf16_f32 v228, v136, v137
    v_mfma_f32_32x32x16_bf16 v[160:175], v[216:219], v[224:227], v[160:175]
    v_exp_f32 v142, v142
    v_exp_f32 v143, v143
    v_cvt_pk_bf16_f32 v229, v138, v139
    v_cvt_pk_bf16_f32 v230, v140, v141
    s_nop 0
    s_waitcnt lgkmcnt(4)
    s_add_u32 s71, s83, 65536
    s_add_u32 s72, s82, 81920
    v_add_u32 v8, s71, v2
    v_add_u32 v9, s72, v2
    v_mfma_f32_32x32x16_bf16 v[80:95], v[236:239], v[96:99], v[80:95]
    v_exp_f32 v144, v144
    v_exp_f32 v145, v145
    v_exp_f32 v146, v146
    v_cvt_pk_bf16_f32 v231, v142, v143
    s_setprio 3
    v_exp_f32 v147, v147
    v_exp_f32 v148, v148
    v_exp_f32 v149, v149
    ds_read_b64_tr_b16 v[232:233], v21 offset:24576
    ds_read_b64_tr_b16 v[234:235], v21 offset:25600
    ds_read_b64_tr_b16 v[236:237], v22 offset:24576
    ds_read_b64_tr_b16 v[238:239], v22 offset:25600
    s_waitcnt lgkmcnt(6)
    v_cvt_pk_bf16_f32 v224, v144, v145
    v_mfma_f32_32x32x16_bf16 v[64:79], v[240:243], v[100:103], v[64:79]
    v_exp_f32 v150, v150
    v_exp_f32 v151, v151
    v_cvt_pk_bf16_f32 v225, v146, v147
    v_cvt_pk_bf16_f32 v226, v148, v149
    s_nop 1
    v_mfma_f32_32x32x16_bf16 v[160:175], v[220:223], v[228:231], v[160:175]
    v_exp_f32 v152, v152
    v_exp_f32 v153, v153
    v_exp_f32 v154, v154
    s_nop 0
    s_waitcnt lgkmcnt(4)
    v_cvt_pk_bf16_f32 v227, v150, v151
    v_mfma_f32_32x32x16_bf16 v[80:95], v[244:247], v[100:103], v[80:95]
    v_exp_f32 v155, v155
    v_exp_f32 v156, v156
    v_exp_f32 v157, v157
    s_nop 1
    v_cvt_pk_bf16_f32 v228, v152, v153
    v_mfma_f32_32x32x16_bf16 v[176:191], v[216:219], v[224:227], v[176:191]
    s_setprio 2
    v_exp_f32 v158, v158
    v_exp_f32 v159, v159
    v_cvt_pk_bf16_f32 v229, v154, v155
    v_cvt_pk_bf16_f32 v230, v156, v157
    ds_read_b64_tr_b16 v[240:241], v21 offset:32768
    ds_read_b64_tr_b16 v[242:243], v21 offset:33792
    ds_read_b64_tr_b16 v[244:245], v22 offset:32768
    ds_read_b64_tr_b16 v[246:247], v22 offset:33792
    ds_write_b128 v8, v[160:163] offset:0
    ds_write_b128 v8, v[164:167] offset:1024
    ds_write_b32 v9, v168
    s_branch FK_ATT_EPI
FK_NOSP:
    v_exp_f32 v128, v128
    v_exp_f32 v129, v129
    v_exp_f32 v130, v130
    v_mfma_f32_32x32x16_bf16 v[144:159], v[120:123], v[116:119], v[192:207]
    v_exp_f32 v131, v131
    v_exp_f32 v132, v132
    v_exp_f32 v133, v133
    ds_read_b128 v[124:127], v8 offset:1024
    v_mov_b32 v96, -1
    v_mov_b32 v97, -1
    v_mov_b32 v98, -1
    v_mov_b32 v99, -1
    s_mul_i32 s89, s69, 180224
    s_add_u32 s89, s89, s82
    s_add_u32 s89, s89, 0xe00000
    s_and_b32 s76, s69, 3
    s_lshl_b32 s76, s76, 13
    s_add_u32 s76, s76, s82
    s_add_u32 s75, s76, 458752
    v_cvt_pk_bf16_f32 v224, v128, v129
    s_add_u32 m0, s82, 0x0
    v_exp_f32 v134, v134
    v_exp_f32 v135, v135
    v_cvt_pk_bf16_f32 v225, v130, v131
    v_cvt_pk_bf16_f32 v226, v132, v133
    buffer_load_dwordx4 v2, s[8:11], s75 offen lds
    s_add_u32 s75, s75, 32768
    s_setprio 1
    v_exp_f32 v136, v136
    v_exp_f32 v137, v137
    v_exp_f32 v138, v138
    v_cvt_pk_bf16_f32 v227, v134, v135
    v_exp_f32 v139, v139
    v_exp_f32 v140, v140
    v_exp_f32 v141, v141
    s_waitcnt lgkmcnt(2)
    v_cvt_pk_bf16_f32 v228, v136, v137
    v_mfma_f32_32x32x16_bf16 v[160:175], v[208:211], v[224:227], 0
    v_exp_f32 v142, v142
    v_exp_f32 v143, v143
    v_cvt_pk_bf16_f32 v229, v138, v139
    v_cvt_pk_bf16_f32 v230, v140, v141
    v_exp_f32 v144, v144
    v_exp_f32 v145, v145
    v_exp_f32 v146, v146
    s_waitcnt lgkmcnt(0)
    v_cvt_pk_bf16_f32 v231, v142, v143
    v_mfma_f32_32x32x16_bf16 v[128:143], v[124:127], v[112:115], v[192:207]
    s_setprio 0
    v_exp_f32 v147, v147
    v_exp_f32 v148, v148
    v_exp_f32 v149, v149
    v_cvt_pk_bf16_f32 v224, v144, v145
    s_add_u32 m0, s82, 0x0
    v_exp_f32 v150, v150
    v_exp_f32 v151, v151
    v_cvt_pk_bf16_f32 v225, v146, v147
    v_cvt_pk_bf16_f32 v226, v148, v149
    buffer_load_dwordx4 v2, s[8:11], s75 offen lds
    v_mfma_f32_32x32x16_bf16 v[160:175], v[212:215], v[228:231], v[160:175]
    s_sub_u32 s75, s75, 491520
    v_exp_f32 v152, v152
    v_exp_f32 v153, v153
    v_exp_f32 v154, v154
    s_mov_b64 exec, s[98:99]
    ds_read_b128 v[216:219], v9 offset:1024
    ds_read_b128 v[220:223], v9 offset:1536
    s_mov_b64 exec, -1
    v_cvt_pk_bf16_f32 v227, v150, v151
    v_exp_f32 v155, v155
    v_exp_f32 v156, v156
    v_exp_f32 v157, v157
    v_cvt_pk_bf16_f32 v228, v152, v153
    s_cmp_lg_u32 s64, 0
    s_cbranch_scc1 KSP_110
    s_mov_b32 s88, 0
    s_waitcnt vmcnt(4)
    s_branch PC_108
PL_107:
    buffer_load_dword v30, v31, s[52:55], 0 offen sc1
    s_waitcnt vmcnt(0)
PC_108:
    v_cmp_ne_u32 vcc, s22, v30
    s_nop 0
    s_cmp_eq_u64 vcc, 0
    s_cbranch_scc1 PD_109
    s_sleep 1
    s_add_u32 s88, s88, 1
    s_cmp_lt_u32 s88, 40000
    s_cbranch_scc1 PL_107
PD_109:
KSP_110:
    s_barrier
    v_mfma_f32_32x32x16_bf16 v[176:191], v[208:211], v[224:227], 0
    s_setprio 3
    v_exp_f32 v158, v158
    v_exp_f32 v159, v159
    v_cvt_pk_bf16_f32 v229, v154, v155
    v_cvt_pk_bf16_f32 v230, v156, v157
    v_exp_f32 v128, v128
    v_exp_f32 v129, v129
    v_exp_f32 v130, v130
    buffer_store_dwordx4 v[96:99], v2, s[52:55], s89 offen sc1
    v_cvt_pk_bf16_f32 v231, v158, v159
    v_mfma_f32_32x32x16_bf16 v[144:159], v[124:127], v[116:119], v[192:207]
    s_add_u32 s89, s89, 8192
    v_exp_f32 v131, v131
    v_exp_f32 v132, v132
    v_exp_f32 v133, v133
    ds_read_b128 v[120:123], v8 offset:8192
    v_cvt_pk_bf16_f32 v224, v128, v129
    s_add_u32 m0, s91, 0x2000
    v_exp_f32 v134, v134
    v_exp_f32 v135, v135
    v_cvt_pk_bf16_f32 v225, v130, v131
    v_cvt_pk_bf16_f32 v226, v132, v133
    buffer_load_dwordx4 v29, s[52:55], s95 offen sc1 lds
    v_mfma_f32_32x32x16_bf16 v[176:191], v[212:215], v[228:231], v[176:191]
    s_add_u32 s95, s95, 2048
    s_xor_b32 s91, s91, 16384
    s_setprio 2
    v_exp_f32 v136, v136
    v_exp_f32 v137, v137
    v_exp_f32 v138, v138
    v_cvt_pk_bf16_f32 v227, v134, v135
    s_add_u32 m0, s82, 0x0
    v_exp_f32 v139, v139
    v_exp_f32 v140, v140
    v_exp_f32 v141, v141
    buffer_load_dwordx4 v2, s[8:11], s75 offen lds
    s_waitcnt lgkmcnt(2)
    v_cvt_pk_bf16_f32 v228, v136, v137
    v_mfma_f32_32x32x16_bf16 v[160:175], v[216:219], v[224:227], v[160:175]
    s_add_u32 s75, s75, 32768
    v_exp_f32 v142, v142
    v_exp_f32 v143, v143
    v_cvt_pk_bf16_f32 v229, v138, v139
    v_cvt_pk_bf16_f32 v230, v140, v141
    v_exp_f32 v144, v144
    v_exp_f32 v145, v145
    v_exp_f32 v146, v146
    buffer_store_dwordx4 v[96:99], v2, s[52:55], s89 offen sc1
    s_waitcnt lgkmcnt(0)
    v_cvt_pk_bf16_f32 v231, v142, v143
    v_mfma_f32_32x32x16_bf16 v[128:143], v[120:123], v[112:115], v[192:207]
    s_add_u32 s89, s89, 8192
    s_setprio 1
    v_exp_f32 v147, v147
    v_exp_f32 v148, v148
    v_exp_f32 v149, v149
    v_cvt_pk_bf16_f32 v224, v144, v145
    s_add_u32 m0, s82, 0x0
    v_exp_f32 v150, v150
    v_exp_f32 v151, v151
    v_cvt_pk_bf16_f32 v225, v146, v147
    v_cvt_pk_bf16_f32 v226, v148, v149
    buffer_load_dwordx4 v2, s[8:11], s75 offen lds
    v_mfma_f32_32x32x16_bf16 v[160:175], v[220:223], v[228:231], v[160:175]
    s_add_u32 s75, s75, 32768
    v_exp_f32 v152, v152
    v_exp_f32 v153, v153
    v_exp_f32 v154, v154
    s_mov_b64 exec, s[98:99]
    ds_read_b128 v[208:211], v9 offset:8192
    ds_read_b128 v[212:215], v9 offset:8704
    s_mov_b64 exec, -1
    v_cvt_pk_bf16_f32 v227, v150, v151
    v_exp_f32 v155, v155
    v_exp_f32 v156, v156
    v_exp_f32 v157, v157
    v_cvt_pk_bf16_f32 v228, v152, v153
    v_mfma_f32_32x32x16_bf16 v[176:191], v[216:219], v[224:227], v[176:191]
    s_setprio 0
    v_exp_f32 v158, v158
    v_exp_f32 v159, v159
    v_cvt_pk_bf16_f32 v229, v154, v155
    v_cvt_pk_bf16_f32 v230, v156, v157
    v_exp_f32 v128, v128
    v_exp_f32 v129, v129
    v_exp_f32 v130, v130
    buffer_store_dwordx4 v[96:99], v2, s[52:55], s89 offen sc1
    v_cvt_pk_bf16_f32 v231, v158, v159
    v_mfma_f32_32x32x16_bf16 v[144:159], v[120:123], v[116:119], v[192:207]
    s_add_u32 s89, s89, 8192
    v_exp_f32 v131, v131
    v_exp_f32 v132, v132
    v_exp_f32 v133, v133
    ds_read_b128 v[124:127], v8 offset:9216
    v_cvt_pk_bf16_f32 v224, v128, v129
    v_exp_f32 v134, v134
    v_exp_f32 v135, v135
    v_cvt_pk_bf16_f32 v225, v130, v131
    v_cvt_pk_bf16_f32 v226, v132, v133
    s_waitcnt vmcnt(10)
    s_barrier
    v_mfma_f32_32x32x16_bf16 v[176:191], v[220:223], v[228:231], v[176:191]
    s_setprio 3
    v_exp_f32 v136, v136
    v_exp_f32 v137, v137
    v_exp_f32 v138, v138
    s_cmp_lg_u32 s64, 0
    s_cbranch_scc1 FL_111
    v_mov_b32 v5, s22
    s_mov_b64 exec, 0x10000
    buffer_store_dword v5, v3, s[52:55], 0 offen sc1
    s_mov_b64 exec, -1
FL_111:
    v_cvt_pk_bf16_f32 v227, v134, v135
    s_add_u32 m0, s91, 0x0
    v_exp_f32 v139, v139
    v_exp_f32 v140, v140
    v_exp_f32 v141, v141
    buffer_load_dwordx4 v29, s[52:55], s95 offen sc1 lds
    s_waitcnt lgkmcnt(2)
    v_cvt_pk_bf16_f32 v228, v136, v137
    v_mfma_f32_32x32x16_bf16 v[160:175], v[208:211], v[224:227], v[160:175]
    s_add_u32 s95, s95, 2048
    v_exp_f32 v142, v142
    v_exp_f32 v143, v143
    v_cvt_pk_bf16_f32 v229, v138, v139
    v_cvt_pk_bf16_f32 v230, v140, v141
    s_add_u32 m0, s82, 0x0
    v_exp_f32 v144, v144
    v_exp_f32 v145, v145
    v_exp_f32 v146, v146
    buffer_load_dwordx4 v2, s[8:11], s75 offen lds
    s_waitcnt lgkmcnt(0)
    v_cvt_pk_bf16_f32 v231, v142, v143
    v_mfma_f32_32x32x16_bf16 v[128:143], v[124:127], v[112:115], v[192:207]
    s_add_u32 s75, s75, 32768
    s_setprio 2
    v_exp_f32 v147, v147
    v_exp_f32 v148, v148
    v_exp_f32 v149, v149
    v_cvt_pk_bf16_f32 v224, v144, v145
    s_add_u32 m0, s82, 0x0
    v_exp_f32 v150, v150
    v_exp_f32 v151, v151
    v_cvt_pk_bf16_f32 v225, v146, v147
    v_cvt_pk_bf16_f32 v226, v148, v149
    buffer_load_dwordx4 v2, s[8:11], s75 offen lds
    v_mfma_f32_32x32x16_bf16 v[160:175], v[212:215], v[228:231], v[160:175]
    s_add_u32 s75, s75, 32768
    v_exp_f32 v152, v152
    v_exp_f32 v153, v153
    v_exp_f32 v154, v154
    s_mov_b64 exec, s[98:99]
    ds_read_b128 v[216:219], v9 offset:9216
    ds_read_b128 v[220:223], v9 offset:9728
    s_mov_b64 exec, -1
    v_cvt_pk_bf16_f32 v227, v150, v151
    v_exp_f32 v155, v155
    v_exp_f32 v156, v156
    v_exp_f32 v157, v157
    buffer_store_dwordx4 v[96:99], v2, s[52:55], s89 offen sc1
    v_cvt_pk_bf16_f32 v228, v152, v153
    v_mfma_f32_32x32x16_bf16 v[176:191], v[208:211], v[224:227], v[176:191]
    s_add_u32 s89, s89, 8192
    s_setprio 1
    v_exp_f32 v158, v158
    v_exp_f32 v159, v159
    v_cvt_pk_bf16_f32 v229, v154, v155
    v_cvt_pk_bf16_f32 v230, v156, v157
    v_xor_b32 v8, 16384, v8
    v_exp_f32 v128, v128
    v_exp_f32 v129, v129
    v_exp_f32 v130, v130
    buffer_store_dwordx4 v[96:99], v2, s[52:55], s89 offen sc1
    v_cvt_pk_bf16_f32 v231, v158, v159
    v_mfma_f32_32x32x16_bf16 v[144:159], v[124:127], v[116:119], v[192:207]
    s_add_u32 s89, s89, 8192
    v_exp_f32 v131, v131
    v_exp_f32 v132, v132
    v_exp_f32 v133, v133
    ds_read_b128 v[120:123], v8 offset:0
    v_cvt_pk_bf16_f32 v224, v128, v129
    s_add_u32 m0, s82, 0x0
    v_exp_f32 v134, v134
    v_exp_f32 v135, v135
    v_cvt_pk_bf16_f32 v225, v130, v131
    v_cvt_pk_bf16_f32 v226, v132, v133
    buffer_load_dwordx4 v2, s[8:11], s75 offen lds
    v_mfma_f32_32x32x16_bf16 v[176:191], v[212:215], v[228:231], v[176:191]
    s_add_u32 s75, s75, 32768
    s_setprio 0
    v_exp_f32 v136, v136
    v_exp_f32 v137, v137
    v_exp_f32 v138, v138
    v_cvt_pk_bf16_f32 v227, v134, v135
    v_exp_f32 v139, v139
    v_exp_f32 v140, v140
    v_exp_f32 v141, v141
    s_waitcnt lgkmcnt(2)
    v_cvt_pk_bf16_f32 v228, v136, v137
    v_mfma_f32_32x32x16_bf16 v[160:175], v[216:219], v[224:227], v[160:175]
    v_exp_f32 v142, v142
    v_exp_f32 v143, v143
    v_cvt_pk_bf16_f32 v229, v138, v139
    v_cvt_pk_bf16_f32 v230, v140, v141
    s_lshl_b32 s71, s69, 6
    s_lshl_b32 s72, s70, 3
    s_add_u32 s71, s71, s72
    s_add_u32 s71, s71, s64
    s_lshl_b32 s71, s71, 12
    v_bfe_u32 v7, v1, 2, 3
    v_lshrrev_b32 v26, 5, v1
    v_lshlrev_b32 v7, 7, v7
    v_lshl_add_u32 v7, v26, 11, v7
    buffer_load_dword v26, v7, s[60:63], s71 offen offset:1024
    v_xor_b32 v9, 16384, v9
    v_exp_f32 v144, v144
    v_exp_f32 v145, v145
    v_exp_f32 v146, v146
    buffer_store_dwordx4 v[96:99], v2, s[52:55], s89 offen sc1
    s_waitcnt lgkmcnt(0)
    v_cvt_pk_bf16_f32 v231, v142, v143
    v_mfma_f32_32x32x16_bf16 v[128:143], v[120:123], v[112:115], v[192:207]
    s_add_u32 s89, s89, 8192
    s_setprio 3
    v_exp_f32 v147, v147
    v_exp_f32 v148, v148
    v_exp_f32 v149, v149
    v_cvt_pk_bf16_f32 v224, v144, v145
    s_add_u32 m0, s82, 0x0
    v_exp_f32 v150, v150
    v_exp_f32 v151, v151
    v_cvt_pk_bf16_f32 v225, v146, v147
    v_cvt_pk_bf16_f32 v226, v148, v149
    buffer_load_dwordx4 v2, s[8:11], s75 offen lds
    v_mfma_f32_32x32x16_bf16 v[160:175], v[220:223], v[228:231], v[160:175]
    s_add_u32 s75, s75, 32768
    v_exp_f32 v152, v152
    v_exp_f32 v153, v153
    v_exp_f32 v154, v154
    s_mov_b64 exec, s[98:99]
    ds_read_b128 v[208:211], v9 offset:0
    ds_read_b128 v[212:215], v9 offset:512
    s_mov_b64 exec, -1
    v_cvt_pk_bf16_f32 v227, v150, v151
    v_exp_f32 v155, v155
    v_exp_f32 v156, v156
    v_exp_f32 v157, v157
    v_cvt_pk_bf16_f32 v228, v152, v153
    v_mfma_f32_32x32x16_bf16 v[176:191], v[216:219], v[224:227], v[176:191]
    s_setprio 2
    v_exp_f32 v158, v158
    v_exp_f32 v159, v159
    v_cvt_pk_bf16_f32 v229, v154, v155
    v_cvt_pk_bf16_f32 v230, v156, v157
    s_mov_b32 s97, 0
FK_LOOP_N1:
    v_exp_f32 v128, v128
    v_exp_f32 v129, v129
    v_exp_f32 v130, v130
    buffer_store_dwordx4 v[96:99], v2, s[52:55], s89 offen sc1
    v_cvt_pk_bf16_f32 v231, v158, v159
    v_mfma_f32_32x32x16_bf16 v[144:159], v[120:123], v[116:119], v[192:207]
    s_add_u32 s89, s89, 8192
    v_exp_f32 v131, v131
    v_exp_f32 v132, v132
    v_exp_f32 v133, v133
    ds_read_b128 v[124:127], v8 offset:1024
    v_cvt_pk_bf16_f32 v224, v128, v129
    s_add_u32 m0, s82, 0x0
    v_exp_f32 v134, v134
    v_exp_f32 v135, v135
    v_cvt_pk_bf16_f32 v225, v130, v131
    v_cvt_pk_bf16_f32 v226, v132, v133
    buffer_load_dwordx4 v2, s[4:7], s76 offen lds
    v_mfma_f32_32x32x16_bf16 v[176:191], v[220:223], v[228:231], v[176:191]
    s_add_u32 s76, s76, 32768
    s_setprio 1
    v_exp_f32 v136, v136
    v_exp_f32 v137, v137
    v_exp_f32 v138, v138
    v_cvt_pk_bf16_f32 v227, v134, v135
    v_exp_f32 v139, v139
    v_exp_f32 v140, v140
    v_exp_f32 v141, v141
    s_waitcnt lgkmcnt(2)
    v_cvt_pk_bf16_f32 v228, v136, v137
    v_mfma_f32_32x32x16_bf16 v[160:175], v[208:211], v[224:227], v[160:175]
    v_exp_f32 v142, v142
    v_exp_f32 v143, v143
    v_cvt_pk_bf16_f32 v229, v138, v139
    v_cvt_pk_bf16_f32 v230, v140, v141
    v_exp_f32 v144, v144
    v_exp_f32 v145, v145
    v_exp_f32 v146, v146
    buffer_store_dwordx4 v[96:99], v2, s[52:55], s89 offen sc1
    s_waitcnt lgkmcnt(0)
    v_cvt_pk_bf16_f32 v231, v142, v143
    v_mfma_f32_32x32x16_bf16 v[128:143], v[124:127], v[112:115], v[192:207]
    s_add_u32 s89, s89, 8192
    s_setprio 0
    v_exp_f32 v147, v147
    v_exp_f32 v148, v148
    v_exp_f32 v149, v149
    v_cvt_pk_bf16_f32 v224, v144, v145
    s_add_u32 m0, s82, 0x0
    v_exp_f32 v150, v150
    v_exp_f32 v151, v151
    v_cvt_pk_bf16_f32 v225, v146, v147
    v_cvt_pk_bf16_f32 v226, v148, v149
    buffer_load_dwordx4 v2, s[4:7], s76 offen lds
    v_mfma_f32_32x32x16_bf16 v[160:175], v[212:215], v[228:231], v[160:175]
    s_add_u32 s76, s76, 32768
    v_exp_f32 v152, v152
    v_exp_f32 v153, v153
    v_exp_f32 v154, v154
    s_mov_b64 exec, s[98:99]
    ds_read_b128 v[216:219], v9 offset:1024
    ds_read_b128 v[220:223], v9 offset:1536
    s_mov_b64 exec, -1
    v_cvt_pk_bf16_f32 v227, v150, v151
    v_exp_f32 v155, v155
    v_exp_f32 v156, v156
    v_exp_f32 v157, v157
    v_cvt_pk_bf16_f32 v228, v152, v153
    s_waitcnt vmcnt(16)
    s_barrier
    v_mfma_f32_32x32x16_bf16 v[176:191], v[208:211], v[224:227], v[176:191]
    s_setprio 3
    v_exp_f32 v158, v158
    v_exp_f32 v159, v159
    v_cvt_pk_bf16_f32 v229, v154, v155
    v_cvt_pk_bf16_f32 v230, v156, v157
    v_exp_f32 v128, v128
    v_exp_f32 v129, v129
    v_exp_f32 v130, v130
    buffer_store_dwordx4 v[96:99], v2, s[52:55], s89 offen sc1
    v_cvt_pk_bf16_f32 v231, v158, v159
    v_mfma_f32_32x32x16_bf16 v[144:159], v[124:127], v[116:119], v[192:207]
    s_add_u32 s89, s89, 8192
    v_exp_f32 v131, v131
    v_exp_f32 v132, v132
    v_exp_f32 v133, v133
    ds_read_b128 v[120:123], v8 offset:8192
    v_cvt_pk_bf16_f32 v224, v128, v129
    s_add_u32 m0, s91, 0x2000
    v_exp_f32 v134, v134
    v_exp_f32 v135, v135
    v_cvt_pk_bf16_f32 v225, v130, v131
    v_cvt_pk_bf16_f32 v226, v132, v133
    buffer_load_dwordx4 v29, s[52:55], s95 offen sc1 lds
    v_mfma_f32_32x32x16_bf16 v[176:191], v[212:215], v[228:231], v[176:191]
    s_add_u32 s95, s95, 2048
    s_xor_b32 s91, s91, 16384
    s_setprio 2
    v_exp_f32 v136, v136
    v_exp_f32 v137, v137
    v_exp_f32 v138, v138
    v_cvt_pk_bf16_f32 v227, v134, v135
    s_add_u32 m0, s82, 0x0
    v_exp_f32 v139, v139
    v_exp_f32 v140, v140
    v_exp_f32 v141, v141
    buffer_load_dwordx4 v2, s[4:7], s76 offen lds
    s_waitcnt lgkmcnt(2)
    v_cvt_pk_bf16_f32 v228, v136, v137
    v_mfma_f32_32x32x16_bf16 v[160:175], v[216:219], v[224:227], v[160:175]
    s_add_u32 s76, s76, 32768
    v_exp_f32 v142, v142
    v_exp_f32 v143, v143
    v_cvt_pk_bf16_f32 v229, v138, v139
    v_cvt_pk_bf16_f32 v230, v140, v141
    v_exp_f32 v144, v144
    v_exp_f32 v145, v145
    v_exp_f32 v146, v146
    buffer_store_dwordx4 v[96:99], v2, s[52:55], s89 offen sc1
    s_waitcnt lgkmcnt(0)
    v_cvt_pk_bf16_f32 v231, v142, v143
    v_mfma_f32_32x32x16_bf16 v[128:143], v[120:123], v[112:115], v[192:207]
    s_add_u32 s89, s89, 8192
    s_setprio 1
    v_exp_f32 v147, v147
    v_exp_f32 v148, v148
    v_exp_f32 v149, v149
    v_cvt_pk_bf16_f32 v224, v144, v145
    s_add_u32 m0, s82, 0x0
    v_exp_f32 v150, v150
    v_exp_f32 v151, v151
    v_cvt_pk_bf16_f32 v225, v146, v147
    v_cvt_pk_bf16_f32 v226, v148, v149
    buffer_load_dwordx4 v2, s[4:7], s76 offen lds
    v_mfma_f32_32x32x16_bf16 v[160:175], v[220:223], v[228:231], v[160:175]
    s_add_u32 s76, s76, 32768
    v_exp_f32 v152, v152
    v_exp_f32 v153, v153
    v_exp_f32 v154, v154
    s_mov_b64 exec, s[98:99]
    ds_read_b128 v[208:211], v9 offset:8192
    ds_read_b128 v[212:215], v9 offset:8704
    s_mov_b64 exec, -1
    v_cvt_pk_bf16_f32 v227, v150, v151
    v_exp_f32 v155, v155
    v_exp_f32 v156, v156
    v_exp_f32 v157, v157
    v_cvt_pk_bf16_f32 v228, v152, v153
    v_mfma_f32_32x32x16_bf16 v[176:191], v[216:219], v[224:227], v[176:191]
    s_setprio 0
    v_exp_f32 v158, v158
    v_exp_f32 v159, v159
    v_cvt_pk_bf16_f32 v229, v154, v155
    v_cvt_pk_bf16_f32 v230, v156, v157
    v_exp_f32 v128, v128
    v_exp_f32 v129, v129
    v_exp_f32 v130, v130
    buffer_store_dwordx4 v[96:99], v2, s[52:55], s89 offen sc1
    v_cvt_pk_bf16_f32 v231, v158, v159
    v_mfma_f32_32x32x16_bf16 v[144:159], v[120:123], v[116:119], v[192:207]
    s_add_u32 s89, s89, 8192
    v_exp_f32 v131, v131
    v_exp_f32 v132, v132
    v_exp_f32 v133, v133
    ds_read_b128 v[124:127], v8 offset:9216
    v_cvt_pk_bf16_f32 v224, v128, v129
    v_exp_f32 v134, v134
    v_exp_f32 v135, v135
    v_cvt_pk_bf16_f32 v225, v130, v131
    v_cvt_pk_bf16_f32 v226, v132, v133
    s_waitcnt vmcnt(17)
    s_barrier
    v_mfma_f32_32x32x16_bf16 v[176:191], v[220:223], v[228:231], v[176:191]
    s_setprio 3
    v_exp_f32 v136, v136
    v_exp_f32 v137, v137
    v_exp_f32 v138, v138
    v_cvt_pk_bf16_f32 v227, v134, v135
    s_add_u32 m0, s91, 0x0
    v_exp_f32 v139, v139
    v_exp_f32 v140, v140
    v_exp_f32 v141, v141
    buffer_load_dwordx4 v29, s[52:55], s95 offen sc1 lds
    s_waitcnt lgkmcnt(2)
    v_cvt_pk_bf16_f32 v228, v136, v137
    v_mfma_f32_32x32x16_bf16 v[160:175], v[208:211], v[224:227], v[160:175]
    s_add_u32 s95, s95, 2048
    v_exp_f32 v142, v142
    v_exp_f32 v143, v143
    v_cvt_pk_bf16_f32 v229, v138, v139
    v_cvt_pk_bf16_f32 v230, v140, v141
    s_add_u32 m0, s82, 0x0
    v_exp_f32 v144, v144
    v_exp_f32 v145, v145
    v_exp_f32 v146, v146
    buffer_load_dwordx4 v2, s[4:7], s76 offen lds
    s_waitcnt lgkmcnt(0)
    v_cvt_pk_bf16_f32 v231, v142, v143
    v_mfma_f32_32x32x16_bf16 v[128:143], v[124:127], v[112:115], v[192:207]
    s_add_u32 s76, s76, 32768
    s_setprio 2
    v_exp_f32 v147, v147
    v_exp_f32 v148, v148
    v_exp_f32 v149, v149
    v_cvt_pk_bf16_f32 v224, v144, v145
    s_add_u32 m0, s82, 0x0
    v_exp_f32 v150, v150
    v_exp_f32 v151, v151
    v_cvt_pk_bf16_f32 v225, v146, v147
    v_cvt_pk_bf16_f32 v226, v148, v149
    buffer_load_dwordx4 v2, s[4:7], s76 offen lds
    v_mfma_f32_32x32x16_bf16 v[160:175], v[212:215], v[228:231], v[160:175]
    s_add_u32 s76, s76, 32768
    v_exp_f32 v152, v152
    v_exp_f32 v153, v153
    v_exp_f32 v154, v154
    s_mov_b64 exec, s[98:99]
    ds_read_b128 v[216:219], v9 offset:9216
    ds_read_b128 v[220:223], v9 offset:9728
    s_mov_b64 exec, -1
    v_cvt_pk_bf16_f32 v227, v150, v151
    v_exp_f32 v155, v155
    v_exp_f32 v156, v156
    v_exp_f32 v157, v157
    buffer_store_dwordx4 v[96:99], v2, s[52:55], s89 offen sc1
    v_cvt_pk_bf16_f32 v228, v152, v153
    v_mfma_f32_32x32x16_bf16 v[176:191], v[208:211], v[224:227], v[176:191]
    s_add_u32 s89, s89, 8192
    s_setprio 1
    v_exp_f32 v158, v158
    v_exp_f32 v159, v159
    v_cvt_pk_bf16_f32 v229, v154, v155
    v_cvt_pk_bf16_f32 v230, v156, v157
    v_xor_b32 v8, 16384, v8
    v_exp_f32 v128, v128
    v_exp_f32 v129, v129
    v_exp_f32 v130, v130
    buffer_store_dwordx4 v[96:99], v2, s[52:55], s89 offen sc1
    v_cvt_pk_bf16_f32 v231, v158, v159
    v_mfma_f32_32x32x16_bf16 v[144:159], v[124:127], v[116:119], v[192:207]
    s_add_u32 s89, s89, 8192
    v_exp_f32 v131, v131
    v_exp_f32 v132, v132
    v_exp_f32 v133, v133
    ds_read_b128 v[120:123], v8 offset:0
    v_cvt_pk_bf16_f32 v224, v128, v129
    s_add_u32 m0, s82, 0x0
    v_exp_f32 v134, v134
    v_exp_f32 v135, v135
    v_cvt_pk_bf16_f32 v225, v130, v131
    v_cvt_pk_bf16_f32 v226, v132, v133
    buffer_load_dwordx4 v2, s[4:7], s76 offen lds
    v_mfma_f32_32x32x16_bf16 v[176:191], v[212:215], v[228:231], v[176:191]
    s_add_u32 s76, s76, 32768
    s_setprio 0
    v_exp_f32 v136, v136
    v_exp_f32 v137, v137
    v_exp_f32 v138, v138
    v_cvt_pk_bf16_f32 v227, v134, v135
    v_exp_f32 v139, v139
    v_exp_f32 v140, v140
    v_exp_f32 v141, v141
    s_waitcnt lgkmcnt(2)
    v_cvt_pk_bf16_f32 v228, v136, v137
    v_mfma_f32_32x32x16_bf16 v[160:175], v[216:219], v[224:227], v[160:175]
    v_exp_f32 v142, v142
    v_exp_f32 v143, v143
    v_cvt_pk_bf16_f32 v229, v138, v139
    v_cvt_pk_bf16_f32 v230, v140, v141
    v_xor_b32 v9, 16384, v9
    v_exp_f32 v144, v144
    v_exp_f32 v145, v145
    v_exp_f32 v146, v146
    buffer_store_dwordx4 v[96:99], v2, s[52:55], s89 offen sc1
    s_waitcnt lgkmcnt(0)
    v_cvt_pk_bf16_f32 v231, v142, v143
    v_mfma_f32_32x32x16_bf16 v[128:143], v[120:123], v[112:115], v[192:207]
    s_add_u32 s89, s89, 8192
    s_setprio 3
    v_exp_f32 v147, v147
    v_exp_f32 v148, v148
    v_exp_f32 v149, v149
    v_cvt_pk_bf16_f32 v224, v144, v145
    s_add_u32 m0, s82, 0x0
    v_exp_f32 v150, v150
    v_exp_f32 v151, v151
    v_cvt_pk_bf16_f32 v225, v146, v147
    v_cvt_pk_bf16_f32 v226, v148, v149
    buffer_load_dwordx4 v2, s[4:7], s76 offen lds
    v_mfma_f32_32x32x16_bf16 v[160:175], v[220:223], v[228:231], v[160:175]
    s_add_u32 s76, s76, 32768
    v_exp_f32 v152, v152
    v_exp_f32 v153, v153
    v_exp_f32 v154, v154
    s_mov_b64 exec, s[98:99]
    ds_read_b128 v[208:211], v9 offset:0
    ds_read_b128 v[212:215], v9 offset:512
    s_mov_b64 exec, -1
    v_cvt_pk_bf16_f32 v227, v150, v151
    v_exp_f32 v155, v155
    v_exp_f32 v156, v156
    v_exp_f32 v157, v157
    v_cvt_pk_bf16_f32 v228, v152, v153
    v_mfma_f32_32x32x16_bf16 v[176:191], v[216:219], v[224:227], v[176:191]
    s_setprio 2
    v_exp_f32 v158, v158
    v_exp_f32 v159, v159
    v_cvt_pk_bf16_f32 v229, v154, v155
    v_cvt_pk_bf16_f32 v230, v156, v157
    s_add_u32 s97, s97, 1
    s_cmp_lt_u32 s97, 2
    s_cbranch_scc1 FK_LOOP_N1
    v_exp_f32 v128, v128
    v_exp_f32 v129, v129
    v_exp_f32 v130, v130
    v_cvt_pk_bf16_f32 v231, v158, v159
    v_mfma_f32_32x32x16_bf16 v[144:159], v[120:123], v[116:119], v[192:207]
    v_exp_f32 v131, v131
    v_exp_f32 v132, v132
    v_exp_f32 v133, v133
    ds_read_b128 v[124:127], v8 offset:1024
    v_cvt_pk_bf16_f32 v224, v128, v129
    s_add_u32 m0, s82, 0x0
    v_exp_f32 v134, v134
    v_exp_f32 v135, v135
    v_cvt_pk_bf16_f32 v225, v130, v131
    v_cvt_pk_bf16_f32 v226, v132, v133
    buffer_load_dwordx4 v2, s[4:7], s76 offen lds
    v_mfma_f32_32x32x16_bf16 v[176:191], v[220:223], v[228:231], v[176:191]
    s_add_u32 s76, s76, 32768
    s_setprio 1
    v_exp_f32 v136, v136
    v_exp_f32 v137, v137
    v_exp_f32 v138, v138
    v_cvt_pk_bf16_f32 v227, v134, v135
    v_exp_f32 v139, v139
    v_exp_f32 v140, v140
    v_exp_f32 v141, v141
    s_waitcnt lgkmcnt(2)
    v_cvt_pk_bf16_f32 v228, v136, v137
    v_mfma_f32_32x32x16_bf16 v[160:175], v[208:211], v[224:227], v[160:175]
    v_exp_f32 v142, v142
    v_exp_f32 v143, v143
    v_cvt_pk_bf16_f32 v229, v138, v139
    v_cvt_pk_bf16_f32 v230, v140, v141
    v_exp_f32 v144, v144
    v_exp_f32 v145, v145
    v_exp_f32 v146, v146
    s_waitcnt lgkmcnt(0)
    v_cvt_pk_bf16_f32 v231, v142, v143
    v_mfma_f32_32x32x16_bf16 v[128:143], v[124:127], v[112:115], v[192:207]
    s_setprio 0
    v_exp_f32 v147, v147
    v_exp_f32 v148, v148
    v_exp_f32 v149, v149
    v_cvt_pk_bf16_f32 v224, v144, v145
    s_add_u32 m0, s82, 0x0
    v_exp_f32 v150, v150
    v_exp_f32 v151, v151
    v_cvt_pk_bf16_f32 v225, v146, v147
    v_cvt_pk_bf16_f32 v226, v148, v149
    buffer_load_dwordx4 v2, s[4:7], s76 offen lds
    v_mfma_f32_32x32x16_bf16 v[160:175], v[212:215], v[228:231], v[160:175]
    s_add_u32 s76, s76, 32768
    v_exp_f32 v152, v152
    v_exp_f32 v153, v153
    v_exp_f32 v154, v154
    s_mov_b64 exec, s[98:99]
    ds_read_b128 v[216:219], v9 offset:1024
    ds_read_b128 v[220:223], v9 offset:1536
    s_mov_b64 exec, -1
    v_cvt_pk_bf16_f32 v227, v150, v151
    v_exp_f32 v155, v155
    v_exp_f32 v156, v156
    v_exp_f32 v157, v157
    v_cvt_pk_bf16_f32 v228, v152, v153
    s_waitcnt vmcnt(14)
    s_barrier
    v_mfma_f32_32x32x16_bf16 v[176:191], v[208:211], v[224:227], v[176:191]
    s_setprio 3
    v_exp_f32 v158, v158
    v_exp_f32 v159, v159
    v_cvt_pk_bf16_f32 v229, v154, v155
    v_cvt_pk_bf16_f32 v230, v156, v157
    s_add_u32 m0, s91, 0x2000
    v_exp_f32 v128, v128
    v_exp_f32 v129, v129
    v_exp_f32 v130, v130
    buffer_load_dwordx4 v29, s[52:55], s95 offen sc1 lds
    v_cvt_pk_bf16_f32 v231, v158, v159
    v_mfma_f32_32x32x16_bf16 v[144:159], v[124:127], v[116:119], v[192:207]
    s_add_u32 s95, s95, 2048
    s_xor_b32 s91, s91, 16384
    v_exp_f32 v131, v131
    v_exp_f32 v132, v132
    v_exp_f32 v133, v133
    ds_read_b128 v[120:123], v8 offset:8192
    v_cvt_pk_bf16_f32 v224, v128, v129
    s_add_u32 m0, s82, 0x0
    v_exp_f32 v134, v134
    v_exp_f32 v135, v135
    v_cvt_pk_bf16_f32 v225, v130, v131
    v_cvt_pk_bf16_f32 v226, v132, v133
    buffer_load_dwordx4 v2, s[4:7], s76 offen lds
    v_mfma_f32_32x32x16_bf16 v[176:191], v[212:215], v[228:231], v[176:191]
    s_add_u32 s76, s76, 32768
    s_setprio 2
    v_exp_f32 v136, v136
    v_exp_f32 v137, v137
    v_exp_f32 v138, v138
    v_cvt_pk_bf16_f32 v227, v134, v135
    v_exp_f32 v139, v139
    v_exp_f32 v140, v140
    v_exp_f32 v141, v141
    s_waitcnt lgkmcnt(2)
    v_cvt_pk_bf16_f32 v228, v136, v137
    v_mfma_f32_32x32x16_bf16 v[160:175], v[216:219], v[224:227], v[160:175]
    v_exp_f32 v142, v142
    v_exp_f32 v143, v143
    v_cvt_pk_bf16_f32 v229, v138, v139
    v_cvt_pk_bf16_f32 v230, v140, v141
    v_exp_f32 v144, v144
    v_exp_f32 v145, v145
    v_exp_f32 v146, v146
    s_waitcnt lgkmcnt(0)
    v_cvt_pk_bf16_f32 v231, v142, v143
    v_mfma_f32_32x32x16_bf16 v[128:143], v[120:123], v[112:115], v[192:207]
    s_setprio 1
    v_exp_f32 v147, v147
    v_exp_f32 v148, v148
    v_exp_f32 v149, v149
    v_cvt_pk_bf16_f32 v224, v144, v145
    s_add_u32 m0, s82, 0x0
    v_exp_f32 v150, v150
    v_exp_f32 v151, v151
    v_cvt_pk_bf16_f32 v225, v146, v147
    v_cvt_pk_bf16_f32 v226, v148, v149
    buffer_load_dwordx4 v2, s[4:7], s76 offen lds
    v_mfma_f32_32x32x16_bf16 v[160:175], v[220:223], v[228:231], v[160:175]
    s_add_u32 s76, s76, 32768
    v_exp_f32 v152, v152
    v_exp_f32 v153, v153
    v_exp_f32 v154, v154
    s_mov_b64 exec, s[98:99]
    ds_read_b128 v[208:211], v9 offset:8192
    ds_read_b128 v[212:215], v9 offset:8704
    s_mov_b64 exec, -1
    v_cvt_pk_bf16_f32 v227, v150, v151
    v_exp_f32 v155, v155
    v_exp_f32 v156, v156
    v_exp_f32 v157, v157
    v_cvt_pk_bf16_f32 v228, v152, v153
    v_mfma_f32_32x32x16_bf16 v[176:191], v[216:219], v[224:227], v[176:191]
    s_setprio 0
    v_exp_f32 v158, v158
    v_exp_f32 v159, v159
    v_cvt_pk_bf16_f32 v229, v154, v155
    v_cvt_pk_bf16_f32 v230, v156, v157
    v_exp_f32 v128, v128
    v_exp_f32 v129, v129
    v_exp_f32 v130, v130
    v_cvt_pk_bf16_f32 v231, v158, v159
    v_mfma_f32_32x32x16_bf16 v[144:159], v[120:123], v[116:119], v[192:207]
    v_exp_f32 v131, v131
    v_exp_f32 v132, v132
    v_exp_f32 v133, v133
    ds_read_b128 v[124:127], v8 offset:9216
    v_cvt_pk_bf16_f32 v224, v128, v129
    v_exp_f32 v134, v134
    v_exp_f32 v135, v135
    v_cvt_pk_bf16_f32 v225, v130, v131
    v_cvt_pk_bf16_f32 v226, v132, v133
    s_waitcnt vmcnt(6)
    s_barrier
    v_mfma_f32_32x32x16_bf16 v[176:191], v[220:223], v[228:231], v[176:191]
    s_setprio 3
    v_exp_f32 v136, v136
    v_exp_f32 v137, v137
    v_exp_f32 v138, v138
    s_cmp_lg_u32 s64, 0
    s_cbranch_scc1 FL_133
    v_mov_b32 v5, s22
    s_mov_b64 exec, 0x40000
    buffer_store_dword v5, v3, s[52:55], 0 offen sc1
    s_mov_b64 exec, -1
FL_133:
    v_cvt_pk_bf16_f32 v227, v134, v135
    s_add_u32 m0, s91, 0x0
    v_exp_f32 v139, v139
    v_exp_f32 v140, v140
    v_exp_f32 v141, v141
    buffer_load_dwordx4 v29, s[52:55], s95 offen sc1 lds
    s_waitcnt lgkmcnt(2)
    v_cvt_pk_bf16_f32 v228, v136, v137
    v_mfma_f32_32x32x16_bf16 v[160:175], v[208:211], v[224:227], v[160:175]
    s_add_u32 s95, s95, 2048
    v_exp_f32 v142, v142
    v_exp_f32 v143, v143
    v_cvt_pk_bf16_f32 v229, v138, v139
    v_cvt_pk_bf16_f32 v230, v140, v141
    s_add_u32 m0, s82, 0x0
    v_exp_f32 v144, v144
    v_exp_f32 v145, v145
    v_exp_f32 v146, v146
    buffer_load_dwordx4 v2, s[4:7], s76 offen lds
    s_waitcnt lgkmcnt(0)
    v_cvt_pk_bf16_f32 v231, v142, v143
    v_mfma_f32_32x32x16_bf16 v[128:143], v[124:127], v[112:115], v[192:207]
    s_add_u32 s76, s76, 32768
    s_setprio 2
    v_exp_f32 v147, v147
    v_exp_f32 v148, v148
    v_exp_f32 v149, v149
    v_cvt_pk_bf16_f32 v224, v144, v145
    s_add_u32 m0, s82, 0x0
    v_exp_f32 v150, v150
    v_exp_f32 v151, v151
    v_cvt_pk_bf16_f32 v225, v146, v147
    v_cvt_pk_bf16_f32 v226, v148, v149
    buffer_load_dwordx4 v2, s[4:7], s76 offen lds
    v_mfma_f32_32x32x16_bf16 v[160:175], v[212:215], v[228:231], v[160:175]
    s_add_u32 s76, s76, 32768
    v_exp_f32 v152, v152
    v_exp_f32 v153, v153
    v_exp_f32 v154, v154
    s_mov_b64 exec, s[98:99]
    ds_read_b128 v[216:219], v9 offset:9216
    ds_read_b128 v[220:223], v9 offset:9728
    s_mov_b64 exec, -1
    v_cvt_pk_bf16_f32 v227, v150, v151
    v_exp_f32 v155, v155
    v_exp_f32 v156, v156
    v_exp_f32 v157, v157
    v_cvt_pk_bf16_f32 v228, v152, v153
    v_mfma_f32_32x32x16_bf16 v[176:191], v[208:211], v[224:227], v[176:191]
    s_setprio 1
    v_exp_f32 v158, v158
    v_exp_f32 v159, v159
    v_cvt_pk_bf16_f32 v229, v154, v155
    v_cvt_pk_bf16_f32 v230, v156, v157
    v_xor_b32 v8, 16384, v8
    v_exp_f32 v128, v128
    v_exp_f32 v129, v129
    v_exp_f32 v130, v130
    v_cvt_pk_bf16_f32 v231, v158, v159
    v_mfma_f32_32x32x16_bf16 v[144:159], v[124:127], v[116:119], v[192:207]
    v_exp_f32 v131, v131
    v_exp_f32 v132, v132
    v_exp_f32 v133, v133
    ds_read_b128 v[120:123], v8 offset:0
    v_cvt_pk_bf16_f32 v224, v128, v129
    s_add_u32 m0, s82, 0x0
    v_exp_f32 v134, v134
    v_exp_f32 v135, v135
    v_cvt_pk_bf16_f32 v225, v130, v131
    v_cvt_pk_bf16_f32 v226, v132, v133
    buffer_load_dwordx4 v2, s[4:7], s76 offen lds
    v_mfma_f32_32x32x16_bf16 v[176:191], v[212:215], v[228:231], v[176:191]
    s_add_u32 s76, s76, 32768
    s_setprio 0
    v_exp_f32 v136, v136
    v_exp_f32 v137, v137
    v_exp_f32 v138, v138
    v_cvt_pk_bf16_f32 v227, v134, v135
    v_exp_f32 v139, v139
    v_exp_f32 v140, v140
    v_exp_f32 v141, v141
    s_waitcnt lgkmcnt(2)
    v_cvt_pk_bf16_f32 v228, v136, v137
    v_mfma_f32_32x32x16_bf16 v[160:175], v[216:219], v[224:227], v[160:175]
    v_exp_f32 v142, v142
    v_exp_f32 v143, v143
    v_cvt_pk_bf16_f32 v229, v138, v139
    v_cvt_pk_bf16_f32 v230, v140, v141
    v_xor_b32 v9, 16384, v9
    v_exp_f32 v144, v144
    v_exp_f32 v145, v145
    v_exp_f32 v146, v146
    s_waitcnt lgkmcnt(0)
    v_cvt_pk_bf16_f32 v231, v142, v143
    v_mfma_f32_32x32x16_bf16 v[128:143], v[120:123], v[112:115], v[192:207]
    s_setprio 3
    v_exp_f32 v147, v147
    v_exp_f32 v148, v148
    v_exp_f32 v149, v149
    v_cvt_pk_bf16_f32 v224, v144, v145
    s_add_u32 m0, s82, 0x0
    v_exp_f32 v150, v150
    v_exp_f32 v151, v151
    v_cvt_pk_bf16_f32 v225, v146, v147
    v_cvt_pk_bf16_f32 v226, v148, v149
    buffer_load_dwordx4 v2, s[4:7], s76 offen lds
    v_mfma_f32_32x32x16_bf16 v[160:175], v[220:223], v[228:231], v[160:175]
    s_add_u32 s76, s76, 32768
    v_exp_f32 v152, v152
    v_exp_f32 v153, v153
    v_exp_f32 v154, v154
    s_mov_b64 exec, s[98:99]
    ds_read_b128 v[208:211], v9 offset:0
    ds_read_b128 v[212:215], v9 offset:512
    s_mov_b64 exec, -1
    v_cvt_pk_bf16_f32 v227, v150, v151
    v_exp_f32 v155, v155
    v_exp_f32 v156, v156
    v_exp_f32 v157, v157
    v_cvt_pk_bf16_f32 v228, v152, v153
    v_mfma_f32_32x32x16_bf16 v[176:191], v[216:219], v[224:227], v[176:191]
    s_setprio 2
    v_exp_f32 v158, v158
    v_exp_f32 v159, v159
    v_cvt_pk_bf16_f32 v229, v154, v155
    v_cvt_pk_bf16_f32 v230, v156, v157
    v_exp_f32 v128, v128
    v_exp_f32 v129, v129
    v_exp_f32 v130, v130
    v_cvt_pk_bf16_f32 v231, v158, v159
    v_mfma_f32_32x32x16_bf16 v[144:159], v[120:123], v[116:119], v[192:207]
    v_exp_f32 v131, v131
    v_exp_f32 v132, v132
    v_exp_f32 v133, v133
    ds_read_b128 v[124:127], v8 offset:1024
    v_cvt_pk_bf16_f32 v224, v128, v129
    s_add_u32 m0, s82, 0x0
    v_exp_f32 v134, v134
    v_exp_f32 v135, v135
    v_cvt_pk_bf16_f32 v225, v130, v131
    v_cvt_pk_bf16_f32 v226, v132, v133
    buffer_load_dwordx4 v2, s[4:7], s76 offen lds
    v_mfma_f32_32x32x16_bf16 v[176:191], v[220:223], v[228:231], v[176:191]
    s_add_u32 s76, s76, 32768
    s_setprio 1
    v_exp_f32 v136, v136
    v_exp_f32 v137, v137
    v_exp_f32 v138, v138
    v_cvt_pk_bf16_f32 v227, v134, v135
    v_exp_f32 v139, v139
    v_exp_f32 v140, v140
    v_exp_f32 v141, v141
    s_waitcnt lgkmcnt(2)
    v_cvt_pk_bf16_f32 v228, v136, v137
    v_mfma_f32_32x32x16_bf16 v[160:175], v[208:211], v[224:227], v[160:175]
    v_exp_f32 v142, v142
    v_exp_f32 v143, v143
    v_cvt_pk_bf16_f32 v229, v138, v139
    v_cvt_pk_bf16_f32 v230, v140, v141
    v_exp_f32 v144, v144
    v_exp_f32 v145, v145
    v_exp_f32 v146, v146
    s_waitcnt lgkmcnt(0)
    v_cvt_pk_bf16_f32 v231, v142, v143
    v_mfma_f32_32x32x16_bf16 v[128:143], v[124:127], v[112:115], v[192:207]
    s_setprio 0
    v_exp_f32 v147, v147
    v_exp_f32 v148, v148
    v_exp_f32 v149, v149
    v_cvt_pk_bf16_f32 v224, v144, v145
    s_add_u32 m0, s82, 0x0
    v_exp_f32 v150, v150
    v_exp_f32 v151, v151
    v_cvt_pk_bf16_f32 v225, v146, v147
    v_cvt_pk_bf16_f32 v226, v148, v149
    buffer_load_dwordx4 v2, s[4:7], s76 offen lds
    v_mfma_f32_32x32x16_bf16 v[160:175], v[212:215], v[228:231], v[160:175]
    s_add_u32 s76, s76, 32768
    v_exp_f32 v152, v152
    v_exp_f32 v153, v153
    v_exp_f32 v154, v154
    s_mov_b64 exec, s[98:99]
    ds_read_b128 v[216:219], v9 offset:1024
    ds_read_b128 v[220:223], v9 offset:1536
    s_mov_b64 exec, -1
    v_cvt_pk_bf16_f32 v227, v150, v151
    v_exp_f32 v155, v155
    v_exp_f32 v156, v156
    v_exp_f32 v157, v157
    v_cvt_pk_bf16_f32 v228, v152, v153
    s_waitcnt vmcnt(9)
    s_barrier
    v_mfma_f32_32x32x16_bf16 v[176:191], v[208:211], v[224:227], v[176:191]
    s_setprio 3
    v_exp_f32 v158, v158
    v_exp_f32 v159, v159
    v_cvt_pk_bf16_f32 v229, v154, v155
    v_cvt_pk_bf16_f32 v230, v156, v157
    s_add_u32 m0, s91, 0x2000
    v_exp_f32 v128, v128
    v_exp_f32 v129, v129
    v_exp_f32 v130, v130
    buffer_load_dwordx4 v29, s[52:55], s95 offen sc1 lds
    v_cvt_pk_bf16_f32 v231, v158, v159
    v_mfma_f32_32x32x16_bf16 v[144:159], v[124:127], v[116:119], v[192:207]
    s_add_u32 s95, s95, 2048
    s_xor_b32 s91, s91, 16384
    v_exp_f32 v131, v131
    v_exp_f32 v132, v132
    v_exp_f32 v133, v133
    ds_read_b128 v[120:123], v8 offset:8192
    v_cvt_pk_bf16_f32 v224, v128, v129
    s_add_u32 m0, s82, 0x0
    v_exp_f32 v134, v134
    v_exp_f32 v135, v135
    v_cvt_pk_bf16_f32 v225, v130, v131
    v_cvt_pk_bf16_f32 v226, v132, v133
    buffer_load_dwordx4 v2, s[4:7], s76 offen lds
    v_mfma_f32_32x32x16_bf16 v[176:191], v[212:215], v[228:231], v[176:191]
    s_add_u32 s76, s76, 32768
    s_setprio 2
    v_exp_f32 v136, v136
    v_exp_f32 v137, v137
    v_exp_f32 v138, v138
    v_cvt_pk_bf16_f32 v227, v134, v135
    v_exp_f32 v139, v139
    v_exp_f32 v140, v140
    v_exp_f32 v141, v141
    s_waitcnt lgkmcnt(2)
    v_cvt_pk_bf16_f32 v228, v136, v137
    v_mfma_f32_32x32x16_bf16 v[160:175], v[216:219], v[224:227], v[160:175]
    v_exp_f32 v142, v142
    v_exp_f32 v143, v143
    v_cvt_pk_bf16_f32 v229, v138, v139
    v_cvt_pk_bf16_f32 v230, v140, v141
    v_exp_f32 v144, v144
    v_exp_f32 v145, v145
    v_exp_f32 v146, v146
    s_waitcnt lgkmcnt(0)
    v_cvt_pk_bf16_f32 v231, v142, v143
    v_mfma_f32_32x32x16_bf16 v[128:143], v[120:123], v[112:115], v[192:207]
    s_setprio 1
    v_exp_f32 v147, v147
    v_exp_f32 v148, v148
    v_exp_f32 v149, v149
    v_cvt_pk_bf16_f32 v224, v144, v145
    s_add_u32 m0, s82, 0x0
    v_exp_f32 v150, v150
    v_exp_f32 v151, v151
    v_cvt_pk_bf16_f32 v225, v146, v147
    v_cvt_pk_bf16_f32 v226, v148, v149
    buffer_load_dwordx4 v2, s[4:7], s76 offen lds
    v_mfma_f32_32x32x16_bf16 v[160:175], v[220:223], v[228:231], v[160:175]
    s_add_u32 s76, s76, 32768
    v_exp_f32 v152, v152
    v_exp_f32 v153, v153
    v_exp_f32 v154, v154
    s_mov_b64 exec, s[98:99]
    ds_read_b128 v[208:211], v9 offset:8192
    ds_read_b128 v[212:215], v9 offset:8704
    s_mov_b64 exec, -1
    v_cvt_pk_bf16_f32 v227, v150, v151
    v_exp_f32 v155, v155
    v_exp_f32 v156, v156
    v_exp_f32 v157, v157
    v_cvt_pk_bf16_f32 v228, v152, v153
    v_mfma_f32_32x32x16_bf16 v[176:191], v[216:219], v[224:227], v[176:191]
    s_setprio 0
    v_exp_f32 v158, v158
    v_exp_f32 v159, v159
    v_cvt_pk_bf16_f32 v229, v154, v155
    v_cvt_pk_bf16_f32 v230, v156, v157
    v_exp_f32 v128, v128
    v_exp_f32 v129, v129
    v_exp_f32 v130, v130
    v_cvt_pk_bf16_f32 v231, v158, v159
    v_mfma_f32_32x32x16_bf16 v[144:159], v[120:123], v[116:119], v[192:207]
    v_exp_f32 v131, v131
    v_exp_f32 v132, v132
    v_exp_f32 v133, v133
    ds_read_b128 v[124:127], v8 offset:9216
    v_cvt_pk_bf16_f32 v224, v128, v129
    v_exp_f32 v134, v134
    v_exp_f32 v135, v135
    v_cvt_pk_bf16_f32 v225, v130, v131
    v_cvt_pk_bf16_f32 v226, v132, v133
    s_waitcnt vmcnt(9)
    s_barrier
    v_mfma_f32_32x32x16_bf16 v[176:191], v[220:223], v[228:231], v[176:191]
    s_setprio 3
    v_exp_f32 v136, v136
    v_exp_f32 v137, v137
    v_exp_f32 v138, v138
    v_cvt_pk_bf16_f32 v227, v134, v135
    s_add_u32 m0, s91, 0x0
    v_exp_f32 v139, v139
    v_exp_f32 v140, v140
    v_exp_f32 v141, v141
    buffer_load_dwordx4 v29, s[52:55], s95 offen sc1 lds
    s_waitcnt lgkmcnt(2)
    v_cvt_pk_bf16_f32 v228, v136, v137
    v_mfma_f32_32x32x16_bf16 v[160:175], v[208:211], v[224:227], v[160:175]
    s_add_u32 s95, s95, 2048
    v_exp_f32 v142, v142
    v_exp_f32 v143, v143
    v_cvt_pk_bf16_f32 v229, v138, v139
    v_cvt_pk_bf16_f32 v230, v140, v141
    v_exp_f32 v144, v144
    v_exp_f32 v145, v145
    v_exp_f32 v146, v146
    s_waitcnt lgkmcnt(0)
    v_cvt_pk_bf16_f32 v231, v142, v143
    v_mfma_f32_32x32x16_bf16 v[128:143], v[124:127], v[112:115], v[192:207]
    s_setprio 2
    v_exp_f32 v147, v147
    v_exp_f32 v148, v148
    v_exp_f32 v149, v149
    v_cvt_pk_bf16_f32 v224, v144, v145
    v_exp_f32 v150, v150
    v_exp_f32 v151, v151
    v_cvt_pk_bf16_f32 v225, v146, v147
    v_cvt_pk_bf16_f32 v226, v148, v149
    v_mfma_f32_32x32x16_bf16 v[160:175], v[212:215], v[228:231], v[160:175]
    v_exp_f32 v152, v152
    v_exp_f32 v153, v153
    v_exp_f32 v154, v154
    s_mov_b64 exec, s[98:99]
    ds_read_b128 v[216:219], v9 offset:9216
    ds_read_b128 v[220:223], v9 offset:9728
    s_mov_b64 exec, -1
    v_cvt_pk_bf16_f32 v227, v150, v151
    v_exp_f32 v155, v155
    v_exp_f32 v156, v156
    v_exp_f32 v157, v157
    v_cvt_pk_bf16_f32 v228, v152, v153
    v_mfma_f32_32x32x16_bf16 v[176:191], v[208:211], v[224:227], v[176:191]
    s_setprio 1
    v_exp_f32 v158, v158
    v_exp_f32 v159, v159
    v_cvt_pk_bf16_f32 v229, v154, v155
    v_cvt_pk_bf16_f32 v230, v156, v157
    v_xor_b32 v8, 16384, v8
    v_exp_f32 v128, v128
    v_exp_f32 v129, v129
    v_exp_f32 v130, v130
    v_cvt_pk_bf16_f32 v231, v158, v159
    v_mfma_f32_32x32x16_bf16 v[144:159], v[124:127], v[116:119], v[192:207]
    v_exp_f32 v131, v131
    v_exp_f32 v132, v132
    v_exp_f32 v133, v133
    ds_read_b128 v[120:123], v8 offset:0
    v_cvt_pk_bf16_f32 v224, v128, v129
    v_exp_f32 v134, v134
    v_exp_f32 v135, v135
    v_cvt_pk_bf16_f32 v225, v130, v131
    v_cvt_pk_bf16_f32 v226, v132, v133
    v_mfma_f32_32x32x16_bf16 v[176:191], v[212:215], v[228:231], v[176:191]
    s_setprio 0
    v_exp_f32 v136, v136
    v_exp_f32 v137, v137
    v_exp_f32 v138, v138
    v_cvt_pk_bf16_f32 v227, v134, v135
    v_exp_f32 v139, v139
    v_exp_f32 v140, v140
    v_exp_f32 v141, v141
    s_waitcnt lgkmcnt(2)
    v_cvt_pk_bf16_f32 v228, v136, v137
    v_mfma_f32_32x32x16_bf16 v[160:175], v[216:219], v[224:227], v[160:175]
    v_exp_f32 v142, v142
    v_exp_f32 v143, v143
    v_cvt_pk_bf16_f32 v229, v138, v139
    v_cvt_pk_bf16_f32 v230, v140, v141
    v_xor_b32 v9, 16384, v9
    v_exp_f32 v144, v144
    v_exp_f32 v145, v145
    v_exp_f32 v146, v146
    s_waitcnt lgkmcnt(0)
    v_cvt_pk_bf16_f32 v231, v142, v143
    v_mfma_f32_32x32x16_bf16 v[128:143], v[120:123], v[112:115], v[192:207]
    s_setprio 3
    v_exp_f32 v147, v147
    v_exp_f32 v148, v148
    v_exp_f32 v149, v149
    v_cvt_pk_bf16_f32 v224, v144, v145
    v_exp_f32 v150, v150
    v_exp_f32 v151, v151
    v_cvt_pk_bf16_f32 v225, v146, v147
    v_cvt_pk_bf16_f32 v226, v148, v149
    v_mfma_f32_32x32x16_bf16 v[160:175], v[220:223], v[228:231], v[160:175]
    v_exp_f32 v152, v152
    v_exp_f32 v153, v153
    v_exp_f32 v154, v154
    s_mov_b64 exec, s[98:99]
    ds_read_b128 v[208:211], v9 offset:0
    ds_read_b128 v[212:215], v9 offset:512
    s_mov_b64 exec, -1
    v_cvt_pk_bf16_f32 v227, v150, v151
    v_exp_f32 v155, v155
    v_exp_f32 v156, v156
    v_exp_f32 v157, v157
    v_cvt_pk_bf16_f32 v228, v152, v153
    v_mfma_f32_32x32x16_bf16 v[176:191], v[216:219], v[224:227], v[176:191]
    s_setprio 2
    v_exp_f32 v158, v158
    v_exp_f32 v159, v159
    v_cvt_pk_bf16_f32 v229, v154, v155
    v_cvt_pk_bf16_f32 v230, v156, v157
    v_exp_f32 v128, v128
    v_exp_f32 v129, v129
    v_exp_f32 v130, v130
    v_cvt_pk_bf16_f32 v231, v158, v159
    v_mfma_f32_32x32x16_bf16 v[144:159], v[120:123], v[116:119], v[192:207]
    v_exp_f32 v131, v131
    v_exp_f32 v132, v132
    v_exp_f32 v133, v133
    ds_read_b128 v[124:127], v8 offset:1024
    v_cvt_pk_bf16_f32 v224, v128, v129
    s_add_u32 m0, s82, 0x0
    v_exp_f32 v134, v134
    v_exp_f32 v135, v135
    v_cvt_pk_bf16_f32 v225, v130, v131
    v_cvt_pk_bf16_f32 v226, v132, v133
    buffer_load_dwordx4 v2, s[8:11], s75 offen lds
    v_mfma_f32_32x32x16_bf16 v[176:191], v[220:223], v[228:231], v[176:191]
    s_add_u32 s75, s75, 32768
    s_setprio 1
    v_exp_f32 v136, v136
    v_exp_f32 v137, v137
    v_exp_f32 v138, v138
    v_cvt_pk_bf16_f32 v227, v134, v135
    v_exp_f32 v139, v139
    v_exp_f32 v140, v140
    v_exp_f32 v141, v141
    s_waitcnt lgkmcnt(2)
    v_cvt_pk_bf16_f32 v228, v136, v137
    v_mfma_f32_32x32x16_bf16 v[160:175], v[208:211], v[224:227], v[160:175]
    v_exp_f32 v142, v142
    v_exp_f32 v143, v143
    v_cvt_pk_bf16_f32 v229, v138, v139
    v_cvt_pk_bf16_f32 v230, v140, v141
    v_exp_f32 v144, v144
    v_exp_f32 v145, v145
    v_exp_f32 v146, v146
    s_waitcnt lgkmcnt(0)
    v_cvt_pk_bf16_f32 v231, v142, v143
    v_mfma_f32_32x32x16_bf16 v[128:143], v[124:127], v[112:115], v[192:207]
    s_setprio 0
    v_exp_f32 v147, v147
    v_exp_f32 v148, v148
    v_exp_f32 v149, v149
    v_cvt_pk_bf16_f32 v224, v144, v145
    s_add_u32 m0, s82, 0x0
    v_exp_f32 v150, v150
    v_exp_f32 v151, v151
    v_cvt_pk_bf16_f32 v225, v146, v147
    v_cvt_pk_bf16_f32 v226, v148, v149
    buffer_load_dwordx4 v2, s[8:11], s75 offen lds
    v_mfma_f32_32x32x16_bf16 v[160:175], v[212:215], v[228:231], v[160:175]
    s_add_u32 s75, s75, 32768
    v_exp_f32 v152, v152
    v_exp_f32 v153, v153
    v_exp_f32 v154, v154
    s_mov_b64 exec, s[98:99]
    ds_read_b128 v[216:219], v9 offset:1024
    ds_read_b128 v[220:223], v9 offset:1536
    s_mov_b64 exec, -1
    v_cvt_pk_bf16_f32 v227, v150, v151
    v_exp_f32 v155, v155
    v_exp_f32 v156, v156
    v_exp_f32 v157, v157
    v_cvt_pk_bf16_f32 v228, v152, v153
    s_waitcnt vmcnt(5)
    s_barrier
    v_mfma_f32_32x32x16_bf16 v[176:191], v[208:211], v[224:227], v[176:191]
    s_setprio 3
    v_exp_f32 v158, v158
    v_exp_f32 v159, v159
    v_cvt_pk_bf16_f32 v229, v154, v155
    v_cvt_pk_bf16_f32 v230, v156, v157
    s_add_u32 m0, s91, 0x2000
    v_exp_f32 v128, v128
    v_exp_f32 v129, v129
    v_exp_f32 v130, v130
    buffer_load_dwordx4 v29, s[52:55], s95 offen sc1 lds
    v_cvt_pk_bf16_f32 v231, v158, v159
    v_mfma_f32_32x32x16_bf16 v[144:159], v[124:127], v[116:119], v[192:207]
    s_add_u32 s95, s95, 2048
    s_xor_b32 s91, s91, 16384
    v_exp_f32 v131, v131
    v_exp_f32 v132, v132
    v_exp_f32 v133, v133
    ds_read_b128 v[120:123], v8 offset:8192
    v_cvt_pk_bf16_f32 v224, v128, v129
    s_add_u32 m0, s82, 0x0
    v_exp_f32 v134, v134
    v_exp_f32 v135, v135
    v_cvt_pk_bf16_f32 v225, v130, v131
    v_cvt_pk_bf16_f32 v226, v132, v133
    buffer_load_dwordx4 v2, s[8:11], s75 offen lds
    v_mfma_f32_32x32x16_bf16 v[176:191], v[212:215], v[228:231], v[176:191]
    s_add_u32 s75, s75, 32768
    s_setprio 2
    v_exp_f32 v136, v136
    v_exp_f32 v137, v137
    v_exp_f32 v138, v138
    v_cvt_pk_bf16_f32 v227, v134, v135
    v_exp_f32 v139, v139
    v_exp_f32 v140, v140
    v_exp_f32 v141, v141
    s_waitcnt lgkmcnt(2)
    v_cvt_pk_bf16_f32 v228, v136, v137
    v_mfma_f32_32x32x16_bf16 v[160:175], v[216:219], v[224:227], v[160:175]
    v_exp_f32 v142, v142
    v_exp_f32 v143, v143
    v_cvt_pk_bf16_f32 v229, v138, v139
    v_cvt_pk_bf16_f32 v230, v140, v141
    s_cmp_lg_u32 s64, 0
    s_cbranch_scc1 MPI_152
    v_lshlrev_b32 v31, 2, v1
    s_lshr_b32 s71, s69, 1
    s_lshl_b32 s71, s71, 7
    s_add_u32 s71, s71, 0x1502000
    s_mov_b32 exec_hi, 0
    v_and_b32 v31, 63, v31
    v_add_u32 v31, s71, v31
    s_not_b64 exec, exec
    v_add_u32 v31, 0x1503f80, v31
    s_mov_b64 exec, -1
    buffer_load_dword v30, v31, s[52:55], 0 offen sc1
MPI_152:
    s_mov_b32 s80, 0x60000
    s_add_u32 m0, s82, 0x24000
    v_exp_f32 v144, v144
    v_exp_f32 v145, v145
    v_exp_f32 v146, v146
    buffer_load_dwordx4 v20, s[4:7], s80 offen lds
    s_waitcnt lgkmcnt(0)
    v_cvt_pk_bf16_f32 v231, v142, v143
    v_mfma_f32_32x32x16_bf16 v[128:143], v[120:123], v[112:115], v[192:207]
    s_setprio 1
    v_exp_f32 v147, v147
    v_exp_f32 v148, v148
    v_exp_f32 v149, v149
    v_cvt_pk_bf16_f32 v224, v144, v145
    s_add_u32 m0, s82, 0x0
    v_exp_f32 v150, v150
    v_exp_f32 v151, v151
    v_cvt_pk_bf16_f32 v225, v146, v147
    v_cvt_pk_bf16_f32 v226, v148, v149
    buffer_load_dwordx4 v2, s[8:11], s75 offen lds
    v_mfma_f32_32x32x16_bf16 v[160:175], v[220:223], v[228:231], v[160:175]
    s_add_u32 s75, s75, 32768
    v_exp_f32 v152, v152
    v_exp_f32 v153, v153
    v_exp_f32 v154, v154
    s_mov_b64 exec, s[98:99]
    ds_read_b128 v[208:211], v9 offset:8192
    ds_read_b128 v[212:215], v9 offset:8704
    s_mov_b64 exec, -1
    v_cvt_pk_bf16_f32 v227, v150, v151
    s_mov_b32 s80, 0x70000
    s_add_u32 m0, s82, 0x26000
    v_exp_f32 v155, v155
    v_exp_f32 v156, v156
    v_exp_f32 v157, v157
    buffer_load_dwordx4 v20, s[8:11], s80 offen lds
    v_cvt_pk_bf16_f32 v228, v152, v153
    v_mfma_f32_32x32x16_bf16 v[176:191], v[216:219], v[224:227], v[176:191]
    s_setprio 0
    v_exp_f32 v158, v158
    v_exp_f32 v159, v159
    v_cvt_pk_bf16_f32 v229, v154, v155
    v_cvt_pk_bf16_f32 v230, v156, v157
    v_exp_f32 v128, v128
    v_exp_f32 v129, v129
    v_exp_f32 v130, v130
    v_cvt_pk_bf16_f32 v231, v158, v159
    v_mfma_f32_32x32x16_bf16 v[144:159], v[120:123], v[116:119], v[192:207]
    v_exp_f32 v131, v131
    v_exp_f32 v132, v132
    v_exp_f32 v133, v133
    ds_read_b128 v[124:127], v8 offset:9216
    v_cvt_pk_bf16_f32 v224, v128, v129
    v_exp_f32 v134, v134
    v_exp_f32 v135, v135
    v_cvt_pk_bf16_f32 v225, v130, v131
    v_cvt_pk_bf16_f32 v226, v132, v133
    s_waitcnt vmcnt(7)
    s_cmp_lg_u32 s64, 0
    s_cbranch_scc1 MPP_151
    s_mov_b32 s88, 0
    s_waitcnt vmcnt(3)
    s_branch PC_149
PL_148:
    buffer_load_dword v30, v31, s[52:55], 0 offen sc1
    s_waitcnt vmcnt(0)
PC_149:
    v_cmp_ne_u32 vcc, s22, v30
    s_nop 0
    s_cmp_eq_u64 vcc, 0
    s_cbranch_scc1 PD_150
    s_sleep 1
    s_add_u32 s88, s88, 1
    s_cmp_lt_u32 s88, 40000
    s_cbranch_scc1 PL_148
PD_150:
MPP_151:
    s_barrier
    v_mfma_f32_32x32x16_bf16 v[176:191], v[220:223], v[228:231], v[176:191]
    s_setprio 3
    v_exp_f32 v136, v136
    v_exp_f32 v137, v137
    v_exp_f32 v138, v138
    v_cvt_pk_bf16_f32 v227, v134, v135
    s_mov_b32 s80, 0x20000
    s_add_u32 m0, s82, 0x1c000
    v_exp_f32 v139, v139
    v_exp_f32 v140, v140
    v_exp_f32 v141, v141
    buffer_load_dwordx4 v20, s[4:7], s80 offen lds
    s_waitcnt lgkmcnt(2)
    v_cvt_pk_bf16_f32 v228, v136, v137
    v_mfma_f32_32x32x16_bf16 v[160:175], v[208:211], v[224:227], v[160:175]
    v_exp_f32 v142, v142
    v_exp_f32 v143, v143
    v_cvt_pk_bf16_f32 v229, v138, v139
    v_cvt_pk_bf16_f32 v230, v140, v141
    s_add_u32 m0, s91, 0x0
    v_exp_f32 v144, v144
    v_exp_f32 v145, v145
    v_exp_f32 v146, v146
    buffer_load_dwordx4 v29, s[52:55], s95 offen sc1 lds
    s_waitcnt lgkmcnt(0)
    v_cvt_pk_bf16_f32 v231, v142, v143
    v_mfma_f32_32x32x16_bf16 v[128:143], v[124:127], v[112:115], v[192:207]
    s_add_u32 s95, s95, 2048
    s_setprio 2
    v_exp_f32 v147, v147
    v_exp_f32 v148, v148
    v_exp_f32 v149, v149
    v_cvt_pk_bf16_f32 v224, v144, v145
    s_mov_b32 s80, 0x30000
    s_add_u32 m0, s82, 0x1e000
    v_exp_f32 v150, v150
    v_exp_f32 v151, v151
    v_cvt_pk_bf16_f32 v225, v146, v147
    v_cvt_pk_bf16_f32 v226, v148, v149
    buffer_load_dwordx4 v20, s[4:7], s80 offen lds
    v_mfma_f32_32x32x16_bf16 v[160:175], v[212:215], v[228:231], v[160:175]
    v_exp_f32 v152, v152
    v_exp_f32 v153, v153
    v_exp_f32 v154, v154
    s_mov_b64 exec, s[98:99]
    ds_read_b128 v[216:219], v9 offset:9216
    ds_read_b128 v[220:223], v9 offset:9728
    s_mov_b64 exec, -1
    v_cvt_pk_bf16_f32 v227, v150, v151
    s_add_u32 m0, s82, 0x0
    v_exp_f32 v155, v155
    v_exp_f32 v156, v156
    v_exp_f32 v157, v157
    buffer_load_dwordx4 v2, s[8:11], s75 offen lds
    v_cvt_pk_bf16_f32 v228, v152, v153
    v_mfma_f32_32x32x16_bf16 v[176:191], v[208:211], v[224:227], v[176:191]
    s_add_u32 s75, s75, 32768
    s_setprio 1
    v_exp_f32 v158, v158
    v_exp_f32 v159, v159
    v_cvt_pk_bf16_f32 v229, v154, v155
    v_cvt_pk_bf16_f32 v230, v156, v157
    v_xor_b32 v8, 16384, v8
    s_add_u32 m0, s82, 0x0
    v_exp_f32 v128, v128
    v_exp_f32 v129, v129
    v_exp_f32 v130, v130
    buffer_load_dwordx4 v2, s[8:11], s75 offen lds
    v_cvt_pk_bf16_f32 v231, v158, v159
    v_mfma_f32_32x32x16_bf16 v[144:159], v[124:127], v[116:119], v[192:207]
    s_add_u32 s75, s75, 32768
    v_exp_f32 v131, v131
    v_exp_f32 v132, v132
    v_exp_f32 v133, v133
    ds_read_b128 v[120:123], v8 offset:0
    v_cvt_pk_bf16_f32 v224, v128, v129
    s_add_u32 m0, s82, 0x0
    v_exp_f32 v134, v134
    v_exp_f32 v135, v135
    v_cvt_pk_bf16_f32 v225, v130, v131
    v_cvt_pk_bf16_f32 v226, v132, v133
    buffer_load_dwordx4 v2, s[8:11], s75 offen lds
    v_mfma_f32_32x32x16_bf16 v[176:191], v[212:215], v[228:231], v[176:191]
    s_add_u32 s75, s75, 32768
    s_setprio 0
    v_exp_f32 v136, v136
    v_exp_f32 v137, v137
    v_exp_f32 v138, v138
    v_cvt_pk_bf16_f32 v227, v134, v135
    v_exp_f32 v139, v139
    v_exp_f32 v140, v140
    v_exp_f32 v141, v141
    s_waitcnt lgkmcnt(2)
    v_cvt_pk_bf16_f32 v228, v136, v137
    v_mfma_f32_32x32x16_bf16 v[160:175], v[216:219], v[224:227], v[160:175]
    v_exp_f32 v142, v142
    v_exp_f32 v143, v143
    v_cvt_pk_bf16_f32 v229, v138, v139
    v_cvt_pk_bf16_f32 v230, v140, v141
    v_xor_b32 v9, 16384, v9
    v_exp_f32 v144, v144
    v_exp_f32 v145, v145
    v_exp_f32 v146, v146
    s_waitcnt lgkmcnt(0)
    v_cvt_pk_bf16_f32 v231, v142, v143
    v_mfma_f32_32x32x16_bf16 v[128:143], v[120:123], v[112:115], v[192:207]
    s_setprio 3
    v_exp_f32 v147, v147
    v_exp_f32 v148, v148
    v_exp_f32 v149, v149
    v_cvt_pk_bf16_f32 v224, v144, v145
    s_mov_b32 s80, 0x40000
    s_add_u32 m0, s82, 0x20000
    v_exp_f32 v150, v150
    v_exp_f32 v151, v151
    v_cvt_pk_bf16_f32 v225, v146, v147
    v_cvt_pk_bf16_f32 v226, v148, v149
    buffer_load_dwordx4 v20, s[4:7], s80 offen lds
    v_mfma_f32_32x32x16_bf16 v[160:175], v[220:223], v[228:231], v[160:175]
    v_exp_f32 v152, v152
    v_exp_f32 v153, v153
    v_exp_f32 v154, v154
    s_mov_b64 exec, s[98:99]
    ds_read_b128 v[208:211], v9 offset:0
    ds_read_b128 v[212:215], v9 offset:512
    s_mov_b64 exec, -1
    v_cvt_pk_bf16_f32 v227, v150, v151
    s_add_u32 m0, s82, 0x0
    v_exp_f32 v155, v155
    v_exp_f32 v156, v156
    v_exp_f32 v157, v157
    buffer_load_dwordx4 v2, s[8:11], s75 offen lds
    v_cvt_pk_bf16_f32 v228, v152, v153
    v_mfma_f32_32x32x16_bf16 v[176:191], v[216:219], v[224:227], v[176:191]
    s_add_u32 s75, s75, 32768
    s_setprio 2
    v_exp_f32 v158, v158
    v_exp_f32 v159, v159
    v_cvt_pk_bf16_f32 v229, v154, v155
    v_cvt_pk_bf16_f32 v230, v156, v157
    s_mov_b32 s80, 0x50000
    s_add_u32 m0, s82, 0x22000
    v_exp_f32 v128, v128
    v_exp_f32 v129, v129
    v_exp_f32 v130, v130
    buffer_load_dwordx4 v20, s[4:7], s80 offen lds
    v_cvt_pk_bf16_f32 v231, v158, v159
    v_mfma_f32_32x32x16_bf16 v[144:159], v[120:123], v[116:119], v[192:207]
    v_exp_f32 v131, v131
    v_exp_f32 v132, v132
    v_exp_f32 v133, v133
    ds_read_b128 v[124:127], v8 offset:1024
    v_cvt_pk_bf16_f32 v224, v128, v129
    v_exp_f32 v134, v134
    v_exp_f32 v135, v135
    v_cvt_pk_bf16_f32 v225, v130, v131
    v_cvt_pk_bf16_f32 v226, v132, v133
    v_mfma_f32_32x32x16_bf16 v[176:191], v[220:223], v[228:231], v[176:191]
    s_setprio 1
    v_exp_f32 v136, v136
    v_exp_f32 v137, v137
    v_exp_f32 v138, v138
    v_cvt_pk_bf16_f32 v227, v134, v135
    v_exp_f32 v139, v139
    v_exp_f32 v140, v140
    v_exp_f32 v141, v141
    s_waitcnt lgkmcnt(2)
    v_cvt_pk_bf16_f32 v228, v136, v137
    v_mfma_f32_32x32x16_bf16 v[160:175], v[208:211], v[224:227], v[160:175]
    v_exp_f32 v142, v142
    v_exp_f32 v143, v143
    v_cvt_pk_bf16_f32 v229, v138, v139
    v_cvt_pk_bf16_f32 v230, v140, v141
    v_exp_f32 v144, v144
    v_exp_f32 v145, v145
    v_exp_f32 v146, v146
    s_waitcnt lgkmcnt(0)
    v_cvt_pk_bf16_f32 v231, v142, v143
    v_mfma_f32_32x32x16_bf16 v[128:143], v[124:127], v[112:115], v[192:207]
    s_setprio 0
    v_exp_f32 v147, v147
    v_exp_f32 v148, v148
    v_exp_f32 v149, v149
    v_cvt_pk_bf16_f32 v224, v144, v145
    v_exp_f32 v150, v150
    v_exp_f32 v151, v151
    v_cvt_pk_bf16_f32 v225, v146, v147
    v_cvt_pk_bf16_f32 v226, v148, v149
    v_mfma_f32_32x32x16_bf16 v[160:175], v[212:215], v[228:231], v[160:175]
    v_exp_f32 v152, v152
    v_exp_f32 v153, v153
    v_exp_f32 v154, v154
    s_mov_b64 exec, s[98:99]
    ds_read_b128 v[216:219], v9 offset:1024
    ds_read_b128 v[220:223], v9 offset:1536
    s_mov_b64 exec, -1
    v_cvt_pk_bf16_f32 v227, v150, v151
    v_exp_f32 v155, v155
    v_exp_f32 v156, v156
    v_exp_f32 v157, v157
    v_cvt_pk_bf16_f32 v228, v152, v153
    s_waitcnt vmcnt(13)
    s_barrier
    v_mfma_f32_32x32x16_bf16 v[176:191], v[208:211], v[224:227], v[176:191]
    s_setprio 3
    v_exp_f32 v158, v158
    v_exp_f32 v159, v159
    v_cvt_pk_bf16_f32 v229, v154, v155
    v_cvt_pk_bf16_f32 v230, v156, v157
    s_mov_b32 s80, 0x0
    s_add_u32 m0, s82, 0x18000
    v_exp_f32 v128, v128
    v_exp_f32 v129, v129
    v_exp_f32 v130, v130
    buffer_load_dwordx4 v20, s[4:7], s80 offen lds
    v_cvt_pk_bf16_f32 v231, v158, v159
    v_mfma_f32_32x32x16_bf16 v[144:159], v[124:127], v[116:119], v[192:207]
    v_exp_f32 v131, v131
    v_exp_f32 v132, v132
    v_exp_f32 v133, v133
    ds_read_b128 v[120:123], v8 offset:8192
    v_cvt_pk_bf16_f32 v224, v128, v129
    s_add_u32 m0, s91, 0x2000
    v_exp_f32 v134, v134
    v_exp_f32 v135, v135
    v_cvt_pk_bf16_f32 v225, v130, v131
    v_cvt_pk_bf16_f32 v226, v132, v133
    buffer_load_dwordx4 v29, s[52:55], s95 offen sc1 lds
    v_mfma_f32_32x32x16_bf16 v[176:191], v[212:215], v[228:231], v[176:191]
    s_add_u32 s95, s95, 2048
    s_xor_b32 s91, s91, 16384
    s_setprio 2
    v_exp_f32 v136, v136
    v_exp_f32 v137, v137
    v_exp_f32 v138, v138
    v_cvt_pk_bf16_f32 v227, v134, v135
    s_mov_b32 s80, 0x10000
    s_add_u32 m0, s82, 0x1a000
    v_exp_f32 v139, v139
    v_exp_f32 v140, v140
    v_exp_f32 v141, v141
    buffer_load_dwordx4 v20, s[4:7], s80 offen lds
    s_waitcnt lgkmcnt(2)
    v_cvt_pk_bf16_f32 v228, v136, v137
    v_mfma_f32_32x32x16_bf16 v[160:175], v[216:219], v[224:227], v[160:175]
    v_exp_f32 v142, v142
    v_exp_f32 v143, v143
    v_cvt_pk_bf16_f32 v229, v138, v139
    v_cvt_pk_bf16_f32 v230, v140, v141
    v_exp_f32 v144, v144
    v_exp_f32 v145, v145
    v_exp_f32 v146, v146
    s_waitcnt lgkmcnt(0)
    v_cvt_pk_bf16_f32 v231, v142, v143
    v_mfma_f32_32x32x16_bf16 v[128:143], v[120:123], v[112:115], v[192:207]
    s_setprio 1
    v_exp_f32 v147, v147
    v_exp_f32 v148, v148
    v_exp_f32 v149, v149
    v_cvt_pk_bf16_f32 v224, v144, v145
    v_exp_f32 v150, v150
    v_exp_f32 v151, v151
    v_cvt_pk_bf16_f32 v225, v146, v147
    v_cvt_pk_bf16_f32 v226, v148, v149
    v_mfma_f32_32x32x16_bf16 v[160:175], v[220:223], v[228:231], v[160:175]
    v_exp_f32 v152, v152
    v_exp_f32 v153, v153
    v_exp_f32 v154, v154
    s_mov_b64 exec, s[98:99]
    ds_read_b128 v[208:211], v9 offset:8192
    ds_read_b128 v[212:215], v9 offset:8704
    s_mov_b64 exec, -1
    v_cvt_pk_bf16_f32 v227, v150, v151
    v_exp_f32 v155, v155
    v_exp_f32 v156, v156
    v_exp_f32 v157, v157
    v_cvt_pk_bf16_f32 v228, v152, v153
    v_mfma_f32_32x32x16_bf16 v[176:191], v[216:219], v[224:227], v[176:191]
    s_setprio 0
    v_exp_f32 v158, v158
    v_exp_f32 v159, v159
    v_cvt_pk_bf16_f32 v229, v154, v155
    v_cvt_pk_bf16_f32 v230, v156, v157
    v_exp_f32 v128, v128
    v_exp_f32 v129, v129
    v_exp_f32 v130, v130
    v_cvt_pk_bf16_f32 v231, v158, v159
    v_mfma_f32_32x32x16_bf16 v[144:159], v[120:123], v[116:119], v[192:207]
    v_exp_f32 v131, v131
    v_exp_f32 v132, v132
    v_exp_f32 v133, v133
    ds_read_b128 v[124:127], v8 offset:9216
    v_cvt_pk_bf16_f32 v224, v128, v129
    v_exp_f32 v134, v134
    v_exp_f32 v135, v135
    v_cvt_pk_bf16_f32 v225, v130, v131
    v_cvt_pk_bf16_f32 v226, v132, v133
    s_waitcnt vmcnt(10)
    s_barrier
    v_mfma_f32_32x32x16_bf16 v[176:191], v[220:223], v[228:231], v[176:191]
    s_setprio 3
    v_exp_f32 v136, v136
    v_exp_f32 v137, v137
    v_exp_f32 v138, v138
    v_cvt_pk_bf16_f32 v227, v134, v135
    s_mov_b32 s80, 0x70000
    s_add_u32 m0, s82, 0x0
    v_exp_f32 v139, v139
    v_exp_f32 v140, v140
    v_exp_f32 v141, v141
    buffer_load_dwordx4 v20, s[4:7], s80 offen lds
    s_waitcnt lgkmcnt(2)
    v_cvt_pk_bf16_f32 v228, v136, v137
    v_mfma_f32_32x32x16_bf16 v[160:175], v[208:211], v[224:227], v[160:175]
    v_exp_f32 v142, v142
    v_exp_f32 v143, v143
    v_cvt_pk_bf16_f32 v229, v138, v139
    v_cvt_pk_bf16_f32 v230, v140, v141
    s_mov_b32 s80, 0x80000
    s_add_u32 m0, s82, 0x2000
    v_exp_f32 v144, v144
    v_exp_f32 v145, v145
    v_exp_f32 v146, v146
    buffer_load_dwordx4 v20, s[4:7], s80 offen lds
    s_waitcnt lgkmcnt(0)
    v_cvt_pk_bf16_f32 v231, v142, v143
    v_mfma_f32_32x32x16_bf16 v[128:143], v[124:127], v[112:115], v[192:207]
    s_setprio 2
    v_exp_f32 v147, v147
    v_exp_f32 v148, v148
    v_exp_f32 v149, v149
    v_cvt_pk_bf16_f32 v224, v144, v145
    s_mov_b32 s80, 0x90000
    s_add_u32 m0, s82, 0x4000
    v_exp_f32 v150, v150
    v_exp_f32 v151, v151
    v_cvt_pk_bf16_f32 v225, v146, v147
    v_cvt_pk_bf16_f32 v226, v148, v149
    buffer_load_dwordx4 v20, s[4:7], s80 offen lds
    v_mfma_f32_32x32x16_bf16 v[160:175], v[212:215], v[228:231], v[160:175]
    v_exp_f32 v152, v152
    v_exp_f32 v153, v153
    v_exp_f32 v154, v154
    s_mov_b64 exec, s[98:99]
    ds_read_b128 v[216:219], v9 offset:9216
    ds_read_b128 v[220:223], v9 offset:9728
    s_mov_b64 exec, -1
    v_cvt_pk_bf16_f32 v227, v150, v151
    s_mov_b32 s80, 0xa0000
    s_add_u32 m0, s82, 0x6000
    v_exp_f32 v155, v155
    v_exp_f32 v156, v156
    v_exp_f32 v157, v157
    buffer_load_dwordx4 v20, s[4:7], s80 offen lds
    v_cvt_pk_bf16_f32 v228, v152, v153
    v_mfma_f32_32x32x16_bf16 v[176:191], v[208:211], v[224:227], v[176:191]
    s_setprio 1
    v_exp_f32 v158, v158
    v_exp_f32 v159, v159
    v_cvt_pk_bf16_f32 v229, v154, v155
    v_cvt_pk_bf16_f32 v230, v156, v157
    s_and_b32 s78, s64, 1
    s_lshr_b32 s79, s64, 1
    s_lshl_b32 s71, s69, 1
    s_add_u32 s71, s71, s78
    s_mul_i32 s71, s71, 88
    s_add_u32 s71, s71, s79
    s_lshl_b32 s77, s71, 10
    s_add_u32 s77, s77, 0xe08000
    v_xor_b32 v8, 16384, v8
    s_mov_b32 s80, 0xb0000
    s_add_u32 m0, s82, 0x8000
    v_exp_f32 v128, v128
    v_exp_f32 v129, v129
    v_exp_f32 v130, v130
    buffer_load_dwordx4 v20, s[4:7], s80 offen lds
    v_cvt_pk_bf16_f32 v231, v158, v159
    v_mfma_f32_32x32x16_bf16 v[144:159], v[124:127], v[116:119], v[192:207]
    v_exp_f32 v131, v131
    v_exp_f32 v132, v132
    v_exp_f32 v133, v133
    ds_read_b128 v[120:123], v8 offset:0
    v_cvt_pk_bf16_f32 v224, v128, v129
    s_mov_b32 s80, 0xc0000
    s_add_u32 m0, s82, 0xa000
    v_exp_f32 v134, v134
    v_exp_f32 v135, v135
    v_cvt_pk_bf16_f32 v225, v130, v131
    v_cvt_pk_bf16_f32 v226, v132, v133
    buffer_load_dwordx4 v20, s[4:7], s80 offen lds
    v_mfma_f32_32x32x16_bf16 v[176:191], v[212:215], v[228:231], v[176:191]
    s_setprio 0
    v_exp_f32 v136, v136
    v_exp_f32 v137, v137
    v_exp_f32 v138, v138
    v_cvt_pk_bf16_f32 v227, v134, v135
    s_mov_b32 s80, 0xd0000
    s_add_u32 m0, s82, 0xc000
    v_exp_f32 v139, v139
    v_exp_f32 v140, v140
    v_exp_f32 v141, v141
    buffer_load_dwordx4 v20, s[4:7], s80 offen lds
    s_waitcnt lgkmcnt(2)
    v_cvt_pk_bf16_f32 v228, v136, v137
    v_mfma_f32_32x32x16_bf16 v[160:175], v[216:219], v[224:227], v[160:175]
    v_exp_f32 v142, v142
    v_exp_f32 v143, v143
    v_cvt_pk_bf16_f32 v229, v138, v139
    v_cvt_pk_bf16_f32 v230, v140, v141
    v_xor_b32 v9, 16384, v9
    v_exp_f32 v144, v144
    v_exp_f32 v145, v145
    v_exp_f32 v146, v146
    v_cvt_pk_bf16_f32 v231, v142, v143
    s_waitcnt vmcnt(7) lgkmcnt(0)
    s_barrier
    v_mfma_f32_32x32x16_bf16 v[128:143], v[120:123], v[112:115], v[192:207]
    s_setprio 3
    v_exp_f32 v147, v147
    v_exp_f32 v148, v148
    v_exp_f32 v149, v149
    v_cvt_pk_bf16_f32 v224, v144, v145
    s_add_u32 s84, s77, 8192
    v_exp_f32 v150, v150
    v_exp_f32 v151, v151
    v_cvt_pk_bf16_f32 v225, v146, v147
    v_cvt_pk_bf16_f32 v226, v148, v149
    buffer_load_dwordx4 v[40:43], v2, s[52:55], s84 offen sc1
    v_mfma_f32_32x32x16_bf16 v[160:175], v[220:223], v[228:231], v[160:175]
    s_add_u32 s84, s77, 12288
    v_exp_f32 v152, v152
    v_exp_f32 v153, v153
    v_exp_f32 v154, v154
    s_mov_b64 exec, s[98:99]
    ds_read_b128 v[208:211], v9 offset:0
    ds_read_b128 v[212:215], v9 offset:512
    s_mov_b64 exec, -1
    buffer_load_dwordx4 v[44:47], v2, s[52:55], s84 offen sc1
    v_cvt_pk_bf16_f32 v227, v150, v151
    s_mov_b32 s80, 0x60000
    s_add_u32 m0, s82, 0xe000
    v_exp_f32 v155, v155
    v_exp_f32 v156, v156
    v_exp_f32 v157, v157
    buffer_load_dwordx4 v20, s[8:11], s80 offen lds
    s_add_u32 s84, s77, 16384
    buffer_load_dwordx4 v[48:51], v2, s[52:55], s84 offen sc1
    s_add_u32 s84, s77, 20480
    buffer_load_dwordx4 v[52:55], v2, s[52:55], s84 offen sc1
    v_cvt_pk_bf16_f32 v228, v152, v153
    v_mfma_f32_32x32x16_bf16 v[176:191], v[216:219], v[224:227], v[176:191]
    s_add_u32 s84, s77, 0
    s_setprio 2
    v_exp_f32 v158, v158
    v_exp_f32 v159, v159
    v_cvt_pk_bf16_f32 v229, v154, v155
    v_cvt_pk_bf16_f32 v230, v156, v157
    buffer_load_dwordx4 v[32:35], v2, s[52:55], s84 offen sc1
    s_add_u32 s84, s77, 4096
    buffer_load_dwordx4 v[36:39], v2, s[52:55], s84 offen sc1
    s_add_u32 s84, s77, 24576
    v_exp_f32 v128, v128
    v_exp_f32 v129, v129
    v_exp_f32 v130, v130
    buffer_load_dwordx4 v[56:59], v2, s[52:55], s84 offen sc1
    v_cvt_pk_bf16_f32 v231, v158, v159
    v_mfma_f32_32x32x16_bf16 v[144:159], v[120:123], v[116:119], v[192:207]
    v_exp_f32 v131, v131
    v_exp_f32 v132, v132
    v_exp_f32 v133, v133
    ds_read_b128 v[124:127], v8 offset:1024
    v_cvt_pk_bf16_f32 v224, v128, v129
    v_exp_f32 v134, v134
    v_exp_f32 v135, v135
    v_cvt_pk_bf16_f32 v225, v130, v131
    v_cvt_pk_bf16_f32 v226, v132, v133
    v_mfma_f32_32x32x16_bf16 v[176:191], v[220:223], v[228:231], v[176:191]
    s_setprio 1
    v_exp_f32 v136, v136
    v_exp_f32 v137, v137
    v_exp_f32 v138, v138
    ds_read_b64_tr_b16 v[232:233], v21 offset:0
    ds_read_b64_tr_b16 v[234:235], v21 offset:1024
    ds_read_b64_tr_b16 v[236:237], v22 offset:0
    ds_read_b64_tr_b16 v[238:239], v22 offset:1024
    v_cvt_pk_bf16_f32 v227, v134, v135
    v_exp_f32 v139, v139
    v_exp_f32 v140, v140
    v_exp_f32 v141, v141
    s_waitcnt lgkmcnt(6)
    v_cvt_pk_bf16_f32 v228, v136, v137
    v_mfma_f32_32x32x16_bf16 v[160:175], v[208:211], v[224:227], v[160:175]
    v_exp_f32 v142, v142
    v_exp_f32 v143, v143
    v_cvt_pk_bf16_f32 v229, v138, v139
    v_cvt_pk_bf16_f32 v230, v140, v141
    s_mov_b32 s88, 0
    s_waitcnt vmcnt(0)
    s_branch UC_168
UC_167:
    s_add_u32 s84, s77, 0
    v_and_b32 v5, 7, v1
    v_min_u32 v5, 6, v5
    v_lshlrev_b32 v5, 12, v5
    s_sleep 2
    buffer_load_dword v6, v5, s[52:55], s84 offen offset:1020 sc1
    s_add_u32 s88, s88, 1
    s_cmp_ge_u32 s88, 40000
    s_cbranch_scc1 UC_169
    s_waitcnt vmcnt(0)
    v_cmp_eq_u32 vcc, -1, v6
    s_nop 0
    s_cmp_lg_u64 vcc, 0
    s_cbranch_scc1 UC_167
    s_add_u32 s84, s77, 0
    buffer_load_dwordx4 v[32:35], v2, s[52:55], s84 offen sc1
    s_add_u32 s84, s77, 4096
    buffer_load_dwordx4 v[36:39], v2, s[52:55], s84 offen sc1
    s_add_u32 s84, s77, 8192
    buffer_load_dwordx4 v[40:43], v2, s[52:55], s84 offen sc1
    s_add_u32 s84, s77, 12288
    buffer_load_dwordx4 v[44:47], v2, s[52:55], s84 offen sc1
    s_add_u32 s84, s77, 16384
    buffer_load_dwordx4 v[48:51], v2, s[52:55], s84 offen sc1
    s_add_u32 s84, s77, 20480
    buffer_load_dwordx4 v[52:55], v2, s[52:55], s84 offen sc1
    s_add_u32 s84, s77, 24576
    buffer_load_dwordx4 v[56:59], v2, s[52:55], s84 offen sc1
    s_waitcnt vmcnt(0)
UC_168:
    v_max3_u32 v5, v32, v33, v34
    v_max3_u32 v6, v35, v36, v37
    v_max3_u32 v5, v5, v38, v39
    v_max3_u32 v6, v6, v40, v41
    v_max3_u32 v5, v5, v42, v43
    v_max3_u32 v6, v6, v44, v45
    v_max3_u32 v5, v5, v46, v47
    v_max3_u32 v6, v6, v48, v49
    v_max3_u32 v5, v5, v50, v51
    v_max3_u32 v6, v6, v52, v53
    v_max3_u32 v5, v5, v54, v55
    v_max3_u32 v6, v6, v56, v57
    v_max3_u32 v5, v5, v58, v59
    v_max_u32 v5, v5, v6
    v_cmp_eq_u32 vcc, -1, v5
    s_nop 0
    s_cmp_lg_u64 vcc, 0
    s_cbranch_scc1 UC_167
UC_169:
    v_exp_f32 v144, v144
    v_exp_f32 v145, v145
    v_exp_f32 v146, v146
    s_waitcnt lgkmcnt(4)
    v_cvt_pk_bf16_f32 v231, v142, v143
    v_mfma_f32_32x32x16_bf16 v[128:143], v[124:127], v[112:115], v[192:207]
    s_setprio 0
    v_exp_f32 v147, v147
    v_exp_f32 v148, v148
    v_exp_f32 v149, v149
    ds_read_b64_tr_b16 v[240:241], v21 offset:8192
    ds_read_b64_tr_b16 v[242:243], v21 offset:9216
    ds_read_b64_tr_b16 v[244:245], v22 offset:8192
    ds_read_b64_tr_b16 v[246:247], v22 offset:9216
    s_waitcnt lgkmcnt(6)
    v_cvt_pk_bf16_f32 v224, v144, v145
    v_mfma_f32_32x32x16_bf16 v[64:79], v[232:235], v[32:35], 0
    v_exp_f32 v150, v150
    v_exp_f32 v151, v151
    v_cvt_pk_bf16_f32 v225, v146, v147
    v_cvt_pk_bf16_f32 v226, v148, v149
    s_nop 1
    v_mfma_f32_32x32x16_bf16 v[160:175], v[212:215], v[228:231], v[160:175]
    v_exp_f32 v152, v152
    v_exp_f32 v153, v153
    v_exp_f32 v154, v154
    s_mov_b64 exec, s[98:99]
    ds_read_b128 v[216:219], v9 offset:1024
    ds_read_b128 v[220:223], v9 offset:1536
    s_mov_b64 exec, -1
    s_waitcnt lgkmcnt(6)
    v_cvt_pk_bf16_f32 v227, v150, v151
    v_mfma_f32_32x32x16_bf16 v[80:95], v[236:239], v[32:35], 0
    v_exp_f32 v155, v155
    v_exp_f32 v156, v156
    v_exp_f32 v157, v157
    v_cvt_pk_bf16_f32 v228, v152, v153
    s_waitcnt lgkmcnt(2)
    s_barrier
    v_mfma_f32_32x32x16_bf16 v[176:191], v[208:211], v[224:227], v[176:191]
    s_setprio 3
    v_exp_f32 v158, v158
    v_exp_f32 v159, v159
    v_cvt_pk_bf16_f32 v229, v154, v155
    v_cvt_pk_bf16_f32 v230, v156, v157
    s_xor_b32 s91, s91, 16384
    ds_read_b64_tr_b16 v[232:233], v21 offset:16384
    ds_read_b64_tr_b16 v[234:235], v21 offset:17408
    ds_read_b64_tr_b16 v[236:237], v22 offset:16384
    ds_read_b64_tr_b16 v[238:239], v22 offset:17408
    v_mfma_f32_32x32x16_bf16 v[64:79], v[240:243], v[36:39], v[64:79]
    s_mov_b32 s80, 0x0
    s_add_u32 m0, s82, 0x18000
    v_exp_f32 v128, v128
    v_exp_f32 v129, v129
    v_exp_f32 v130, v130
    s_nop 0
    buffer_load_dwordx4 v20, s[8:11], s80 offen lds
    v_cvt_pk_bf16_f32 v231, v158, v159
    v_mfma_f32_32x32x16_bf16 v[144:159], v[124:127], v[116:119], v[192:207]
    v_exp_f32 v131, v131
    v_exp_f32 v132, v132
    v_exp_f32 v133, v133
    s_nop 0
    ds_read_b128 v[120:123], v8 offset:8192
    v_cvt_pk_bf16_f32 v224, v128, v129
    v_mfma_f32_32x32x16_bf16 v[80:95], v[244:247], v[36:39], v[80:95]
    s_add_u32 s84, s77, 28672
    v_exp_f32 v134, v134
    v_exp_f32 v135, v135
    v_cvt_pk_bf16_f32 v225, v130, v131
    v_cvt_pk_bf16_f32 v226, v132, v133
    s_nop 0
    buffer_load_dwordx4 v[60:63], v2, s[52:55], s84 offen sc1
    v_mfma_f32_32x32x16_bf16 v[176:191], v[212:215], v[228:231], v[176:191]
    s_setprio 2
    v_exp_f32 v136, v136
    v_exp_f32 v137, v137
    v_exp_f32 v138, v138
    ds_read_b64_tr_b16 v[240:241], v21 offset:24576
    ds_read_b64_tr_b16 v[242:243], v21 offset:25600
    ds_read_b64_tr_b16 v[244:245], v22 offset:24576
    ds_read_b64_tr_b16 v[246:247], v22 offset:25600
    s_waitcnt lgkmcnt(7)
    v_cvt_pk_bf16_f32 v227, v134, v135
    v_mfma_f32_32x32x16_bf16 v[64:79], v[232:235], v[40:43], v[64:79]
    s_add_u32 s84, s77, 45056
    v_exp_f32 v139, v139
    v_exp_f32 v140, v140
    v_exp_f32 v141, v141
    s_nop 0
    buffer_load_dwordx4 v[108:111], v2, s[52:55], s84 offen sc1
    v_cvt_pk_bf16_f32 v228, v136, v137
    v_mfma_f32_32x32x16_bf16 v[160:175], v[216:219], v[224:227], v[160:175]
    s_add_u32 s84, s77, 49152
    v_exp_f32 v142, v142
    v_exp_f32 v143, v143
    v_cvt_pk_bf16_f32 v229, v138, v139
    v_cvt_pk_bf16_f32 v230, v140, v141
    buffer_load_dwordx4 v[248:251], v2, s[52:55], s84 offen sc1
    s_waitcnt lgkmcnt(5)
    v_mfma_f32_32x32x16_bf16 v[80:95], v[236:239], v[40:43], v[80:95]
    s_add_u32 s84, s77, 32768
    v_exp_f32 v144, v144
    v_exp_f32 v145, v145
    v_exp_f32 v146, v146
    buffer_load_dwordx4 v[96:99], v2, s[52:55], s84 offen sc1
    s_waitcnt lgkmcnt(4)
    v_cvt_pk_bf16_f32 v231, v142, v143
    v_mfma_f32_32x32x16_bf16 v[128:143], v[120:123], v[112:115], v[192:207]
    s_add_u32 s84, s77, 53248
    s_setprio 1
    v_exp_f32 v147, v147
    v_exp_f32 v148, v148
    v_exp_f32 v149, v149
    ds_read_b64_tr_b16 v[232:233], v21 offset:32768
    ds_read_b64_tr_b16 v[234:235], v21 offset:33792
    ds_read_b64_tr_b16 v[236:237], v22 offset:32768
    ds_read_b64_tr_b16 v[238:239], v22 offset:33792
    buffer_load_dwordx4 v[252:255], v2, s[52:55], s84 offen sc1
    s_waitcnt lgkmcnt(6)
    v_cvt_pk_bf16_f32 v224, v144, v145
    v_mfma_f32_32x32x16_bf16 v[64:79], v[240:243], v[44:47], v[64:79]
    s_mov_b32 s80, 0x10000
    s_add_u32 m0, s82, 0x1a000
    v_exp_f32 v150, v150
    v_exp_f32 v151, v151
    v_cvt_pk_bf16_f32 v225, v146, v147
    v_cvt_pk_bf16_f32 v226, v148, v149
    s_nop 0
    buffer_load_dwordx4 v20, s[8:11], s80 offen lds
    v_mfma_f32_32x32x16_bf16 v[160:175], v[220:223], v[228:231], v[160:175]
    s_lshl_b32 s71, s69, 1
    s_add_u32 s71, s71, s78
    v_exp_f32 v152, v152
    v_exp_f32 v153, v153
    v_exp_f32 v154, v154
    s_mov_b64 exec, s[98:99]
    ds_read_b128 v[208:211], v9 offset:8192
    ds_read_b128 v[212:215], v9 offset:8704
    s_mov_b64 exec, -1
    s_lshl_b32 s71, s71, 7
    s_add_u32 s71, s71, 0x1400000
    v_and_b32 v23, 31, v1
    v_lshlrev_b32 v23, 2, v23
    buffer_load_dword v23, v23, s[52:55], s71 offen sc1
    s_waitcnt lgkmcnt(6)
    v_cvt_pk_bf16_f32 v227, v150, v151
    v_mfma_f32_32x32x16_bf16 v[80:95], v[244:247], v[44:47], v[80:95]
    s_add_u32 s84, s77, 36864
    v_exp_f32 v155, v155
    v_exp_f32 v156, v156
    v_exp_f32 v157, v157
    s_nop 0
    buffer_load_dwordx4 v[100:103], v2, s[52:55], s84 offen sc1
    v_cvt_pk_bf16_f32 v228, v152, v153
    v_mfma_f32_32x32x16_bf16 v[176:191], v[216:219], v[224:227], v[176:191]
    s_setprio 0
    v_exp_f32 v158, v158
    v_exp_f32 v159, v159
    v_cvt_pk_bf16_f32 v229, v154, v155
    v_cvt_pk_bf16_f32 v230, v156, v157
    ds_read_b64_tr_b16 v[240:241], v21 offset:40960
    ds_read_b64_tr_b16 v[242:243], v21 offset:41984
    ds_read_b64_tr_b16 v[244:245], v22 offset:40960
    ds_read_b64_tr_b16 v[246:247], v22 offset:41984
    s_waitcnt lgkmcnt(8)
    v_mfma_f32_32x32x16_bf16 v[64:79], v[232:235], v[48:51], v[64:79]
    s_add_u32 s84, s77, 40960
    v_exp_f32 v128, v128
    v_exp_f32 v129, v129
    v_exp_f32 v130, v130
    s_nop 0
    buffer_load_dwordx4 v[104:107], v2, s[52:55], s84 offen sc1
    v_cvt_pk_bf16_f32 v231, v158, v159
    v_mfma_f32_32x32x16_bf16 v[144:159], v[120:123], v[116:119], v[192:207]
    v_exp_f32 v131, v131
    v_exp_f32 v132, v132
    v_exp_f32 v133, v133
    ds_read_b128 v[124:127], v8 offset:9216
    s_waitcnt lgkmcnt(7)
    v_cvt_pk_bf16_f32 v224, v128, v129
    v_mfma_f32_32x32x16_bf16 v[80:95], v[236:239], v[48:51], v[80:95]
    v_exp_f32 v134, v134
    v_exp_f32 v135, v135
    v_cvt_pk_bf16_f32 v225, v130, v131
    v_cvt_pk_bf16_f32 v226, v132, v133
    s_waitcnt lgkmcnt(1)
    s_barrier
    v_mfma_f32_32x32x16_bf16 v[176:191], v[220:223], v[228:231], v[176:191]
    s_setprio 3
    v_exp_f32 v136, v136
    v_exp_f32 v137, v137
    v_exp_f32 v138, v138
    ds_read_b64_tr_b16 v[232:233], v21 offset:49152
    ds_read_b64_tr_b16 v[234:235], v21 offset:50176
    ds_read_b64_tr_b16 v[236:237], v22 offset:49152
    ds_read_b64_tr_b16 v[238:239], v22 offset:50176
    v_cvt_pk_bf16_f32 v227, v134, v135
    v_mfma_f32_32x32x16_bf16 v[64:79], v[240:243], v[52:55], v[64:79]
    s_mov_b32 s80, 0x30000
    s_add_u32 m0, s82, 0x1e000
    v_exp_f32 v139, v139
    v_exp_f32 v140, v140
    v_exp_f32 v141, v141
    s_nop 0
    buffer_load_dwordx4 v20, s[8:11], s80 offen lds
    v_cvt_pk_bf16_f32 v228, v136, v137
    v_mfma_f32_32x32x16_bf16 v[160:175], v[208:211], v[224:227], v[160:175]
    v_exp_f32 v142, v142
    v_exp_f32 v143, v143
    v_cvt_pk_bf16_f32 v229, v138, v139
    v_cvt_pk_bf16_f32 v230, v140, v141
    s_nop 1
    v_mfma_f32_32x32x16_bf16 v[80:95], v[244:247], v[52:55], v[80:95]
    s_mov_b32 s80, 0x20000
    s_add_u32 m0, s82, 0x1c000
    v_exp_f32 v144, v144
    v_exp_f32 v145, v145
    v_exp_f32 v146, v146
    buffer_load_dwordx4 v20, s[8:11], s80 offen lds
    s_waitcnt lgkmcnt(4)
    v_cvt_pk_bf16_f32 v231, v142, v143
    v_mfma_f32_32x32x16_bf16 v[128:143], v[124:127], v[112:115], v[192:207]
    s_mov_b32 s80, 0x40000
    s_add_u32 m0, s82, 0x20000
    s_setprio 2
    v_exp_f32 v147, v147
    v_exp_f32 v148, v148
    v_exp_f32 v149, v149
    v_subrev_u32 v21, 98304, v21
    v_subrev_u32 v22, 98304, v22
    ds_read_b64_tr_b16 v[240:241], v21 offset:0
    ds_read_b64_tr_b16 v[242:243], v21 offset:1024
    ds_read_b64_tr_b16 v[244:245], v22 offset:0
    ds_read_b64_tr_b16 v[246:247], v22 offset:1024
    buffer_load_dwordx4 v20, s[8:11], s80 offen lds
    s_waitcnt lgkmcnt(6)
    v_cvt_pk_bf16_f32 v224, v144, v145
    v_mfma_f32_32x32x16_bf16 v[64:79], v[232:235], v[56:59], v[64:79]
    s_mov_b32 s80, 0x50000
    s_add_u32 m0, s82, 0x22000
    v_exp_f32 v150, v150
    v_exp_f32 v151, v151
    v_cvt_pk_bf16_f32 v225, v146, v147
    v_cvt_pk_bf16_f32 v226, v148, v149
    s_nop 0
    buffer_load_dwordx4 v20, s[8:11], s80 offen lds
    v_mfma_f32_32x32x16_bf16 v[160:175], v[212:215], v[228:231], v[160:175]
    v_exp_f32 v152, v152
    v_exp_f32 v153, v153
    v_exp_f32 v154, v154
    s_mov_b64 exec, s[98:99]
    ds_read_b128 v[216:219], v9 offset:9216
    ds_read_b128 v[220:223], v9 offset:9728
    s_mov_b64 exec, -1
    s_waitcnt lgkmcnt(6)
    v_cvt_pk_bf16_f32 v227, v150, v151
    v_mfma_f32_32x32x16_bf16 v[80:95], v[236:239], v[56:59], v[80:95]
    v_exp_f32 v155, v155
    v_exp_f32 v156, v156
    v_exp_f32 v157, v157
    s_nop 1
    v_cvt_pk_bf16_f32 v228, v152, v153
    v_mfma_f32_32x32x16_bf16 v[176:191], v[208:211], v[224:227], v[176:191]
    s_setprio 1
    v_exp_f32 v158, v158
    v_exp_f32 v159, v159
    v_cvt_pk_bf16_f32 v229, v154, v155
    v_cvt_pk_bf16_f32 v230, v156, v157
    ds_read_b64_tr_b16 v[232:233], v21 offset:8192
    ds_read_b64_tr_b16 v[234:235], v21 offset:9216
    ds_read_b64_tr_b16 v[236:237], v22 offset:8192
    ds_read_b64_tr_b16 v[238:239], v22 offset:9216
    s_waitcnt lgkmcnt(8)
    s_mov_b32 s88, 0
    s_waitcnt vmcnt(4)
    s_branch UC_171
UC_170:
    s_add_u32 s84, s77, 28672
    v_and_b32 v5, 7, v1
    v_min_u32 v5, 6, v5
    v_lshlrev_b32 v5, 12, v5
    s_sleep 2
    buffer_load_dword v6, v5, s[52:55], s84 offen offset:1020 sc1
    s_add_u32 s88, s88, 1
    s_cmp_ge_u32 s88, 40000
    s_cbranch_scc1 UC_172
    s_waitcnt vmcnt(0)
    v_cmp_eq_u32 vcc, -1, v6
    s_nop 0
    s_cmp_lg_u64 vcc, 0
    s_cbranch_scc1 UC_170
    s_add_u32 s84, s77, 28672
    buffer_load_dwordx4 v[60:63], v2, s[52:55], s84 offen sc1
    s_add_u32 s84, s77, 32768
    buffer_load_dwordx4 v[96:99], v2, s[52:55], s84 offen sc1
    s_add_u32 s84, s77, 36864
    buffer_load_dwordx4 v[100:103], v2, s[52:55], s84 offen sc1
    s_add_u32 s84, s77, 40960
    buffer_load_dwordx4 v[104:107], v2, s[52:55], s84 offen sc1
    s_add_u32 s84, s77, 45056
    buffer_load_dwordx4 v[108:111], v2, s[52:55], s84 offen sc1
    s_add_u32 s84, s77, 49152
    buffer_load_dwordx4 v[248:251], v2, s[52:55], s84 offen sc1
    s_add_u32 s84, s77, 53248
    buffer_load_dwordx4 v[252:255], v2, s[52:55], s84 offen sc1
    s_waitcnt vmcnt(0)
UC_171:
    v_max3_u32 v5, v60, v61, v62
    v_max3_u32 v6, v63, v96, v97
    v_max3_u32 v5, v5, v98, v99
    v_max3_u32 v6, v6, v100, v101
    v_max3_u32 v5, v5, v102, v103
    v_max3_u32 v6, v6, v104, v105
    v_max3_u32 v5, v5, v106, v107
    v_max3_u32 v6, v6, v108, v109
    v_max3_u32 v5, v5, v110, v111
    v_max3_u32 v6, v6, v248, v249
    v_max3_u32 v5, v5, v250, v251
    v_max3_u32 v6, v6, v252, v253
    v_max3_u32 v5, v5, v254, v255
    v_max_u32 v5, v5, v6
    v_cmp_eq_u32 vcc, -1, v5
    s_nop 0
    s_cmp_lg_u64 vcc, 0
    s_cbranch_scc1 UC_170
UC_172:
    v_mfma_f32_32x32x16_bf16 v[64:79], v[240:243], v[60:63], v[64:79]
    v_exp_f32 v128, v128
    v_exp_f32 v129, v129
    v_exp_f32 v130, v130
    s_nop 1
    v_cvt_pk_bf16_f32 v231, v158, v159
    v_mfma_f32_32x32x16_bf16 v[144:159], v[124:127], v[116:119], v[192:207]
    v_exp_f32 v131, v131
    v_exp_f32 v132, v132
    v_exp_f32 v133, v133
    s_nop 0
    s_waitcnt lgkmcnt(6)
    v_cvt_pk_bf16_f32 v224, v128, v129
    v_mfma_f32_32x32x16_bf16 v[80:95], v[244:247], v[60:63], v[80:95]
    v_exp_f32 v134, v134
    v_exp_f32 v135, v135
    v_cvt_pk_bf16_f32 v225, v130, v131
    v_cvt_pk_bf16_f32 v226, v132, v133
    s_nop 1
    v_mfma_f32_32x32x16_bf16 v[176:191], v[212:215], v[228:231], v[176:191]
    s_setprio 0
    v_exp_f32 v136, v136
    v_exp_f32 v137, v137
    v_exp_f32 v138, v138
    ds_read_b64_tr_b16 v[240:241], v21 offset:16384
    ds_read_b64_tr_b16 v[242:243], v21 offset:17408
    ds_read_b64_tr_b16 v[244:245], v22 offset:16384
    ds_read_b64_tr_b16 v[246:247], v22 offset:17408
    s_waitcnt lgkmcnt(6)
    v_cvt_pk_bf16_f32 v227, v134, v135
    v_mfma_f32_32x32x16_bf16 v[64:79], v[232:235], v[96:99], v[64:79]
    v_exp_f32 v139, v139
    v_exp_f32 v140, v140
    v_exp_f32 v141, v141
    s_nop 1
    v_cvt_pk_bf16_f32 v228, v136, v137
    v_mfma_f32_32x32x16_bf16 v[160:175], v[216:219], v[224:227], v[160:175]
    v_exp_f32 v142, v142
    v_exp_f32 v143, v143
    v_cvt_pk_bf16_f32 v229, v138, v139
    v_cvt_pk_bf16_f32 v230, v140, v141
    s_nop 0
    s_waitcnt lgkmcnt(4)
    s_add_u32 s71, s83, 65536
    s_add_u32 s72, s82, 81920
    v_add_u32 v8, s71, v2
    v_add_u32 v9, s72, v2
    v_mfma_f32_32x32x16_bf16 v[80:95], v[236:239], v[96:99], v[80:95]
    v_exp_f32 v144, v144
    v_exp_f32 v145, v145
    v_exp_f32 v146, v146
    v_cvt_pk_bf16_f32 v231, v142, v143
    s_setprio 3
    v_exp_f32 v147, v147
    v_exp_f32 v148, v148
    v_exp_f32 v149, v149
    ds_read_b64_tr_b16 v[232:233], v21 offset:24576
    ds_read_b64_tr_b16 v[234:235], v21 offset:25600
    ds_read_b64_tr_b16 v[236:237], v22 offset:24576
    ds_read_b64_tr_b16 v[238:239], v22 offset:25600
    s_waitcnt lgkmcnt(6)
    v_cvt_pk_bf16_f32 v224, v144, v145
    v_mfma_f32_32x32x16_bf16 v[64:79], v[240:243], v[100:103], v[64:79]
    v_exp_f32 v150, v150
    v_exp_f32 v151, v151
    v_cvt_pk_bf16_f32 v225, v146, v147
    v_cvt_pk_bf16_f32 v226, v148, v149
    s_nop 1
    v_mfma_f32_32x32x16_bf16 v[160:175], v[220:223], v[228:231], v[160:175]
    v_exp_f32 v152, v152
    v_exp_f32 v153, v153
    v_exp_f32 v154, v154
    s_nop 0
    s_waitcnt lgkmcnt(4)
    v_cvt_pk_bf16_f32 v227, v150, v151
    v_mfma_f32_32x32x16_bf16 v[80:95], v[244:247], v[100:103], v[80:95]
    v_exp_f32 v155, v155
    v_exp_f32 v156, v156
    v_exp_f32 v157, v157
    s_nop 1
    v_cvt_pk_bf16_f32 v228, v152, v153
    v_mfma_f32_32x32x16_bf16 v[176:191], v[216:219], v[224:227], v[176:191]
    s_setprio 2
    v_exp_f32 v158, v158
    v_exp_f32 v159, v159
    v_cvt_pk_bf16_f32 v229, v154, v155
    v_cvt_pk_bf16_f32 v230, v156, v157
    ds_read_b64_tr_b16 v[240:241], v21 offset:32768
    ds_read_b64_tr_b16 v[242:243], v21 offset:33792
    ds_read_b64_tr_b16 v[244:245], v22 offset:32768
    ds_read_b64_tr_b16 v[246:247], v22 offset:33792
    ds_write_b128 v8, v[160:163] offset:0
    ds_write_b128 v8, v[164:167] offset:1024
    ds_write_b32 v9, v168
FK_ATT_EPI:
    v_cvt_pk_bf16_f32 v231, v158, v159
    s_nop 1
    v_mfma_f32_32x32x16_bf16 v[176:191], v[220:223], v[228:231], v[176:191]
    v_xor_b32 v8, 8192, v8
    v_xor_b32 v9, 4096, v9
    s_waitcnt vmcnt(0) lgkmcnt(0)
    s_barrier
    ds_read_b128 v[32:35], v8 offset:0
    ds_read_b128 v[36:39], v8 offset:1024
    ds_read_b32 v40, v9
    s_mul_i32 s72, s79, 7168
    s_add_u32 s77, s77, s72
    s_sub_u32 s77, s77, 32768
    s_add_u32 s85, s77, 4096
    s_mul_i32 s71, s79, 14336
    s_add_u32 s71, s71, 98304
    s_mov_b32 s72, s71
    s_cmp_eq_u32 s79, 3
    s_cmov_b32 s72, 51200
    v_add_u32 v14, s71, v21
    v_add_u32 v15, s71, v22
    v_add_u32 v16, s72, v21
    v_add_u32 v17, s72, v22
    v_and_b32 v18, 7, v1
    v_lshlrev_b32 v18, 10, v18
    s_mul_i32 s84, s90, 88
    s_add_u32 s84, s84, s16
    s_lshl_b32 s84, s84, 10
    s_add_u32 s89, s84, 0xe00000
    s_mov_b32 s84, 0x71800000
    s_mov_b32 s71, 0x0d800000
    s_mov_b32 s72, 0x207
    s_waitcnt lgkmcnt(2)
    v_pk_add_f32 v[176:177], v[176:177], v[32:33]
    v_pk_add_f32 v[178:179], v[178:179], v[34:35]
    s_waitcnt lgkmcnt(1)
    v_pk_add_f32 v[180:181], v[180:181], v[36:37]
    v_pk_add_f32 v[182:183], v[182:183], v[38:39]
    s_waitcnt lgkmcnt(0)
    v_add_f32 v184, v184, v40
    v_rcp_f32 v8, v184
    v_pk_add_f32 v[32:33], v[176:177], v[178:179]
    v_pk_add_f32 v[34:35], v[180:181], v[182:183]
    v_cmp_ngt_f32 s[86:87], s84, v184
    v_pk_add_f32 v[32:33], v[32:33], v[34:35]
    v_cmp_nlt_f32 vcc, s71, v184
    v_add_f32 v32, v32, v33
    s_or_b64 s[86:87], vcc, s[86:87]
    v_cmp_class_f32 vcc, v32, s72
    v_pk_mul_f32 v[176:177], v[176:177], v[8:9] op_sel_hi:[1,0]
    v_pk_mul_f32 v[178:179], v[178:179], v[8:9] op_sel_hi:[1,0]
    v_pk_mul_f32 v[180:181], v[180:181], v[8:9] op_sel_hi:[1,0]
    v_pk_mul_f32 v[182:183], v[182:183], v[8:9] op_sel_hi:[1,0]
    v_cvt_pk_bf16_f32 v120, v176, v177
    v_cvt_pk_bf16_f32 v121, v178, v179
    v_cvt_pk_bf16_f32 v122, v180, v181
    v_cvt_pk_bf16_f32 v123, v182, v183
    s_or_b64 vcc, vcc, s[86:87]
    s_cbranch_scc1 FK_FB
FK_FBRET:
    buffer_store_dwordx4 v[120:123], v2, s[52:55], s89 offen sc1
    ds_read_b64_tr_b16 v[44:45], v21 offset:40960
    ds_read_b64_tr_b16 v[46:47], v21 offset:41984
    ds_read_b64_tr_b16 v[48:49], v22 offset:40960
    ds_read_b64_tr_b16 v[50:51], v22 offset:41984
    ds_read_b64_tr_b16 v[52:53], v21 offset:49152
    ds_read_b64_tr_b16 v[54:55], v21 offset:50176
    ds_read_b64_tr_b16 v[56:57], v22 offset:49152
    ds_read_b64_tr_b16 v[58:59], v22 offset:50176
    ds_read_b64_tr_b16 v[128:129], v16 offset:0
    ds_read_b64_tr_b16 v[130:131], v16 offset:1024
    ds_read_b64_tr_b16 v[132:133], v17 offset:0
    ds_read_b64_tr_b16 v[134:135], v17 offset:1024
    ds_read_b64_tr_b16 v[136:137], v16 offset:2048
    ds_read_b64_tr_b16 v[138:139], v16 offset:3072
    ds_read_b64_tr_b16 v[140:141], v17 offset:2048
    ds_read_b64_tr_b16 v[142:143], v17 offset:3072
    ds_read_b64_tr_b16 v[144:145], v16 offset:4096
    ds_read_b64_tr_b16 v[146:147], v16 offset:5120
    ds_read_b64_tr_b16 v[148:149], v17 offset:4096
    ds_read_b64_tr_b16 v[150:151], v17 offset:5120
    v_mfma_f32_32x32x16_bf16 v[64:79], v[232:235], v[104:107], v[64:79]
    v_mfma_f32_32x32x16_bf16 v[80:95], v[236:239], v[104:107], v[80:95]
    ds_read_b64_tr_b16 v[152:153], v16 offset:6144
    ds_read_b64_tr_b16 v[154:155], v16 offset:7168
    ds_read_b64_tr_b16 v[156:157], v17 offset:6144
    ds_read_b64_tr_b16 v[158:159], v17 offset:7168
    v_mfma_f32_32x32x16_bf16 v[64:79], v[240:243], v[108:111], v[64:79]
    v_mfma_f32_32x32x16_bf16 v[80:95], v[244:247], v[108:111], v[80:95]
    ds_read_b64_tr_b16 v[160:161], v14 offset:8192
    ds_read_b64_tr_b16 v[162:163], v14 offset:9216
    ds_read_b64_tr_b16 v[164:165], v15 offset:8192
    ds_read_b64_tr_b16 v[166:167], v15 offset:9216
    s_waitcnt lgkmcnt(15)
    v_mfma_f32_32x32x16_bf16 v[64:79], v[44:47], v[248:251], v[64:79]
    v_mfma_f32_32x32x16_bf16 v[80:95], v[48:51], v[248:251], v[80:95]
    ds_read_b64_tr_b16 v[168:169], v14 offset:10240
    ds_read_b64_tr_b16 v[170:171], v14 offset:11264
    ds_read_b64_tr_b16 v[172:173], v15 offset:10240
    ds_read_b64_tr_b16 v[174:175], v15 offset:11264
    v_mfma_f32_32x32x16_bf16 v[64:79], v[52:55], v[252:255], v[64:79]
    v_mfma_f32_32x32x16_bf16 v[80:95], v[56:59], v[252:255], v[80:95]
    ds_read_b64_tr_b16 v[176:177], v14 offset:12288
    ds_read_b64_tr_b16 v[178:179], v14 offset:13312
    ds_read_b64_tr_b16 v[180:181], v15 offset:12288
    ds_read_b64_tr_b16 v[182:183], v15 offset:13312
    ds_read_b64_tr_b16 v[184:185], v14 offset:14336
    ds_read_b64_tr_b16 v[186:187], v14 offset:15360
    ds_read_b64_tr_b16 v[188:189], v15 offset:14336
    ds_read_b64_tr_b16 v[190:191], v15 offset:15360
    v_and_b32 v5, 31, v1
    v_lshrrev_b32 v6, 5, v1
    v_lshlrev_b32 v7, 4, v5
    v_lshl_add_u32 v7, v6, 3, v7
    v_and_b32 v6, 2, v1
    v_lshlrev_b32 v6, 2, v6
    v_and_or_b32 v6, v1, 7, v6
    v_xor_b32 v7, v7, v6
    s_lshl_b32 s71, s64, 13
    v_lshl_add_u32 v32, v7, 4, s71
    v_xor_b32 v33, 16, v32
    v_xor_b32 v34, 32, v32
    v_xor_b32 v35, 48, v32
    v_xor_b32 v36, 64, v32
    v_xor_b32 v37, 80, v32
    v_xor_b32 v38, 96, v32
    v_xor_b32 v39, 112, v32
    v_lshrrev_b32 v6, 3, v0
    v_and_b32 v7, 7, v0
    v_and_b32 v5, 2, v6
    v_lshlrev_b32 v5, 2, v5
    v_and_or_b32 v5, v6, 7, v5
    v_xor_b32 v5, v5, v7
    v_lshl_add_u32 v5, v6, 4, v5
    v_lshlrev_b32 v12, 4, v5
    v_xor_b32 v11, 128, v12
    v_lshlrev_b32 v6, 10, v6
    v_lshl_add_u32 v13, v7, 4, v6
    s_lshl_b32 s71, s69, 16
    s_lshl_b32 s72, s70, 7
    s_add_u32 s87, s71, s72
    v_sub_f32 v8, 1.0, v23
    v_mul_f32 v64, v64, v8
    v_mul_f32 v65, v65, v8
    v_mul_f32 v66, v66, v8
    v_mul_f32 v67, v67, v8
    v_mul_f32 v68, v68, v8
    v_mul_f32 v69, v69, v8
    v_mul_f32 v70, v70, v8
    v_mul_f32 v71, v71, v8
    v_mul_f32 v72, v72, v8
    v_mul_f32 v73, v73, v8
    v_mul_f32 v74, v74, v8
    v_mul_f32 v75, v75, v8
    v_mul_f32 v76, v76, v8
    v_mul_f32 v77, v77, v8
    v_mul_f32 v78, v78, v8
    v_mul_f32 v79, v79, v8
    v_mul_f32 v80, v80, v8
    v_mul_f32 v81, v81, v8
    v_mul_f32 v82, v82, v8
    v_mul_f32 v83, v83, v8
    v_mul_f32 v84, v84, v8
    v_mul_f32 v85, v85, v8
    v_mul_f32 v86, v86, v8
    v_mul_f32 v87, v87, v8
    v_mul_f32 v88, v88, v8
    v_mul_f32 v89, v89, v8
    v_mul_f32 v90, v90, v8
    v_mul_f32 v91, v91, v8
    v_mul_f32 v92, v92, v8
    v_mul_f32 v93, v93, v8
    v_mul_f32 v94, v94, v8
    v_mul_f32 v95, v95, v8
    s_mov_b32 s88, 0
    v_and_b32 v7, 7, v1
    v_lshlrev_b32 v7, 10, v7
    s_waitcnt lgkmcnt(0)
    s_barrier
    buffer_load_dwordx4 v[192:195], v2, s[52:55], s77 offen offset:0 sc1
    buffer_load_dwordx4 v[196:199], v2, s[52:55], s77 offen offset:1024 sc1
    buffer_load_dwordx4 v[200:203], v2, s[52:55], s77 offen offset:2048 sc1
    buffer_load_dwordx4 v[204:207], v2, s[52:55], s77 offen offset:3072 sc1
    buffer_load_dwordx4 v[208:211], v2, s[52:55], s85 offen offset:0 sc1
    buffer_load_dwordx4 v[212:215], v2, s[52:55], s85 offen offset:1024 sc1
    buffer_load_dwordx4 v[216:219], v2, s[52:55], s85 offen offset:2048 sc1
    buffer_load_dwordx4 v[220:223], v2, s[52:55], s85 offen offset:3072 sc1
FK_OK0:
    s_waitcnt vmcnt(7)
    v_max3_u32 v5, v192, v193, v194
    v_max_u32 v5, v5, v195
    v_cmp_eq_u32 vcc, -1, v5
    s_nop 0
    s_cbranch_vccnz FK_OS0
    v_mfma_f32_32x32x16_bf16 v[224:239], v[128:131], v[192:195], 0
    v_mfma_f32_32x32x16_bf16 v[240:255], v[132:135], v[192:195], 0
FK_OK1:
    s_waitcnt vmcnt(6)
    v_max3_u32 v5, v196, v197, v198
    v_max_u32 v5, v5, v199
    v_cmp_eq_u32 vcc, -1, v5
    s_nop 0
    s_cbranch_vccnz FK_OS1
    v_mfma_f32_32x32x16_bf16 v[224:239], v[136:139], v[196:199], v[224:239]
    v_mfma_f32_32x32x16_bf16 v[240:255], v[140:143], v[196:199], v[240:255]
FK_OK2:
    s_waitcnt vmcnt(5)
    v_max3_u32 v5, v200, v201, v202
    v_max_u32 v5, v5, v203
    v_cmp_eq_u32 vcc, -1, v5
    s_nop 0
    s_cbranch_vccnz FK_OS2
    v_mfma_f32_32x32x16_bf16 v[224:239], v[144:147], v[200:203], v[224:239]
    v_mfma_f32_32x32x16_bf16 v[240:255], v[148:151], v[200:203], v[240:255]
FK_OK3:
    s_waitcnt vmcnt(4)
    v_max3_u32 v5, v204, v205, v206
    v_max_u32 v5, v5, v207
    v_cmp_eq_u32 vcc, -1, v5
    s_nop 0
    s_cbranch_vccnz FK_OS3
    v_mfma_f32_32x32x16_bf16 v[224:239], v[152:155], v[204:207], v[224:239]
    v_mfma_f32_32x32x16_bf16 v[240:255], v[156:159], v[204:207], v[240:255]
FK_OK4:
    s_waitcnt vmcnt(3)
    v_max3_u32 v5, v208, v209, v210
    v_max_u32 v5, v5, v211
    v_cmp_eq_u32 vcc, -1, v5
    s_nop 0
    s_cbranch_vccnz FK_OS4
    v_mfma_f32_32x32x16_bf16 v[224:239], v[160:163], v[208:211], v[224:239]
    v_mfma_f32_32x32x16_bf16 v[240:255], v[164:167], v[208:211], v[240:255]
FK_OK5:
    s_waitcnt vmcnt(2)
    v_max3_u32 v5, v212, v213, v214
    v_max_u32 v5, v5, v215
    v_cmp_eq_u32 vcc, -1, v5
    s_nop 0
    s_cbranch_vccnz FK_OS5
    v_mfma_f32_32x32x16_bf16 v[224:239], v[168:171], v[212:215], v[224:239]
    v_mfma_f32_32x32x16_bf16 v[240:255], v[172:175], v[212:215], v[240:255]
FK_OK6:
    s_waitcnt vmcnt(1)
    v_max3_u32 v5, v216, v217, v218
    v_max_u32 v5, v5, v219
    v_cmp_eq_u32 vcc, -1, v5
    s_nop 0
    s_cbranch_vccnz FK_OS6
    v_mfma_f32_32x32x16_bf16 v[224:239], v[176:179], v[216:219], v[224:239]
    v_mfma_f32_32x32x16_bf16 v[240:255], v[180:183], v[216:219], v[240:255]
FK_OK7:
    s_waitcnt vmcnt(0)
    v_max3_u32 v5, v220, v221, v222
    v_max_u32 v5, v5, v223
    v_cmp_eq_u32 vcc, -1, v5
    s_nop 0
    s_cbranch_vccnz FK_OS7
    v_mfma_f32_32x32x16_bf16 v[224:239], v[184:187], v[220:223], v[224:239]
    v_mfma_f32_32x32x16_bf16 v[240:255], v[188:191], v[220:223], v[240:255]
FK_OK8:
    s_nop 10
    v_fmac_f32 v64, v224, v23
    v_fmac_f32 v65, v225, v23
    v_fmac_f32 v66, v226, v23
    v_fmac_f32 v67, v227, v23
    ds_write_b128 v32, v[64:67]
    v_fmac_f32 v68, v228, v23
    v_fmac_f32 v69, v229, v23
    v_fmac_f32 v70, v230, v23
    v_fmac_f32 v71, v231, v23
    ds_write_b128 v33, v[68:71]
    v_fmac_f32 v72, v232, v23
    v_fmac_f32 v73, v233, v23
    v_fmac_f32 v74, v234, v23
    v_fmac_f32 v75, v235, v23
    ds_write_b128 v34, v[72:75]
    v_fmac_f32 v76, v236, v23
    v_fmac_f32 v77, v237, v23
    v_fmac_f32 v78, v238, v23
    v_fmac_f32 v79, v239, v23
    ds_write_b128 v35, v[76:79]
    v_fmac_f32 v80, v240, v23
    v_fmac_f32 v81, v241, v23
    v_fmac_f32 v82, v242, v23
    v_fmac_f32 v83, v243, v23
    ds_write_b128 v36, v[80:83]
    v_fmac_f32 v84, v244, v23
    v_fmac_f32 v85, v245, v23
    v_fmac_f32 v86, v246, v23
    v_fmac_f32 v87, v247, v23
    ds_write_b128 v37, v[84:87]
    v_fmac_f32 v88, v248, v23
    v_fmac_f32 v89, v249, v23
    v_fmac_f32 v90, v250, v23
    v_fmac_f32 v91, v251, v23
    ds_write_b128 v38, v[88:91]
    v_fmac_f32 v92, v252, v23
    v_fmac_f32 v93, v253, v23
    v_fmac_f32 v94, v254, v23
    v_fmac_f32 v95, v255, v23
    ds_write_b128 v39, v[92:95]
    s_waitcnt lgkmcnt(0)
    s_barrier
    ds_read_b128 v[128:131], v12 offset:0
    ds_read_b128 v[132:135], v11 offset:0
    ds_read_b128 v[136:139], v12 offset:16384
    ds_read_b128 v[140:143], v11 offset:16384
    ds_read_b128 v[144:147], v12 offset:32768
    ds_read_b128 v[148:151], v11 offset:32768
    ds_read_b128 v[152:155], v12 offset:49152
    ds_read_b128 v[156:159], v11 offset:49152
    s_waitcnt lgkmcnt(5)
    v_pk_add_f32 v[128:129], v[128:129], v[136:137]
    v_pk_add_f32 v[130:131], v[130:131], v[138:139]
    s_waitcnt lgkmcnt(4)
    v_pk_add_f32 v[132:133], v[132:133], v[140:141]
    v_pk_add_f32 v[134:135], v[134:135], v[142:143]
    s_waitcnt lgkmcnt(1)
    v_pk_add_f32 v[144:145], v[144:145], v[152:153]
    v_pk_add_f32 v[146:147], v[146:147], v[154:155]
    s_waitcnt lgkmcnt(0)
    v_pk_add_f32 v[148:149], v[148:149], v[156:157]
    v_pk_add_f32 v[150:151], v[150:151], v[158:159]
    v_pk_add_f32 v[128:129], v[128:129], v[144:145]
    v_pk_add_f32 v[130:131], v[130:131], v[146:147]
    v_pk_add_f32 v[132:133], v[132:133], v[148:149]
    v_pk_add_f32 v[134:135], v[134:135], v[150:151]
    v_cvt_pk_bf16_f32 v136, v128, v129
    v_cvt_pk_bf16_f32 v137, v130, v131
    v_cvt_pk_bf16_f32 v138, v132, v133
    v_cvt_pk_bf16_f32 v139, v134, v135
    buffer_store_dwordx4 v[136:139], v13, s[12:15], s87 offen sc1
    s_endpgm
FK_OS0:
    s_mov_b32 s84, 0
    s_mov_b32 s86, 1
    s_waitcnt vmcnt(0)
    s_branch FK_OC1
FK_OS1:
    s_mov_b32 s84, 1
    s_mov_b32 s86, 2
    s_waitcnt vmcnt(0)
    s_branch FK_OC2
FK_OS2:
    s_mov_b32 s84, 2
    s_mov_b32 s86, 4
    s_waitcnt vmcnt(0)
    s_branch FK_OC3
FK_OS3:
    s_mov_b32 s84, 3
    s_mov_b32 s86, 8
    s_waitcnt vmcnt(0)
    s_branch FK_OC4
FK_OS4:
    s_mov_b32 s84, 4
    s_mov_b32 s86, 16
    s_waitcnt vmcnt(0)
    s_branch FK_OC5
FK_OS5:
    s_mov_b32 s84, 5
    s_mov_b32 s86, 32
    s_waitcnt vmcnt(0)
    s_branch FK_OC6
FK_OS6:
    s_mov_b32 s84, 6
    s_mov_b32 s86, 64
    s_waitcnt vmcnt(0)
    s_branch FK_OC7
FK_OS7:
    s_mov_b32 s84, 7
    s_mov_b32 s86, 128
    s_branch FK_OC8
FK_OC1:
    v_max3_u32 v5, v196, v197, v198
    v_max_u32 v5, v5, v199
    v_cmp_eq_u32 vcc, -1, v5
    s_nop 0
    s_cbranch_vccz FK_OC2
    s_bitset1_b32 s86, 1
FK_OC2:
    v_max3_u32 v5, v200, v201, v202
    v_max_u32 v5, v5, v203
    v_cmp_eq_u32 vcc, -1, v5
    s_nop 0
    s_cbranch_vccz FK_OC3
    s_bitset1_b32 s86, 2
FK_OC3:
    v_max3_u32 v5, v204, v205, v206
    v_max_u32 v5, v5, v207
    v_cmp_eq_u32 vcc, -1, v5
    s_nop 0
    s_cbranch_vccz FK_OC4
    s_bitset1_b32 s86, 3
FK_OC4:
    v_max3_u32 v5, v208, v209, v210
    v_max_u32 v5, v5, v211
    v_cmp_eq_u32 vcc, -1, v5
    s_nop 0
    s_cbranch_vccz FK_OC5
    s_bitset1_b32 s86, 4
FK_OC5:
    v_max3_u32 v5, v212, v213, v214
    v_max_u32 v5, v5, v215
    v_cmp_eq_u32 vcc, -1, v5
    s_nop 0
    s_cbranch_vccz FK_OC6
    s_bitset1_b32 s86, 5
FK_OC6:
    v_max3_u32 v5, v216, v217, v218
    v_max_u32 v5, v5, v219
    v_cmp_eq_u32 vcc, -1, v5
    s_nop 0
    s_cbranch_vccz FK_OC7
    s_bitset1_b32 s86, 6
FK_OC7:
    v_max3_u32 v5, v220, v221, v222
    v_max_u32 v5, v5, v223
    v_cmp_eq_u32 vcc, -1, v5
    s_nop 0
    s_cbranch_vccz FK_OC8
    s_bitset1_b32 s86, 7
FK_OC8:
    s_add_u32 s88, s88, 1
    s_cmp_ge_u32 s88, 40000
    s_cbranch_scc1 FK_OK8
    s_bcnt1_i32_b32 s71, s86
    s_cmp_le_u32 s71, 0
    s_cbranch_scc1 FK_OR
FK_OP:
    s_sleep 2
    buffer_load_dword v6, v7, s[52:55], s77 offen offset:1020 sc1
    s_add_u32 s88, s88, 1
    s_cmp_ge_u32 s88, 40000
    s_cbranch_scc1 FK_OR
    s_waitcnt vmcnt(0)
    v_cmp_ne_u32 vcc, -1, v6
    s_nop 0
    s_and_b32 s71, vcc_lo, s86
    s_cbranch_scc0 FK_OP
FK_OR:
    s_bitcmp1_b32 s86, 0
    s_cbranch_scc0 FK_OT0
    buffer_load_dwordx4 v[192:195], v2, s[52:55], s77 offen offset:0 sc1
FK_OT0:
    s_bitcmp1_b32 s86, 1
    s_cbranch_scc0 FK_OT1
    buffer_load_dwordx4 v[196:199], v2, s[52:55], s77 offen offset:1024 sc1
FK_OT1:
    s_bitcmp1_b32 s86, 2
    s_cbranch_scc0 FK_OT2
    buffer_load_dwordx4 v[200:203], v2, s[52:55], s77 offen offset:2048 sc1
FK_OT2:
    s_bitcmp1_b32 s86, 3
    s_cbranch_scc0 FK_OT3
    buffer_load_dwordx4 v[204:207], v2, s[52:55], s77 offen offset:3072 sc1
FK_OT3:
    s_bitcmp1_b32 s86, 4
    s_cbranch_scc0 FK_OT4
    buffer_load_dwordx4 v[208:211], v2, s[52:55], s85 offen offset:0 sc1
FK_OT4:
    s_bitcmp1_b32 s86, 5
    s_cbranch_scc0 FK_OT5
    buffer_load_dwordx4 v[212:215], v2, s[52:55], s85 offen offset:1024 sc1
FK_OT5:
    s_bitcmp1_b32 s86, 6
    s_cbranch_scc0 FK_OT6
    buffer_load_dwordx4 v[216:219], v2, s[52:55], s85 offen offset:2048 sc1
FK_OT6:
    s_bitcmp1_b32 s86, 7
    s_cbranch_scc0 FK_OT7
    buffer_load_dwordx4 v[220:223], v2, s[52:55], s85 offen offset:3072 sc1
FK_OT7:
    s_waitcnt vmcnt(0)
    s_cmp_eq_u32 s84, 0
    s_cbranch_scc1 FK_OK0
    s_cmp_eq_u32 s84, 1
    s_cbranch_scc1 FK_OK1
    s_cmp_eq_u32 s84, 2
    s_cbranch_scc1 FK_OK2
    s_cmp_eq_u32 s84, 3
    s_cbranch_scc1 FK_OK3
    s_cmp_eq_u32 s84, 4
    s_cbranch_scc1 FK_OK4
    s_cmp_eq_u32 s84, 5
    s_cbranch_scc1 FK_OK5
    s_cmp_eq_u32 s84, 6
    s_cbranch_scc1 FK_OK6
    s_branch FK_OK7
FK_FB:
    s_lshl_b32 s71, s16, 16
    s_add_u32 s86, s71, 0x200000
    v_mov_b32 v5, 0xff800000
    s_mov_b32 s97, 0
FK_FB1:
    buffer_load_dwordx4 v[120:123], v2, s[52:55], s86 offen sc1
    s_waitcnt vmcnt(0)
    v_mfma_f32_32x32x16_bf16 v[128:143], v[120:123], v[116:119], 0
    s_nop 11
    v_max3_f32 v5, v5, v128, v129
    v_max3_f32 v5, v5, v130, v131
    v_max3_f32 v5, v5, v132, v133
    v_max3_f32 v5, v5, v134, v135
    v_max3_f32 v5, v5, v136, v137
    v_max3_f32 v5, v5, v138, v139
    v_max3_f32 v5, v5, v140, v141
    v_max3_f32 v5, v5, v142, v143
    s_add_u32 s86, s86, 1024
    s_add_u32 s97, s97, 1
    s_cmp_lt_u32 s97, 64
    s_cbranch_scc1 FK_FB1
    v_mov_b32 v7, v5
    s_nop 1
    v_permlane32_swap_b32 v5, v7
    v_max_f32 v5, v5, v7
    v_sub_f32 v192, 0, v5
    v_mov_b32 v176, 0
    v_sub_f32 v193, 0, v5
    v_mov_b32 v177, 0
    v_sub_f32 v194, 0, v5
    v_mov_b32 v178, 0
    v_sub_f32 v195, 0, v5
    v_mov_b32 v179, 0
    v_sub_f32 v196, 0, v5
    v_mov_b32 v180, 0
    v_sub_f32 v197, 0, v5
    v_mov_b32 v181, 0
    v_sub_f32 v198, 0, v5
    v_mov_b32 v182, 0
    v_sub_f32 v199, 0, v5
    v_mov_b32 v183, 0
    v_sub_f32 v200, 0, v5
    v_mov_b32 v184, 0
    v_sub_f32 v201, 0, v5
    v_mov_b32 v185, 0
    v_sub_f32 v202, 0, v5
    v_mov_b32 v186, 0
    v_sub_f32 v203, 0, v5
    v_mov_b32 v187, 0
    v_sub_f32 v204, 0, v5
    v_mov_b32 v188, 0
    v_sub_f32 v205, 0, v5
    v_mov_b32 v189, 0
    v_sub_f32 v206, 0, v5
    v_mov_b32 v190, 0
    v_sub_f32 v207, 0, v5
    v_mov_b32 v191, 0
    v_lshrrev_b32 v5, 5, v1
    v_and_b32 v6, 15, v1
    v_lshlrev_b32 v6, 4, v6
    v_lshl_add_u32 v6, v5, 8, v6
    s_add_u32 s86, s71, 0x200000
    s_add_u32 s87, s71, 0x400000
    s_mov_b32 s97, 0
FK_FB2:
    buffer_load_dwordx4 v[120:123], v2, s[52:55], s86 offen sc1
    s_mov_b64 exec, s[98:99]
    buffer_load_dwordx4 v[208:211], v6, s[52:55], s87 offen sc1
    buffer_load_dwordx4 v[212:215], v6, s[52:55], s87 offen offset:512 sc1
    s_mov_b64 exec, -1
    s_waitcnt vmcnt(2)
    v_mfma_f32_32x32x16_bf16 v[128:143], v[120:123], v[116:119], v[192:207]
    s_nop 11
    v_exp_f32 v128, v128
    v_exp_f32 v129, v129
    v_exp_f32 v130, v130
    v_exp_f32 v131, v131
    v_exp_f32 v132, v132
    v_exp_f32 v133, v133
    v_exp_f32 v134, v134
    v_exp_f32 v135, v135
    v_exp_f32 v136, v136
    v_exp_f32 v137, v137
    v_exp_f32 v138, v138
    v_exp_f32 v139, v139
    v_exp_f32 v140, v140
    v_exp_f32 v141, v141
    v_exp_f32 v142, v142
    v_exp_f32 v143, v143
    v_cvt_pk_bf16_f32 v224, v128, v129
    v_cvt_pk_bf16_f32 v225, v130, v131
    v_cvt_pk_bf16_f32 v226, v132, v133
    v_cvt_pk_bf16_f32 v227, v134, v135
    v_cvt_pk_bf16_f32 v228, v136, v137
    v_cvt_pk_bf16_f32 v229, v138, v139
    v_cvt_pk_bf16_f32 v230, v140, v141
    v_cvt_pk_bf16_f32 v231, v142, v143
    s_waitcnt vmcnt(1)
    v_mfma_f32_32x32x16_bf16 v[176:191], v[208:211], v[224:227], v[176:191]
    s_waitcnt vmcnt(0)
    v_mfma_f32_32x32x16_bf16 v[176:191], v[212:215], v[228:231], v[176:191]
    s_add_u32 s86, s86, 1024
    s_add_u32 s87, s87, 1024
    s_add_u32 s97, s97, 1
    s_cmp_lt_u32 s97, 64
    s_cbranch_scc1 FK_FB2
    s_nop 6
    v_rcp_f32 v8, v184
    s_nop 0
    v_mul_f32 v176, v176, v8
    v_mul_f32 v177, v177, v8
    v_mul_f32 v178, v178, v8
    v_mul_f32 v179, v179, v8
    v_mul_f32 v180, v180, v8
    v_mul_f32 v181, v181, v8
    v_mul_f32 v182, v182, v8
    v_mul_f32 v183, v183, v8
    v_cvt_pk_bf16_f32 v120, v176, v177
    v_cvt_pk_bf16_f32 v121, v178, v179
    v_cvt_pk_bf16_f32 v122, v180, v181
    v_cvt_pk_bf16_f32 v123, v182, v183
    s_branch FK_FBRET
FK_END:
    s_endpgm
FK_CODE_END:

.section .rodata,"a"
.p2align 6
.amdhsa_kernel gated_mix__mha_block__mixer_gmlp__prompt_kernel
  .amdhsa_next_free_vgpr 256
  .amdhsa_next_free_sgpr 102
  .amdhsa_accum_offset 256
  .amdhsa_group_segment_fixed_size 0
  .amdhsa_kernarg_size 96
  .amdhsa_user_sgpr_count 2
  .amdhsa_user_sgpr_kernarg_segment_ptr 1
  .amdhsa_system_sgpr_workgroup_id_x 1
.end_amdhsa_kernel
```
